```python
import torch

def _softmax(x, axis=-1):
    return torch.softmax(x, dim=axis)
def _gelu(x):
    return torch.nn.functional.gelu(x, approximate="tanh")
def _silu(x):
    return torch.nn.functional.silu(x)
def _sigmoid(x):
    return torch.sigmoid(x)
def _layernorm(x, axis=-1, eps=1e-5):
    m = x.mean(dim=axis, keepdim=True)
    v = x.var(dim=axis, keepdim=True, unbiased=False)
    return (x - m) / torch.sqrt(v + eps)
def _scatter_add(tgt, idx, src, axis=0):
    return tgt.clone().index_add_(axis, idx, src)
def _segment_sum(src, seg, n):
    out = torch.zeros((n,) + src.shape[1:], dtype=src.dtype)
    return out.index_add_(0, seg, src)
def _pad(x, pw):
    flat = tuple(v for pair in reversed(pw) for v in pair)
    return torch.nn.functional.pad(x, flat)

kernel_name = 'parallel_sum__sliding_local_dilated__mixer_channel_mlp__prompt'

def setup_inputs():

    _w = (lambda a: (lambda t: t.to(torch.bfloat16) if t.is_floating_point() else t)(torch.as_tensor(a)))
    def _A_setup():
        B, S, D = 1, 2048, 640
        return {
            "x": _w((lambda *s: torch.randn(*s, dtype=torch.bfloat16) * 0.05)(B, S, D)),
            "wqkv": _w((lambda *s: torch.randn(*s, dtype=torch.bfloat16) * 0.05)(D, 3 * D)),
            "wo": _w((lambda *s: torch.randn(*s, dtype=torch.bfloat16) * 0.05)(D, D)),
        }
    _A_in = _A_setup()

    def _B_setup():
        B, S, D, F = 1, 2048, 640, 1728
        return {
            "x": _w((lambda *s: torch.randn(*s, dtype=torch.bfloat16) * 0.05)(B, S, D)),
            "w1": _w((lambda *s: torch.randn(*s, dtype=torch.bfloat16) * 3.2)(D, F) * (D ** -0.5)),
            "b1": _w((lambda *s: torch.randn(*s, dtype=torch.bfloat16) * 1.6)(F)),
            "w2": _w((lambda *s: torch.randn(*s, dtype=torch.bfloat16) * 0.2)(F, D) * (F ** -0.5)),
            "b2": _w((lambda *s: torch.randn(*s, dtype=torch.bfloat16) * 0.4)(D)),
        }
    _B_in = _B_setup()

    return {
        "A_x": _A_in["x"],
        "A_wqkv": _A_in["wqkv"],
        "A_wo": _A_in["wo"],
        "B_x": _B_in["x"],
        "B_w1": _B_in["w1"],
        "B_b1": _B_in["b1"],
        "B_w2": _B_in["w2"],
        "B_b2": _B_in["b2"],
    }

def reference(A_x, A_wqkv, A_wo, B_x, B_w1, B_b1, B_w2, B_b2):
    def _A_ref(x, wqkv, wo):
        B, S, D = x.shape
        H = 32; Dh = D // H
        W, dil = 8, 2
        qkv = (lambda x, *d: x.permute(*d))((x @ wqkv).reshape(B, S, 3, H, Dh), 2, 0, 3, 1, 4)
        q, k, v = qkv[0], qkv[1], qkv[2]
        scale = Dh ** -0.5
        pos = torch.arange(S)
        off = torch.arange(W) * dil
        idx = pos[:, None] - off[None, :]
        mask = idx >= 0
        idx_c = torch.where(mask, idx, 0).reshape(-1)
        kg = k[:, :, idx_c, :].reshape(B, H, S, W, Dh)
        vg = v[:, :, idx_c, :].reshape(B, H, S, W, Dh)
        logits = torch.einsum("bhsd,bhswd->bhsw", q, kg) * scale
        logits = torch.where(mask[None, None, :, :], logits, -1e9)
        attn = _softmax(logits, axis=-1)
        o = torch.einsum("bhsw,bhswd->bhsd", attn, vg)
        return (lambda x, *d: x.permute(*d))(o, 0, 2, 1, 3).reshape(B, S, D) @ wo

    def _B_ref(x, w1, b1, w2, b2):
        y = _layernorm(x, axis=-1)
        h = _gelu(torch.einsum("bsd,df->bsf", y, w1) + b1)
        return torch.einsum("bsf,fd->bsd", h, w2) + b2

    x = A_x
    xn = _layernorm(x, axis=-1)
    return x + _A_ref(xn, A_wqkv, A_wo) + _B_ref(xn, B_w1, B_b1, B_w2, B_b2)
```

```asm
; @launch grid=(256,1,1) block=(256,1,1) lds=160768
.amdgcn_target "amdgcn-amd-amdhsa--gfx950"
.text
.globl parallel_sum__sliding_local_dilated__mixer_channel_mlp__prompt_kernel
.p2align 8
.type parallel_sum__sliding_local_dilated__mixer_channel_mlp__prompt_kernel,@function
parallel_sum__sliding_local_dilated__mixer_channel_mlp__prompt_kernel:
  s_cmp_ge_u32 s2, 256
  s_cbranch_scc1 L_end1
  s_add_u32 s2, s2, 144
  s_and_b32 s2, s2, 255
  s_load_dwordx4 s[60:63], s[0:1], 0
  s_load_dwordx4 s[64:67], s[0:1], 32
  s_load_dwordx4 s[68:71], s[0:1], 72
  s_load_dwordx2 s[56:57], s[0:1], 48
  s_load_dwordx2 s[58:59], s[0:1], 16
  v_lshrrev_b32 v2, 6, v0
  v_and_b32 v1, 63, v0
  v_readfirstlane_b32 s20, v2
  s_bfe_u32 s21, s2, 0x10002
  s_lshr_b32 s3, s2, 3
  s_cmp_ge_u32 s3, 18
  s_cbranch_scc1 L_w1
  s_and_b32 s23, s2, 3
  s_lshl_b32 s23, s23, 1
  s_and_b32 s41, s3, 1
  s_add_u32 s23, s23, s41
  s_lshr_b32 s22, s3, 1
  s_mul_i32 s43, s41, 1
  s_add_u32 s43, s43, s22
  s_mul_i32 s41, s43, 52
  s_lshr_b32 s41, s41, 8
  s_mul_i32 s41, s41, 5
  s_sub_u32 s43, s43, s41
  s_mul_i32 s43, s43, 1
  s_add_u32 s41, s43, 0
  s_sub_u32 s42, s41, 5
  s_cmp_ge_u32 s41, 5
  s_cselect_b32 s41, s42, s41
  s_lshl_b32 s26, s41, 8
  s_mul_i32 s31, s41, 491520
  s_add_u32 s41, s43, 1
  s_sub_u32 s42, s41, 5
  s_cmp_ge_u32 s41, 5
  s_cselect_b32 s41, s42, s41
  s_lshl_b32 s27, s41, 8
  s_mul_i32 s32, s41, 491520
  s_add_u32 s41, s43, 2
  s_sub_u32 s42, s41, 5
  s_cmp_ge_u32 s41, 5
  s_cselect_b32 s41, s42, s41
  s_lshl_b32 s28, s41, 8
  s_mul_i32 s33, s41, 491520
  s_add_u32 s41, s43, 3
  s_sub_u32 s42, s41, 5
  s_cmp_ge_u32 s41, 5
  s_cselect_b32 s41, s42, s41
  s_lshl_b32 s29, s41, 8
  s_mul_i32 s34, s41, 491520
  s_add_u32 s41, s43, 4
  s_sub_u32 s42, s41, 5
  s_cmp_ge_u32 s41, 5
  s_cselect_b32 s41, s42, s41
  s_lshl_b32 s30, s41, 8
  s_mul_i32 s35, s41, 491520
  s_waitcnt lgkmcnt(0)
  s_mov_b32 s4, s60
  s_and_b32 s5, s61, 0xffff
  s_mov_b32 s6, 2621440
  s_mov_b32 s7, 0x20000
  s_mov_b32 s8, s62
  s_and_b32 s9, s63, 0xffff
  s_mov_b32 s10, 2457600
  s_mov_b32 s11, 0x20000
  s_mov_b32 s12, s70
  s_and_b32 s13, s71, 0xffff
  s_mov_b32 s14, 9699328
  s_mov_b32 s15, 0x20000
  s_mul_i32 s54, s22, 120
  s_lshl_b32 s41, s20, 5
  s_add_u32 s54, s54, s41
  s_sub_u32 s54, s54, 8
  v_lshrrev_b32 v2, 3, v1
  v_lshlrev_b32 v2, 1, v2
  v_add_u32 v2, s54, v2
  v_lshlrev_b32 v3, 1, v2
  v_add_u32 v3, s21, v3
  v_mul_u32_u24 v3, 1280, v3
  s_mul_i32 s40, s20, 5120
  v_lshrrev_b32 v4, 4, v1
  v_xor_b32 v4, v4, v1
  v_and_b32 v4, 7, v4
  v_lshlrev_b32 v4, 4, v4
  v_add_u32 v92, v4, v3
  v_xor_b32 v4, 64, v4
  v_add_u32 v93, v4, v3
  v_add_u32 v93, 40960, v93
  s_movk_i32 s41, 1024
  v_cmp_gt_u32 vcc, s41, v2
  v_bfrev_b32 v3, 1
  s_nop 0
  v_cndmask_b32 v92, v3, v92, vcc
  v_add_u32 v2, 16, v2
  v_cmp_gt_u32 vcc, s41, v2
  s_nop 1
  v_cndmask_b32 v93, v3, v93, vcc
  s_add_u32 m0, s40, 40960
  s_nop 0
  buffer_load_dwordx4 v92, s[4:7], s26 offen offset:0 lds
  s_add_u32 m0, s40, 41984
  s_nop 0
  buffer_load_dwordx4 v93, s[4:7], s26 offen offset:0 lds
  s_add_u32 m0, s40, 42880
  s_nop 0
  buffer_load_dwordx4 v92, s[4:7], s26 offen offset:128 lds
  s_add_u32 m0, s40, 43904
  s_nop 0
  buffer_load_dwordx4 v93, s[4:7], s26 offen offset:128 lds
  s_add_u32 m0, s40, 61440
  s_nop 0
  buffer_load_dwordx4 v92, s[4:7], s27 offen offset:0 lds
  s_add_u32 m0, s40, 62464
  s_nop 0
  buffer_load_dwordx4 v93, s[4:7], s27 offen offset:0 lds
  s_add_u32 m0, s40, 63360
  s_nop 0
  buffer_load_dwordx4 v92, s[4:7], s27 offen offset:128 lds
  s_add_u32 m0, s40, 64384
  s_nop 0
  buffer_load_dwordx4 v93, s[4:7], s27 offen offset:128 lds
  s_add_u32 m0, s40, 81920
  s_nop 0
  buffer_load_dwordx4 v92, s[4:7], s28 offen offset:0 lds
  s_add_u32 m0, s40, 82944
  s_nop 0
  buffer_load_dwordx4 v93, s[4:7], s28 offen offset:0 lds
  s_add_u32 m0, s40, 83840
  s_nop 0
  buffer_load_dwordx4 v92, s[4:7], s28 offen offset:128 lds
  s_add_u32 m0, s40, 84864
  s_nop 0
  buffer_load_dwordx4 v93, s[4:7], s28 offen offset:128 lds
  s_mul_i32 s38, s23, 160
  s_add_u32 s36, s38, 1280
  s_add_u32 s37, s38, 2560
  s_lshl_b32 s41, s20, 5
  v_add_u32 v7, 0, v1
  v_mul_u32_u24 v8, 6554, v7
  v_lshrrev_b32 v8, 16, v8
  v_mul_u32_u24 v9, 10, v8
  v_sub_u32 v7, v7, v9
  v_and_b32 v9, 0x13, v8
  v_bfe_u32 v10, v8, 2, 1
  v_lshl_add_u32 v9, v10, 3, v9
  v_bfe_u32 v10, v8, 3, 1
  v_lshl_add_u32 v9, v10, 2, v9
  v_add_u32 v9, s41, v9
  v_mul_u32_u24 v9, 3840, v9
  v_lshl_add_u32 v9, v7, 4, v9
  v_subrev_u32 v2, 0, v9
  v_add_u32 v7, 64, v1
  v_mul_u32_u24 v8, 6554, v7
  v_lshrrev_b32 v8, 16, v8
  v_mul_u32_u24 v9, 10, v8
  v_sub_u32 v7, v7, v9
  v_and_b32 v9, 0x13, v8
  v_bfe_u32 v10, v8, 2, 1
  v_lshl_add_u32 v9, v10, 3, v9
  v_bfe_u32 v10, v8, 3, 1
  v_lshl_add_u32 v9, v10, 2, v9
  v_add_u32 v9, s41, v9
  v_mul_u32_u24 v9, 3840, v9
  v_lshl_add_u32 v9, v7, 4, v9
  v_subrev_u32 v3, 1024, v9
  v_add_u32 v7, 128, v1
  v_mul_u32_u24 v8, 6554, v7
  v_lshrrev_b32 v8, 16, v8
  v_mul_u32_u24 v9, 10, v8
  v_sub_u32 v7, v7, v9
  v_and_b32 v9, 0x13, v8
  v_bfe_u32 v10, v8, 2, 1
  v_lshl_add_u32 v9, v10, 3, v9
  v_bfe_u32 v10, v8, 3, 1
  v_lshl_add_u32 v9, v10, 2, v9
  v_add_u32 v9, s41, v9
  v_mul_u32_u24 v9, 3840, v9
  v_lshl_add_u32 v9, v7, 4, v9
  v_subrev_u32 v4, 2048, v9
  v_add_u32 v7, 192, v1
  v_mul_u32_u24 v8, 6554, v7
  v_lshrrev_b32 v8, 16, v8
  v_mul_u32_u24 v9, 10, v8
  v_sub_u32 v7, v7, v9
  v_and_b32 v9, 0x13, v8
  v_bfe_u32 v10, v8, 2, 1
  v_lshl_add_u32 v9, v10, 3, v9
  v_bfe_u32 v10, v8, 3, 1
  v_lshl_add_u32 v9, v10, 2, v9
  v_add_u32 v9, s41, v9
  v_mul_u32_u24 v9, 3840, v9
  v_lshl_add_u32 v9, v7, 4, v9
  v_subrev_u32 v5, 3072, v9
  v_add_u32 v7, 256, v1
  v_mul_u32_u24 v8, 6554, v7
  v_lshrrev_b32 v8, 16, v8
  v_mul_u32_u24 v9, 10, v8
  v_sub_u32 v7, v7, v9
  v_and_b32 v9, 0x13, v8
  v_bfe_u32 v10, v8, 2, 1
  v_lshl_add_u32 v9, v10, 3, v9
  v_bfe_u32 v10, v8, 3, 1
  v_lshl_add_u32 v9, v10, 2, v9
  v_add_u32 v9, s41, v9
  v_mul_u32_u24 v9, 3840, v9
  v_lshl_add_u32 v9, v7, 4, v9
  v_subrev_u32 v6, 0, v9
  v_lshrrev_b32 v7, 5, v1
  v_lshlrev_b32 v7, 4, v7
  v_bfe_u32 v8, v1, 4, 1
  v_lshl_add_u32 v7, v8, 2, v7
  v_bfe_u32 v8, v1, 2, 2
  v_add_u32 v7, v7, v8
  v_lshlrev_b32 v7, 2, v7
  v_and_b32 v8, 3, v1
  v_add_u32 v7, v7, v8
  v_mul_u32_u24 v7, 40, v7
  v_add_u32 v8, 61440, v7
  v_lshrrev_b32 v9, 4, v1
  v_and_b32 v10, 3, v1
  v_lshl_add_u32 v9, v9, 2, v10
  v_mul_u32_u24 v9, 160, v9
  s_mul_i32 s41, s20, 2560
  s_add_u32 s41, s41, 144384
  s_add_u32 s42, s20, 3
  s_and_b32 s42, s42, 3
  s_mul_i32 s42, s42, 2560
  s_add_u32 s42, s42, 144384
  v_add_u32 v10, s42, v9
  v_add_u32 v9, s41, v9
  v_and_b32 v11, 15, v1
  v_lshlrev_b32 v11, 3, v11
  s_lshl_b32 s41, s20, 7
  s_add_u32 s41, s41, 143360
  v_add_u32 v11, s41, v11
  s_mov_b32 s52, 0xf000f000
  s_mov_b32 s53, 0xf000f000
  s_and_b32 s41, s2, 7
  s_lshl_b32 s41, s41, 2
  s_lshr_b32 s42, s2, 6
  s_add_u32 s100, s41, s42
  s_bfe_u32 s101, s2, 0x30003
  s_mul_i32 s62, s100, 303104
  s_mul_i32 s63, s101, 378880
  v_mov_b32 v32, 0x3f803f80
  v_mov_b32 v33, v32
  v_mov_b32 v34, v32
  v_mov_b32 v35, v32
  v_and_b32 v44, 15, v1
  v_lshrrev_b32 v45, 4, v1
  v_lshrrev_b32 v46, 2, v44
  v_and_b32 v47, 1, v1
  v_lshlrev_b32 v47, 4, v47
  v_mov_b32 v48, 0x3f80
  v_lshlrev_b32 v48, v47, v48
  v_cmp_eq_u32 vcc, v45, v46
  s_nop 1
  v_cndmask_b32 v48, 0, v48, vcc
  v_and_b32 v47, 2, v1
  v_cmp_eq_u32 vcc, 0, v47
  v_mov_b32 v36, 0
  v_mov_b32 v37, 0
  v_cndmask_b32 v38, 0, v48, vcc
  v_cndmask_b32 v39, v48, 0, vcc
  v_mov_b32 v40, 0
  v_mov_b32 v41, 0
  v_bfe_u32 v42, v1, 1, 3
  v_lshrrev_b32 v43, 4, v1
  v_xor_b32 v42, v42, v43
  v_and_b32 v43, 15, v1
  v_lshlrev_b32 v43, 7, v43
  v_lshl_add_u32 v42, v42, 4, v43
  s_add_u32 s41, s40, 40960
  v_add_u32 v42, s41, v42
  v_xor_b32 v43, 64, v42
  v_add_u32 v88, 61440, v42
  v_add_u32 v89, 61440, v43
  s_add_u32 m0, s40, 102400
  s_nop 0
  buffer_load_dwordx4 v92, s[4:7], s29 offen offset:0 lds
  s_add_u32 m0, s40, 103424
  s_nop 0
  buffer_load_dwordx4 v93, s[4:7], s29 offen offset:0 lds
  s_add_u32 m0, s40, 104320
  s_nop 0
  buffer_load_dwordx4 v92, s[4:7], s29 offen offset:128 lds
  s_add_u32 m0, s40, 105344
  s_nop 0
  buffer_load_dwordx4 v93, s[4:7], s29 offen offset:128 lds
  s_add_u32 m0, s40, 122880
  s_nop 0
  buffer_load_dwordx4 v92, s[4:7], s30 offen offset:0 lds
  s_add_u32 m0, s40, 123904
  s_nop 0
  buffer_load_dwordx4 v93, s[4:7], s30 offen offset:0 lds
  s_add_u32 m0, s40, 124800
  s_nop 0
  buffer_load_dwordx4 v92, s[4:7], s30 offen offset:128 lds
  s_add_u32 m0, s40, 125824
  s_nop 0
  buffer_load_dwordx4 v93, s[4:7], s30 offen offset:128 lds
  s_getpc_b64 s[72:73]
L_pcq:
  s_sub_u32 s72, s72, L_pcq-parallel_sum__sliding_local_dilated__mixer_channel_mlp__prompt_kernel
  s_subb_u32 s73, s73, 0
  s_lshl_b32 s74, s20, 11
  s_bfe_u32 s75, s2, 0x20003
  s_lshl_b32 s75, s75, 13
  s_add_u32 s74, s74, s75
  v_lshlrev_b32 v254, 7, v1
  v_add_u32 v254, s74, v254
  v_min_u32 v254, L_w1-parallel_sum__sliding_local_dilated__mixer_channel_mlp__prompt_kernel, v254
  v_mov_b32 v255, s73
  v_add_co_u32 v254, vcc, s72, v254
  s_nop 1
  v_addc_co_u32 v255, vcc, 0, v255, vcc
  s_add_u32 s76, s70, 13631488
  s_addc_u32 s77, s71, 0
  s_and_b32 s77, s77, 0xffff
  s_mov_b32 s78, 37888
  s_mov_b32 s79, 0x20000
  s_lshr_b32 s72, s100, 4
  s_and_b32 s73, s100, 15
  s_lshr_b32 s74, s73, 1
  s_lshl_b32 s75, s72, 3
  s_add_u32 s75, s75, s74
  s_mul_i32 s72, s72, 9
  s_add_u32 s72, s72, s74
  s_add_u32 s72, s72, 16
  s_and_b32 s73, s73, 1
  s_add_u32 s73, s73, s72
  v_mov_b32 v96, s73
  v_mov_b32 v97, s72
  v_cmp_gt_u32 vcc, 16, v1
  s_nop 1
  v_cndmask_b32 v96, v96, v97, vcc
  v_mov_b32 v97, s75
  v_cmp_gt_u32 vcc, 8, v1
  s_nop 1
  v_cndmask_b32 v96, v96, v97, vcc
  v_and_b32 v97, 7, v1
  v_lshlrev_b32 v97, 7, v97
  v_lshl_add_u32 v96, v96, 10, v97
  s_mul_i32 s72, s21, 9
  s_add_u32 s72, s72, s22
  s_add_u32 s72, s72, 16
  s_lshl_b32 s72, s72, 10
  s_lshl_b32 s73, s23, 7
  s_add_u32 s72, s72, s73
  v_writelane_b32 v96, s72, 24
  s_lshl_b32 s72, s2, 2
  s_add_u32 s72, s72, 36864
  s_cmp_lt_u32 s2, 192
  s_cselect_b32 s72, s72, 0x40000000
  v_writelane_b32 v96, s72, 25
  s_cmp_eq_u32 s20, 0
  s_cselect_b32 s72, 36864, 0x40000000
  v_mul_u32_u24 v97, 12, v1
  v_add_u32 v97, s72, v97
  v_cmp_gt_u32 vcc, 26, v1
  v_mov_b32 v98, 0x40000000
  s_nop 0
  v_cndmask_b32 v96, v98, v96, vcc
  buffer_load_dword a35, v96, s[76:79], 0 offen sc1
  buffer_load_dwordx3 a[32:34], v97, s[76:79], 0 offen sc1
  s_waitcnt vmcnt(20)
  ds_read_b128 v[96:99], v42 offset:0
  ds_read_b128 v[100:103], v43 offset:0
  s_waitcnt vmcnt(18)
  ds_read_b128 v[104:107], v42 offset:2048
  s_waitcnt lgkmcnt(2)
  v_mfma_f32_16x16x32_bf16 v[44:47], v[32:35], v[96:99], 0
  v_mfma_f32_16x16x32_bf16 v[52:55], v[96:99], v[96:99], 0
  ds_read_b128 v[108:111], v43 offset:2048
  s_waitcnt lgkmcnt(2)
  v_mfma_f32_16x16x32_bf16 v[44:47], v[32:35], v[100:103], v[44:47]
  v_mfma_f32_16x16x32_bf16 v[52:55], v[100:103], v[100:103], v[52:55]
  s_add_u32 s42, s26, 2560
  s_add_u32 m0, s40, 40960
  s_nop 0
  buffer_load_dwordx4 v92, s[4:7], s42 offen offset:0 lds
  s_add_u32 m0, s40, 41984
  s_nop 0
  buffer_load_dwordx4 v93, s[4:7], s42 offen offset:0 lds
  s_mov_b32 exec_lo, 0xffff
  s_mov_b32 exec_hi, 0
  global_load_dword a31, v[254:255], off
  s_mov_b64 exec, -1
  s_waitcnt vmcnt(19)
  ds_read_b128 v[112:115], v42 offset:20480
  s_waitcnt lgkmcnt(2)
  v_mfma_f32_16x16x32_bf16 v[44:47], v[32:35], v[104:107], v[44:47]
  v_mfma_f32_16x16x32_bf16 v[52:55], v[104:107], v[104:107], v[52:55]
  ds_read_b128 v[116:119], v43 offset:20480
  s_waitcnt lgkmcnt(2)
  v_mfma_f32_16x16x32_bf16 v[44:47], v[32:35], v[108:111], v[44:47]
  v_mfma_f32_16x16x32_bf16 v[52:55], v[108:111], v[108:111], v[52:55]
  s_add_u32 m0, s40, 42880
  s_nop 0
  buffer_load_dwordx4 v92, s[4:7], s42 offen offset:128 lds
  s_add_u32 m0, s40, 43904
  s_nop 0
  buffer_load_dwordx4 v93, s[4:7], s42 offen offset:128 lds
  s_waitcnt vmcnt(19)
  ds_read_b128 v[120:123], v42 offset:22528
  s_waitcnt lgkmcnt(2)
  v_mfma_f32_16x16x32_bf16 v[44:47], v[32:35], v[112:115], v[44:47]
  v_mfma_f32_16x16x32_bf16 v[52:55], v[112:115], v[112:115], v[52:55]
  ds_read_b128 v[124:127], v43 offset:22528
  s_waitcnt lgkmcnt(2)
  v_mfma_f32_16x16x32_bf16 v[44:47], v[32:35], v[116:119], v[44:47]
  v_mfma_f32_16x16x32_bf16 v[52:55], v[116:119], v[116:119], v[52:55]
  s_add_u32 s42, s27, 2560
  s_add_u32 m0, s40, 61440
  s_nop 0
  buffer_load_dwordx4 v92, s[4:7], s42 offen offset:0 lds
  s_add_u32 m0, s40, 62464
  s_nop 0
  buffer_load_dwordx4 v93, s[4:7], s42 offen offset:0 lds
  s_waitcnt vmcnt(19)
  ds_read_b128 v[128:131], v42 offset:40960
  s_waitcnt lgkmcnt(2)
  v_mfma_f32_16x16x32_bf16 v[44:47], v[32:35], v[120:123], v[44:47]
  v_mfma_f32_16x16x32_bf16 v[52:55], v[120:123], v[120:123], v[52:55]
  ds_read_b128 v[132:135], v43 offset:40960
  s_waitcnt lgkmcnt(2)
  v_mfma_f32_16x16x32_bf16 v[44:47], v[32:35], v[124:127], v[44:47]
  v_mfma_f32_16x16x32_bf16 v[52:55], v[124:127], v[124:127], v[52:55]
  s_add_u32 m0, s40, 63360
  s_nop 0
  buffer_load_dwordx4 v92, s[4:7], s42 offen offset:128 lds
  s_add_u32 m0, s40, 64384
  s_nop 0
  buffer_load_dwordx4 v93, s[4:7], s42 offen offset:128 lds
  s_waitcnt vmcnt(19)
  ds_read_b128 v[136:139], v42 offset:43008
  s_waitcnt lgkmcnt(2)
  v_mfma_f32_16x16x32_bf16 v[44:47], v[32:35], v[128:131], v[44:47]
  v_mfma_f32_16x16x32_bf16 v[52:55], v[128:131], v[128:131], v[52:55]
  ds_read_b128 v[140:143], v43 offset:43008
  s_waitcnt lgkmcnt(2)
  v_mfma_f32_16x16x32_bf16 v[44:47], v[32:35], v[132:135], v[44:47]
  v_mfma_f32_16x16x32_bf16 v[52:55], v[132:135], v[132:135], v[52:55]
  s_add_u32 s42, s28, 2560
  s_add_u32 m0, s40, 81920
  s_nop 0
  buffer_load_dwordx4 v92, s[4:7], s42 offen offset:0 lds
  s_add_u32 m0, s40, 82944
  s_nop 0
  buffer_load_dwordx4 v93, s[4:7], s42 offen offset:0 lds
  s_waitcnt vmcnt(19)
  ds_read_b128 v[144:147], v88 offset:0
  s_waitcnt lgkmcnt(2)
  v_mfma_f32_16x16x32_bf16 v[44:47], v[32:35], v[136:139], v[44:47]
  v_mfma_f32_16x16x32_bf16 v[52:55], v[136:139], v[136:139], v[52:55]
  ds_read_b128 v[148:151], v89 offset:0
  s_waitcnt lgkmcnt(2)
  v_mfma_f32_16x16x32_bf16 v[44:47], v[32:35], v[140:143], v[44:47]
  v_mfma_f32_16x16x32_bf16 v[52:55], v[140:143], v[140:143], v[52:55]
  s_add_u32 m0, s40, 83840
  s_nop 0
  buffer_load_dwordx4 v92, s[4:7], s42 offen offset:128 lds
  s_add_u32 m0, s40, 84864
  s_nop 0
  buffer_load_dwordx4 v93, s[4:7], s42 offen offset:128 lds
  s_waitcnt vmcnt(19)
  ds_read_b128 v[152:155], v88 offset:2048
  s_waitcnt lgkmcnt(2)
  v_mfma_f32_16x16x32_bf16 v[44:47], v[32:35], v[144:147], v[44:47]
  v_mfma_f32_16x16x32_bf16 v[52:55], v[144:147], v[144:147], v[52:55]
  ds_read_b128 v[156:159], v89 offset:2048
  s_waitcnt lgkmcnt(2)
  v_mfma_f32_16x16x32_bf16 v[44:47], v[32:35], v[148:151], v[44:47]
  v_mfma_f32_16x16x32_bf16 v[52:55], v[148:151], v[148:151], v[52:55]
  s_add_u32 s42, s29, 2560
  s_add_u32 m0, s40, 102400
  s_nop 0
  buffer_load_dwordx4 v92, s[4:7], s42 offen offset:0 lds
  s_add_u32 m0, s40, 103424
  s_nop 0
  buffer_load_dwordx4 v93, s[4:7], s42 offen offset:0 lds
  s_waitcnt vmcnt(19)
  ds_read_b128 v[160:163], v88 offset:20480
  s_waitcnt lgkmcnt(2)
  v_mfma_f32_16x16x32_bf16 v[44:47], v[32:35], v[152:155], v[44:47]
  v_mfma_f32_16x16x32_bf16 v[52:55], v[152:155], v[152:155], v[52:55]
  ds_read_b128 v[164:167], v89 offset:20480
  s_waitcnt lgkmcnt(2)
  v_mfma_f32_16x16x32_bf16 v[44:47], v[32:35], v[156:159], v[44:47]
  v_mfma_f32_16x16x32_bf16 v[52:55], v[156:159], v[156:159], v[52:55]
  s_add_u32 m0, s40, 104320
  s_nop 0
  buffer_load_dwordx4 v92, s[4:7], s42 offen offset:128 lds
  s_add_u32 m0, s40, 105344
  s_nop 0
  buffer_load_dwordx4 v93, s[4:7], s42 offen offset:128 lds
  s_waitcnt vmcnt(19)
  ds_read_b128 v[168:171], v88 offset:22528
  s_waitcnt lgkmcnt(2)
  v_mfma_f32_16x16x32_bf16 v[44:47], v[32:35], v[160:163], v[44:47]
  v_mfma_f32_16x16x32_bf16 v[52:55], v[160:163], v[160:163], v[52:55]
  ds_read_b128 v[172:175], v89 offset:22528
  s_waitcnt lgkmcnt(2)
  v_mfma_f32_16x16x32_bf16 v[44:47], v[32:35], v[164:167], v[44:47]
  v_mfma_f32_16x16x32_bf16 v[52:55], v[164:167], v[164:167], v[52:55]
  s_add_u32 s42, s30, 2560
  s_add_u32 m0, s40, 122880
  s_nop 0
  buffer_load_dwordx4 v92, s[4:7], s42 offen offset:0 lds
  s_add_u32 m0, s40, 123904
  s_nop 0
  buffer_load_dwordx4 v93, s[4:7], s42 offen offset:0 lds
  s_waitcnt lgkmcnt(1)
  v_mfma_f32_16x16x32_bf16 v[44:47], v[32:35], v[168:171], v[44:47]
  v_mfma_f32_16x16x32_bf16 v[52:55], v[168:171], v[168:171], v[52:55]
  s_waitcnt lgkmcnt(0)
  v_mfma_f32_16x16x32_bf16 v[44:47], v[32:35], v[172:175], v[44:47]
  v_mfma_f32_16x16x32_bf16 v[52:55], v[172:175], v[172:175], v[52:55]
  s_add_u32 m0, s40, 124800
  s_nop 0
  buffer_load_dwordx4 v92, s[4:7], s42 offen offset:128 lds
  s_add_u32 m0, s40, 125824
  s_nop 0
  buffer_load_dwordx4 v93, s[4:7], s42 offen offset:128 lds
  s_nop 0
  v_mul_f32 v60, 0xbacccccd, v44
  v_mul_f32 v61, 0xbacccccd, v45
  v_mul_f32 v62, 0xbacccccd, v46
  v_mul_f32 v63, 0xbacccccd, v47
  s_nop 1
  v_mfma_f32_16x16x32_bf16 v[68:71], v[38:41], v[96:99], v[60:63]
  v_mfma_f32_16x16x32_bf16 v[72:75], v[36:39], v[96:99], v[60:63]
  s_lshl_b32 s73, s2, 2
  s_add_u32 s73, s73, s20
  s_min_u32 s73, s73, 739
  s_mul_i32 s74, s73, 6554
  s_lshr_b32 s74, s74, 16
  s_mul_i32 s75, s74, 10
  s_sub_u32 s75, s73, s75
  s_mov_b32 s96, s74
  v_mfma_f32_16x16x32_bf16 v[76:79], v[38:41], v[100:103], v[60:63]
  v_mfma_f32_16x16x32_bf16 v[80:83], v[36:39], v[100:103], v[60:63]
  v_cvt_pk_bf16_f32 v96, v68, v69
  v_cvt_pk_bf16_f32 v97, v70, v71
  v_cvt_pk_bf16_f32 v98, v72, v73
  v_cvt_pk_bf16_f32 v99, v74, v75
  s_mov_b32 s97, s75
  s_sub_u32 s76, s74, 54
  s_mul_i32 s77, s76, 52
  s_lshr_b32 s77, s77, 8
  s_mul_i32 s78, s77, 5
  s_sub_u32 s78, s76, s78
  s_mul_i32 s77, s77, 160
  s_lshr_b32 s79, s78, 1
  v_mfma_f32_16x16x32_bf16 v[20:23], v[38:41], v[104:107], v[60:63]
  v_mfma_f32_16x16x32_bf16 v[24:27], v[36:39], v[104:107], v[60:63]
  v_cvt_pk_bf16_f32 v100, v76, v77
  v_cvt_pk_bf16_f32 v101, v78, v79
  v_cvt_pk_bf16_f32 v102, v80, v81
  v_cvt_pk_bf16_f32 v103, v82, v83
  s_mul_i32 s79, s79, 80
  s_and_b32 s76, s78, 1
  s_lshl_b32 s76, s76, 3
  s_add_u32 s79, s79, s76
  s_cmp_eq_u32 s78, 4
  s_cselect_b32 s79, 16, s79
  s_cselect_b32 s76, 80, 40
  s_cselect_b32 s78, 40, 20
  v_mfma_f32_16x16x32_bf16 v[68:71], v[38:41], v[108:111], v[60:63]
  v_mfma_f32_16x16x32_bf16 v[72:75], v[36:39], v[108:111], v[60:63]
  v_cvt_pk_bf16_f32 v104, v20, v21
  v_cvt_pk_bf16_f32 v105, v22, v23
  v_cvt_pk_bf16_f32 v106, v24, v25
  v_cvt_pk_bf16_f32 v107, v26, v27
  s_cselect_b32 s73, 20, 4
  s_add_u32 s77, s77, s79
  s_lshl_b32 s79, s74, 5
  s_cmp_lt_u32 s74, 54
  s_cselect_b32 s77, s79, s77
  s_cselect_b32 s76, 16, s76
  s_cselect_b32 s78, 4, s78
  s_cselect_b32 s73, 8, s73
  v_mfma_f32_16x16x32_bf16 v[76:79], v[38:41], v[112:115], v[60:63]
  v_mfma_f32_16x16x32_bf16 v[80:83], v[36:39], v[112:115], v[60:63]
  v_cvt_pk_bf16_f32 v108, v68, v69
  v_cvt_pk_bf16_f32 v109, v70, v71
  v_cvt_pk_bf16_f32 v110, v72, v73
  v_cvt_pk_bf16_f32 v111, v74, v75
  s_cselect_b32 s16, s56, s58
  s_cselect_b32 s17, s57, s59
  s_cselect_b32 s18, 27, 10
  s_mul_i32 s18, s18, 81920
  s_and_b32 s17, s17, 0xffff
  s_cmp_lt_u32 s2, 192
  s_cselect_b32 s18, s18, 0
  s_mov_b32 s19, 0x20000
  v_mfma_f32_16x16x32_bf16 v[20:23], v[38:41], v[116:119], v[60:63]
  v_mfma_f32_16x16x32_bf16 v[24:27], v[36:39], v[116:119], v[60:63]
  v_cvt_pk_bf16_f32 v112, v76, v77
  v_cvt_pk_bf16_f32 v113, v78, v79
  v_cvt_pk_bf16_f32 v114, v80, v81
  v_cvt_pk_bf16_f32 v115, v82, v83
  v_lshrrev_b32 v90, 5, v1
  v_mul_lo_u32 v90, v90, s73
  v_bfe_u32 v91, v1, 3, 2
  v_add_u32 v90, v90, v91
  v_mul_u32_u24 v90, 1280, v90
  v_and_b32 v91, 7, v1
  v_lshl_add_u32 v90, v91, 4, v90
  s_mul_i32 s77, s77, 1280
  v_mfma_f32_16x16x32_bf16 v[68:71], v[38:41], v[120:123], v[60:63]
  v_mfma_f32_16x16x32_bf16 v[72:75], v[36:39], v[120:123], v[60:63]
  v_cvt_pk_bf16_f32 v116, v20, v21
  v_cvt_pk_bf16_f32 v117, v22, v23
  v_cvt_pk_bf16_f32 v118, v24, v25
  v_cvt_pk_bf16_f32 v119, v26, v27
  s_lshl_b32 s75, s75, 7
  s_add_u32 s77, s77, s75
  s_mul_i32 s76, s76, 1280
  s_mul_i32 s78, s78, 1280
  v_mfma_f32_16x16x32_bf16 v[76:79], v[38:41], v[124:127], v[60:63]
  v_mfma_f32_16x16x32_bf16 v[80:83], v[36:39], v[124:127], v[60:63]
  v_cvt_pk_bf16_f32 v120, v68, v69
  v_cvt_pk_bf16_f32 v121, v70, v71
  v_cvt_pk_bf16_f32 v122, v72, v73
  v_cvt_pk_bf16_f32 v123, v74, v75
  s_waitcnt vmcnt(19)
  ds_read_b128 v[176:179], v42 offset:0
  v_mfma_f32_16x16x32_bf16 v[20:23], v[38:41], v[128:131], v[60:63]
  v_mfma_f32_16x16x32_bf16 v[24:27], v[36:39], v[128:131], v[60:63]
  v_cvt_pk_bf16_f32 v124, v76, v77
  v_cvt_pk_bf16_f32 v125, v78, v79
  v_cvt_pk_bf16_f32 v126, v80, v81
  v_cvt_pk_bf16_f32 v127, v82, v83
  ds_read_b128 v[180:183], v43 offset:0
  v_mfma_f32_16x16x32_bf16 v[68:71], v[38:41], v[132:135], v[60:63]
  v_mfma_f32_16x16x32_bf16 v[72:75], v[36:39], v[132:135], v[60:63]
  v_cvt_pk_bf16_f32 v128, v20, v21
  v_cvt_pk_bf16_f32 v129, v22, v23
  v_cvt_pk_bf16_f32 v130, v24, v25
  v_cvt_pk_bf16_f32 v131, v26, v27
  s_waitcnt vmcnt(16)
  ds_read_b128 v[184:187], v42 offset:2048
  v_mfma_f32_16x16x32_bf16 v[76:79], v[38:41], v[136:139], v[60:63]
  v_mfma_f32_16x16x32_bf16 v[80:83], v[36:39], v[136:139], v[60:63]
  s_waitcnt lgkmcnt(2)
  v_mfma_f32_16x16x32_bf16 v[48:51], v[32:35], v[176:179], 0
  v_mfma_f32_16x16x32_bf16 v[56:59], v[176:179], v[176:179], 0
  v_cvt_pk_bf16_f32 v132, v68, v69
  v_cvt_pk_bf16_f32 v133, v70, v71
  v_cvt_pk_bf16_f32 v134, v72, v73
  v_cvt_pk_bf16_f32 v135, v74, v75
  ds_read_b128 v[188:191], v43 offset:2048
  v_mfma_f32_16x16x32_bf16 v[20:23], v[38:41], v[140:143], v[60:63]
  v_mfma_f32_16x16x32_bf16 v[24:27], v[36:39], v[140:143], v[60:63]
  s_waitcnt lgkmcnt(2)
  v_mfma_f32_16x16x32_bf16 v[48:51], v[32:35], v[180:183], v[48:51]
  v_mfma_f32_16x16x32_bf16 v[56:59], v[180:183], v[180:183], v[56:59]
  v_cvt_pk_bf16_f32 v136, v76, v77
  v_cvt_pk_bf16_f32 v137, v78, v79
  v_cvt_pk_bf16_f32 v138, v80, v81
  v_cvt_pk_bf16_f32 v139, v82, v83
  s_waitcnt vmcnt(14)
  ds_read_b128 v[192:195], v42 offset:20480
  v_mfma_f32_16x16x32_bf16 v[68:71], v[38:41], v[144:147], v[60:63]
  v_mfma_f32_16x16x32_bf16 v[72:75], v[36:39], v[144:147], v[60:63]
  s_waitcnt lgkmcnt(2)
  v_mfma_f32_16x16x32_bf16 v[48:51], v[32:35], v[184:187], v[48:51]
  v_mfma_f32_16x16x32_bf16 v[56:59], v[184:187], v[184:187], v[56:59]
  v_cvt_pk_bf16_f32 v140, v20, v21
  v_cvt_pk_bf16_f32 v141, v22, v23
  v_cvt_pk_bf16_f32 v142, v24, v25
  v_cvt_pk_bf16_f32 v143, v26, v27
  s_add_u32 s41, s31, s36
  s_add_u32 m0, s40, 0
  s_nop 0
  buffer_load_dwordx4 v2, s[8:11], s41 offen offset:0 lds
  ds_read_b128 v[196:199], v43 offset:20480
  v_mfma_f32_16x16x32_bf16 v[76:79], v[38:41], v[148:151], v[60:63]
  v_mfma_f32_16x16x32_bf16 v[80:83], v[36:39], v[148:151], v[60:63]
  s_waitcnt lgkmcnt(2)
  v_mfma_f32_16x16x32_bf16 v[48:51], v[32:35], v[188:191], v[48:51]
  v_mfma_f32_16x16x32_bf16 v[56:59], v[188:191], v[188:191], v[56:59]
  v_cvt_pk_bf16_f32 v144, v68, v69
  v_cvt_pk_bf16_f32 v145, v70, v71
  v_cvt_pk_bf16_f32 v146, v72, v73
  v_cvt_pk_bf16_f32 v147, v74, v75
  s_add_u32 m0, s40, 0
  s_nop 0
  buffer_load_dwordx4 v3, s[8:11], s41 offen offset:1024 lds
  s_waitcnt vmcnt(14)
  ds_read_b128 v[200:203], v42 offset:22528
  v_mfma_f32_16x16x32_bf16 v[20:23], v[38:41], v[152:155], v[60:63]
  v_mfma_f32_16x16x32_bf16 v[24:27], v[36:39], v[152:155], v[60:63]
  s_waitcnt lgkmcnt(2)
  v_mfma_f32_16x16x32_bf16 v[48:51], v[32:35], v[192:195], v[48:51]
  v_mfma_f32_16x16x32_bf16 v[56:59], v[192:195], v[192:195], v[56:59]
  v_cvt_pk_bf16_f32 v148, v76, v77
  v_cvt_pk_bf16_f32 v149, v78, v79
  v_cvt_pk_bf16_f32 v150, v80, v81
  v_cvt_pk_bf16_f32 v151, v82, v83
  s_add_u32 m0, s40, 0
  s_nop 0
  buffer_load_dwordx4 v4, s[8:11], s41 offen offset:2048 lds
  ds_read_b128 v[204:207], v43 offset:22528
  v_mfma_f32_16x16x32_bf16 v[68:71], v[38:41], v[156:159], v[60:63]
  v_mfma_f32_16x16x32_bf16 v[72:75], v[36:39], v[156:159], v[60:63]
  s_waitcnt lgkmcnt(2)
  v_mfma_f32_16x16x32_bf16 v[48:51], v[32:35], v[196:199], v[48:51]
  v_mfma_f32_16x16x32_bf16 v[56:59], v[196:199], v[196:199], v[56:59]
  v_cvt_pk_bf16_f32 v152, v20, v21
  v_cvt_pk_bf16_f32 v153, v22, v23
  v_cvt_pk_bf16_f32 v154, v24, v25
  v_cvt_pk_bf16_f32 v155, v26, v27
  s_add_u32 m0, s40, 0
  s_nop 0
  buffer_load_dwordx4 v5, s[8:11], s41 offen offset:3072 lds
  s_waitcnt vmcnt(14)
  ds_read_b128 v[208:211], v42 offset:40960
  v_mfma_f32_16x16x32_bf16 v[76:79], v[38:41], v[160:163], v[60:63]
  v_mfma_f32_16x16x32_bf16 v[80:83], v[36:39], v[160:163], v[60:63]
  s_waitcnt lgkmcnt(2)
  v_mfma_f32_16x16x32_bf16 v[48:51], v[32:35], v[200:203], v[48:51]
  v_mfma_f32_16x16x32_bf16 v[56:59], v[200:203], v[200:203], v[56:59]
  v_cvt_pk_bf16_f32 v156, v68, v69
  v_cvt_pk_bf16_f32 v157, v70, v71
  v_cvt_pk_bf16_f32 v158, v72, v73
  v_cvt_pk_bf16_f32 v159, v74, v75
  s_add_u32 m0, s40, 4096
  s_nop 0
  buffer_load_dwordx4 v6, s[8:11], s41 offen offset:0 lds
  ds_read_b128 v[212:215], v43 offset:40960
  v_mfma_f32_16x16x32_bf16 v[20:23], v[38:41], v[164:167], v[60:63]
  v_mfma_f32_16x16x32_bf16 v[24:27], v[36:39], v[164:167], v[60:63]
  s_waitcnt lgkmcnt(2)
  v_mfma_f32_16x16x32_bf16 v[48:51], v[32:35], v[204:207], v[48:51]
  v_mfma_f32_16x16x32_bf16 v[56:59], v[204:207], v[204:207], v[56:59]
  v_cvt_pk_bf16_f32 v160, v76, v77
  v_cvt_pk_bf16_f32 v161, v78, v79
  v_cvt_pk_bf16_f32 v162, v80, v81
  v_cvt_pk_bf16_f32 v163, v82, v83
  s_add_u32 s41, s32, s36
  s_add_u32 m0, s40, 20480
  s_nop 0
  buffer_load_dwordx4 v2, s[8:11], s41 offen offset:0 lds
  s_waitcnt vmcnt(14)
  ds_read_b128 v[216:219], v42 offset:43008
  v_mfma_f32_16x16x32_bf16 v[68:71], v[38:41], v[168:171], v[60:63]
  v_mfma_f32_16x16x32_bf16 v[72:75], v[36:39], v[168:171], v[60:63]
  s_waitcnt lgkmcnt(2)
  v_mfma_f32_16x16x32_bf16 v[48:51], v[32:35], v[208:211], v[48:51]
  v_mfma_f32_16x16x32_bf16 v[56:59], v[208:211], v[208:211], v[56:59]
  v_cvt_pk_bf16_f32 v164, v20, v21
  v_cvt_pk_bf16_f32 v165, v22, v23
  v_cvt_pk_bf16_f32 v166, v24, v25
  v_cvt_pk_bf16_f32 v167, v26, v27
  s_add_u32 m0, s40, 20480
  s_nop 0
  buffer_load_dwordx4 v3, s[8:11], s41 offen offset:1024 lds
  ds_read_b128 v[220:223], v43 offset:43008
  v_mfma_f32_16x16x32_bf16 v[76:79], v[38:41], v[172:175], v[60:63]
  v_mfma_f32_16x16x32_bf16 v[80:83], v[36:39], v[172:175], v[60:63]
  s_waitcnt lgkmcnt(2)
  v_mfma_f32_16x16x32_bf16 v[48:51], v[32:35], v[212:215], v[48:51]
  v_mfma_f32_16x16x32_bf16 v[56:59], v[212:215], v[212:215], v[56:59]
  v_cvt_pk_bf16_f32 v168, v68, v69
  v_cvt_pk_bf16_f32 v169, v70, v71
  v_cvt_pk_bf16_f32 v170, v72, v73
  v_cvt_pk_bf16_f32 v171, v74, v75
  s_add_u32 m0, s40, 20480
  s_nop 0
  buffer_load_dwordx4 v4, s[8:11], s41 offen offset:2048 lds
  s_waitcnt vmcnt(14)
  ds_read_b128 v[224:227], v88 offset:0
  s_waitcnt lgkmcnt(2)
  v_mfma_f32_16x16x32_bf16 v[48:51], v[32:35], v[216:219], v[48:51]
  v_mfma_f32_16x16x32_bf16 v[56:59], v[216:219], v[216:219], v[56:59]
  v_cvt_pk_bf16_f32 v172, v76, v77
  v_cvt_pk_bf16_f32 v173, v78, v79
  v_cvt_pk_bf16_f32 v174, v80, v81
  v_cvt_pk_bf16_f32 v175, v82, v83
  s_add_u32 m0, s40, 20480
  s_nop 0
  buffer_load_dwordx4 v5, s[8:11], s41 offen offset:3072 lds
  ds_read_b128 v[228:231], v89 offset:0
  s_waitcnt lgkmcnt(2)
  v_mfma_f32_16x16x32_bf16 v[48:51], v[32:35], v[220:223], v[48:51]
  v_mfma_f32_16x16x32_bf16 v[56:59], v[220:223], v[220:223], v[56:59]
  s_add_u32 m0, s40, 24576
  s_nop 0
  buffer_load_dwordx4 v6, s[8:11], s41 offen offset:0 lds
  s_waitcnt vmcnt(14)
  ds_read_b128 v[232:235], v88 offset:2048
  s_waitcnt lgkmcnt(2)
  v_mfma_f32_16x16x32_bf16 v[48:51], v[32:35], v[224:227], v[48:51]
  v_mfma_f32_16x16x32_bf16 v[56:59], v[224:227], v[224:227], v[56:59]
  s_add_u32 s41, s33, s36
  s_add_u32 m0, s40, 40960
  s_nop 0
  buffer_load_dwordx4 v2, s[8:11], s41 offen offset:0 lds
  ds_read_b128 v[236:239], v89 offset:2048
  s_waitcnt lgkmcnt(2)
  v_mfma_f32_16x16x32_bf16 v[48:51], v[32:35], v[228:231], v[48:51]
  v_mfma_f32_16x16x32_bf16 v[56:59], v[228:231], v[228:231], v[56:59]
  s_add_u32 m0, s40, 40960
  s_nop 0
  buffer_load_dwordx4 v3, s[8:11], s41 offen offset:1024 lds
  s_waitcnt vmcnt(14)
  ds_read_b128 v[240:243], v88 offset:20480
  s_waitcnt lgkmcnt(2)
  v_mfma_f32_16x16x32_bf16 v[48:51], v[32:35], v[232:235], v[48:51]
  v_mfma_f32_16x16x32_bf16 v[56:59], v[232:235], v[232:235], v[56:59]
  s_add_u32 m0, s40, 40960
  s_nop 0
  buffer_load_dwordx4 v4, s[8:11], s41 offen offset:2048 lds
  ds_read_b128 v[244:247], v89 offset:20480
  s_waitcnt lgkmcnt(2)
  v_mfma_f32_16x16x32_bf16 v[48:51], v[32:35], v[236:239], v[48:51]
  v_mfma_f32_16x16x32_bf16 v[56:59], v[236:239], v[236:239], v[56:59]
  s_add_u32 m0, s40, 40960
  s_nop 0
  buffer_load_dwordx4 v5, s[8:11], s41 offen offset:3072 lds
  s_waitcnt vmcnt(14)
  ds_read_b128 v[248:251], v88 offset:22528
  s_waitcnt lgkmcnt(2)
  v_mfma_f32_16x16x32_bf16 v[48:51], v[32:35], v[240:243], v[48:51]
  v_mfma_f32_16x16x32_bf16 v[56:59], v[240:243], v[240:243], v[56:59]
  s_add_u32 m0, s40, 45056
  s_nop 0
  buffer_load_dwordx4 v6, s[8:11], s41 offen offset:0 lds
  ds_read_b128 v[252:255], v89 offset:22528
  s_waitcnt lgkmcnt(2)
  v_mfma_f32_16x16x32_bf16 v[48:51], v[32:35], v[244:247], v[48:51]
  v_mfma_f32_16x16x32_bf16 v[56:59], v[244:247], v[244:247], v[56:59]
  s_add_u32 s41, s34, s36
  s_add_u32 m0, s40, 61440
  s_nop 0
  buffer_load_dwordx4 v2, s[8:11], s41 offen offset:0 lds
  s_waitcnt lgkmcnt(1)
  v_mfma_f32_16x16x32_bf16 v[48:51], v[32:35], v[248:251], v[48:51]
  v_mfma_f32_16x16x32_bf16 v[56:59], v[248:251], v[248:251], v[56:59]
  s_add_u32 m0, s40, 61440
  s_nop 0
  buffer_load_dwordx4 v3, s[8:11], s41 offen offset:1024 lds
  s_waitcnt lgkmcnt(0)
  v_mfma_f32_16x16x32_bf16 v[48:51], v[32:35], v[252:255], v[48:51]
  v_mfma_f32_16x16x32_bf16 v[56:59], v[252:255], v[252:255], v[56:59]
  s_add_u32 m0, s40, 61440
  s_nop 0
  buffer_load_dwordx4 v4, s[8:11], s41 offen offset:2048 lds
  s_nop 3
  v_mul_f32 v64, 0xbacccccd, v48
  v_mul_f32 v65, 0xbacccccd, v49
  v_mul_f32 v66, 0xbacccccd, v50
  v_mul_f32 v67, 0xbacccccd, v51
  s_nop 1
  v_mfma_f32_16x16x32_bf16 v[68:71], v[38:41], v[176:179], v[64:67]
  v_mfma_f32_16x16x32_bf16 v[72:75], v[36:39], v[176:179], v[64:67]
  s_add_u32 m0, s40, 61440
  s_nop 0
  buffer_load_dwordx4 v5, s[8:11], s41 offen offset:3072 lds
  v_mfma_f32_16x16x32_bf16 v[76:79], v[38:41], v[180:183], v[64:67]
  v_mfma_f32_16x16x32_bf16 v[80:83], v[36:39], v[180:183], v[64:67]
  s_nop 1
  v_cvt_pk_bf16_f32 v176, v68, v69
  v_cvt_pk_bf16_f32 v177, v70, v71
  v_cvt_pk_bf16_f32 v178, v72, v73
  v_cvt_pk_bf16_f32 v179, v74, v75
  v_mfma_f32_16x16x32_bf16 v[20:23], v[38:41], v[184:187], v[64:67]
  v_mfma_f32_16x16x32_bf16 v[24:27], v[36:39], v[184:187], v[64:67]
  s_add_u32 m0, s40, 65536
  s_nop 0
  buffer_load_dwordx4 v6, s[8:11], s41 offen offset:0 lds
  v_cvt_pk_bf16_f32 v180, v76, v77
  v_cvt_pk_bf16_f32 v181, v78, v79
  v_cvt_pk_bf16_f32 v182, v80, v81
  v_cvt_pk_bf16_f32 v183, v82, v83
  v_and_b32 v44, 1, v1
  v_cmp_eq_u32 vcc, 1, v44
  s_nop 1
  v_cndmask_b32 v52, v52, v53, vcc
  v_mfma_f32_16x16x32_bf16 v[68:71], v[38:41], v[188:191], v[64:67]
  v_mfma_f32_16x16x32_bf16 v[72:75], v[36:39], v[188:191], v[64:67]
  v_cvt_pk_bf16_f32 v184, v20, v21
  v_cvt_pk_bf16_f32 v185, v22, v23
  v_cvt_pk_bf16_f32 v186, v24, v25
  v_cvt_pk_bf16_f32 v187, v26, v27
  v_cndmask_b32 v54, v54, v55, vcc
  v_and_b32 v44, 2, v1
  v_cmp_eq_u32 vcc, 2, v44
  v_mfma_f32_16x16x32_bf16 v[76:79], v[38:41], v[192:195], v[64:67]
  v_mfma_f32_16x16x32_bf16 v[80:83], v[36:39], v[192:195], v[64:67]
  s_add_u32 s41, s35, s36
  s_add_u32 m0, s40, 81920
  s_nop 0
  buffer_load_dwordx4 v2, s[8:11], s41 offen offset:0 lds
  v_cvt_pk_bf16_f32 v188, v68, v69
  v_cvt_pk_bf16_f32 v189, v70, v71
  v_cvt_pk_bf16_f32 v190, v72, v73
  v_cvt_pk_bf16_f32 v191, v74, v75
  v_cndmask_b32 v52, v52, v54, vcc
  v_and_b32 v44, 15, v1
  v_lshrrev_b32 v45, 2, v44
  v_mfma_f32_16x16x32_bf16 v[20:23], v[38:41], v[196:199], v[64:67]
  v_mfma_f32_16x16x32_bf16 v[24:27], v[36:39], v[196:199], v[64:67]
  v_cvt_pk_bf16_f32 v192, v76, v77
  v_cvt_pk_bf16_f32 v193, v78, v79
  v_cvt_pk_bf16_f32 v194, v80, v81
  v_cvt_pk_bf16_f32 v195, v82, v83
  v_lshl_add_u32 v44, v45, 4, v44
  v_lshlrev_b32 v44, 2, v44
  ds_bpermute_b32 v53, v44, v52
  v_mfma_f32_16x16x32_bf16 v[68:71], v[38:41], v[200:203], v[64:67]
  v_mfma_f32_16x16x32_bf16 v[72:75], v[36:39], v[200:203], v[64:67]
  s_add_u32 m0, s40, 81920
  s_nop 0
  buffer_load_dwordx4 v3, s[8:11], s41 offen offset:1024 lds
  v_cvt_pk_bf16_f32 v196, v20, v21
  v_cvt_pk_bf16_f32 v197, v22, v23
  v_cvt_pk_bf16_f32 v198, v24, v25
  v_cvt_pk_bf16_f32 v199, v26, v27
  v_mul_f32 v45, v60, v60
  v_and_b32 v48, 1, v1
  v_cmp_eq_u32 vcc, 1, v48
  v_mfma_f32_16x16x32_bf16 v[76:79], v[38:41], v[204:207], v[64:67]
  v_mfma_f32_16x16x32_bf16 v[80:83], v[36:39], v[204:207], v[64:67]
  v_cvt_pk_bf16_f32 v200, v68, v69
  v_cvt_pk_bf16_f32 v201, v70, v71
  v_cvt_pk_bf16_f32 v202, v72, v73
  v_cvt_pk_bf16_f32 v203, v74, v75
  v_cndmask_b32 v56, v56, v57, vcc
  v_cndmask_b32 v58, v58, v59, vcc
  v_and_b32 v48, 2, v1
  v_mfma_f32_16x16x32_bf16 v[20:23], v[38:41], v[208:211], v[64:67]
  v_mfma_f32_16x16x32_bf16 v[24:27], v[36:39], v[208:211], v[64:67]
  s_add_u32 m0, s40, 81920
  s_nop 0
  buffer_load_dwordx4 v4, s[8:11], s41 offen offset:2048 lds
  v_cvt_pk_bf16_f32 v204, v76, v77
  v_cvt_pk_bf16_f32 v205, v78, v79
  v_cvt_pk_bf16_f32 v206, v80, v81
  v_cvt_pk_bf16_f32 v207, v82, v83
  v_cmp_eq_u32 vcc, 2, v48
  s_nop 1
  v_cndmask_b32 v56, v56, v58, vcc
  v_and_b32 v48, 15, v1
  v_mfma_f32_16x16x32_bf16 v[68:71], v[38:41], v[212:215], v[64:67]
  v_mfma_f32_16x16x32_bf16 v[72:75], v[36:39], v[212:215], v[64:67]
  v_cvt_pk_bf16_f32 v208, v20, v21
  v_cvt_pk_bf16_f32 v209, v22, v23
  v_cvt_pk_bf16_f32 v210, v24, v25
  v_cvt_pk_bf16_f32 v211, v26, v27
  v_lshrrev_b32 v49, 2, v48
  v_lshl_add_u32 v48, v49, 4, v48
  v_lshlrev_b32 v48, 2, v48
  v_mfma_f32_16x16x32_bf16 v[76:79], v[38:41], v[216:219], v[64:67]
  v_mfma_f32_16x16x32_bf16 v[80:83], v[36:39], v[216:219], v[64:67]
  s_add_u32 m0, s40, 81920
  s_nop 0
  buffer_load_dwordx4 v5, s[8:11], s41 offen offset:3072 lds
  v_cvt_pk_bf16_f32 v212, v68, v69
  v_cvt_pk_bf16_f32 v213, v70, v71
  v_cvt_pk_bf16_f32 v214, v72, v73
  v_cvt_pk_bf16_f32 v215, v74, v75
  ds_bpermute_b32 v57, v48, v56
  v_mul_f32 v49, v64, v64
  s_waitcnt lgkmcnt(1)
  v_mul_f32 v53, 0x3acccccd, v53
  v_mfma_f32_16x16x32_bf16 v[20:23], v[38:41], v[220:223], v[64:67]
  v_mfma_f32_16x16x32_bf16 v[24:27], v[36:39], v[220:223], v[64:67]
  s_lshl_b32 s73, s20, 12
  s_add_u32 m0, s73, 144384
  s_mov_b32 s79, s77
  buffer_load_dwordx4 v90, s[16:19], s79 offen lds
  v_cvt_pk_bf16_f32 v216, v76, v77
  v_cvt_pk_bf16_f32 v217, v78, v79
  v_cvt_pk_bf16_f32 v218, v80, v81
  v_cvt_pk_bf16_f32 v219, v82, v83
  v_sub_f32 v53, v53, v45
  v_max_f32 v53, 0, v53
  v_add_f32 v44, 0x3727c5ac, v53
  v_mfma_f32_16x16x32_bf16 v[68:71], v[38:41], v[224:227], v[64:67]
  v_mfma_f32_16x16x32_bf16 v[72:75], v[36:39], v[224:227], v[64:67]
  s_add_u32 m0, s40, 86016
  s_nop 0
  buffer_load_dwordx4 v6, s[8:11], s41 offen offset:0 lds
  v_cvt_pk_bf16_f32 v220, v20, v21
  v_cvt_pk_bf16_f32 v221, v22, v23
  v_cvt_pk_bf16_f32 v222, v24, v25
  v_cvt_pk_bf16_f32 v223, v26, v27
  v_rsq_f32 v94, v44
  s_waitcnt lgkmcnt(0)
  v_mul_f32 v57, 0x3acccccd, v57
  v_sub_f32 v57, v57, v49
  v_mfma_f32_16x16x32_bf16 v[76:79], v[38:41], v[228:231], v[64:67]
  v_mfma_f32_16x16x32_bf16 v[80:83], v[36:39], v[228:231], v[64:67]
  s_lshl_b32 s73, s20, 12
  s_add_u32 m0, s73, 145408
  s_add_u32 s79, s77, s78
  buffer_load_dwordx4 v90, s[16:19], s79 offen lds
  v_cvt_pk_bf16_f32 v224, v68, v69
  v_cvt_pk_bf16_f32 v225, v70, v71
  v_cvt_pk_bf16_f32 v226, v72, v73
  v_cvt_pk_bf16_f32 v227, v74, v75
  v_max_f32 v57, 0, v57
  v_add_f32 v48, 0x3727c5ac, v57
  v_rsq_f32 v95, v48
  v_mfma_f32_16x16x32_bf16 v[20:23], v[38:41], v[232:235], v[64:67]
  v_mfma_f32_16x16x32_bf16 v[24:27], v[36:39], v[232:235], v[64:67]
  s_add_u32 s41, s31, s37
  s_add_u32 m0, s40, 102400
  s_nop 0
  buffer_load_dwordx4 v2, s[8:11], s41 offen offset:0 lds
  v_cvt_pk_bf16_f32 v228, v76, v77
  v_cvt_pk_bf16_f32 v229, v78, v79
  v_cvt_pk_bf16_f32 v230, v80, v81
  v_cvt_pk_bf16_f32 v231, v82, v83
  v_mfma_f32_16x16x32_bf16 v[68:71], v[38:41], v[236:239], v[64:67]
  v_mfma_f32_16x16x32_bf16 v[72:75], v[36:39], v[236:239], v[64:67]
  s_lshl_b32 s73, s20, 12
  s_add_u32 m0, s73, 146432
  s_add_u32 s79, s77, s76
  buffer_load_dwordx4 v90, s[16:19], s79 offen lds
  v_cvt_pk_bf16_f32 v232, v20, v21
  v_cvt_pk_bf16_f32 v233, v22, v23
  v_cvt_pk_bf16_f32 v234, v24, v25
  v_cvt_pk_bf16_f32 v235, v26, v27
  v_mfma_f32_16x16x32_bf16 v[76:79], v[38:41], v[240:243], v[64:67]
  v_mfma_f32_16x16x32_bf16 v[80:83], v[36:39], v[240:243], v[64:67]
  s_add_u32 m0, s40, 102400
  s_nop 0
  buffer_load_dwordx4 v3, s[8:11], s41 offen offset:1024 lds
  v_cvt_pk_bf16_f32 v236, v68, v69
  v_cvt_pk_bf16_f32 v237, v70, v71
  v_cvt_pk_bf16_f32 v238, v72, v73
  v_cvt_pk_bf16_f32 v239, v74, v75
  v_mfma_f32_16x16x32_bf16 v[20:23], v[38:41], v[244:247], v[64:67]
  v_mfma_f32_16x16x32_bf16 v[24:27], v[36:39], v[244:247], v[64:67]
  s_lshl_b32 s73, s20, 12
  s_add_u32 m0, s73, 147456
  s_add_u32 s79, s79, s78
  buffer_load_dwordx4 v90, s[16:19], s79 offen lds
  s_add_u32 s56, s70, 13631488
  s_addc_u32 s57, s71, 0
  s_and_b32 s57, s57, 0xffff
  s_mov_b32 s58, 37888
  s_mov_b32 s59, 0x20000
  v_cvt_pk_bf16_f32 v240, v76, v77
  v_cvt_pk_bf16_f32 v241, v78, v79
  v_cvt_pk_bf16_f32 v242, v80, v81
  v_cvt_pk_bf16_f32 v243, v82, v83
  v_mfma_f32_16x16x32_bf16 v[68:71], v[38:41], v[248:251], v[64:67]
  v_mfma_f32_16x16x32_bf16 v[72:75], v[36:39], v[248:251], v[64:67]
  s_add_u32 m0, s40, 102400
  s_nop 0
  buffer_load_dwordx4 v4, s[8:11], s41 offen offset:2048 lds
  v_cvt_pk_bf16_f32 v244, v20, v21
  v_cvt_pk_bf16_f32 v245, v22, v23
  v_cvt_pk_bf16_f32 v246, v24, v25
  v_cvt_pk_bf16_f32 v247, v26, v27
  v_mfma_f32_16x16x32_bf16 v[76:79], v[38:41], v[252:255], v[64:67]
  v_mfma_f32_16x16x32_bf16 v[80:83], v[36:39], v[252:255], v[64:67]
  v_cvt_pk_bf16_f32 v248, v68, v69
  v_cvt_pk_bf16_f32 v249, v70, v71
  v_cvt_pk_bf16_f32 v250, v72, v73
  v_cvt_pk_bf16_f32 v251, v74, v75
  s_add_u32 m0, s40, 102400
  s_nop 0
  buffer_load_dwordx4 v5, s[8:11], s41 offen offset:3072 lds
  v_cvt_pk_bf16_f32 v252, v76, v77
  v_cvt_pk_bf16_f32 v253, v78, v79
  v_cvt_pk_bf16_f32 v254, v80, v81
  v_cvt_pk_bf16_f32 v255, v82, v83
  ds_write_b64 v11, v[94:95] offset:32
  v_add_u32 v92, 122880, v7
  s_waitcnt vmcnt(28)
  s_waitcnt lgkmcnt(0)
  s_barrier
  ds_read_b64_tr_b16 a[0:1], v7 offset:0
  ds_read_b64_tr_b16 a[2:3], v7 offset:1280
  ds_read_b64_tr_b16 a[4:5], v7 offset:8
  ds_read_b64_tr_b16 a[6:7], v7 offset:1288
  ds_read_b64_tr_b16 a[8:9], v7 offset:16
  ds_read_b64_tr_b16 a[10:11], v7 offset:1296
  ds_read_b64_tr_b16 a[12:13], v7 offset:24
  ds_read_b64_tr_b16 a[14:15], v7 offset:1304
  ds_read_b64_tr_b16 a[16:17], v7 offset:32
  ds_read_b64_tr_b16 a[18:19], v7 offset:1312
  s_waitcnt lgkmcnt(6)
  v_mfma_f32_16x16x32_bf16 v[32:35], a[0:3], v[96:99], 0
  s_add_u32 m0, s40, 106496
  s_nop 0
  buffer_load_dwordx4 v6, s[8:11], s41 offen offset:0 lds
  ds_read_b64_tr_b16 a[20:21], v7 offset:5120
  v_mfma_f32_16x16x32_bf16 v[36:39], a[0:3], v[176:179], 0
  ds_read_b64_tr_b16 a[22:23], v7 offset:6400
  v_mfma_f32_16x16x32_bf16 v[40:43], a[4:7], v[96:99], 0
  ds_read_b64_tr_b16 a[0:1], v7 offset:5128
  v_mfma_f32_16x16x32_bf16 v[44:47], a[4:7], v[176:179], 0
  ds_read_b64_tr_b16 a[2:3], v7 offset:6408
  s_waitcnt lgkmcnt(6)
  v_mfma_f32_16x16x32_bf16 v[48:51], a[8:11], v[96:99], 0
  ds_read_b64_tr_b16 a[4:5], v7 offset:5136
  v_mfma_f32_16x16x32_bf16 v[52:55], a[8:11], v[176:179], 0
  ds_read_b64_tr_b16 a[6:7], v7 offset:6416
  v_mfma_f32_16x16x32_bf16 v[56:59], a[12:15], v[96:99], 0
  ds_read_b64_tr_b16 a[8:9], v7 offset:5144
  v_mfma_f32_16x16x32_bf16 v[60:63], a[12:15], v[176:179], 0
  ds_read_b64_tr_b16 a[10:11], v7 offset:6424
  s_waitcnt lgkmcnt(6)
  v_mfma_f32_16x16x32_bf16 v[64:67], a[16:19], v[96:99], 0
  ds_read_b64_tr_b16 a[12:13], v7 offset:5152
  v_mfma_f32_16x16x32_bf16 v[68:71], a[16:19], v[176:179], 0
  ds_read_b64_tr_b16 a[14:15], v7 offset:6432
  v_mfma_f32_16x16x32_bf16 v[32:35], a[20:23], v[100:103], v[32:35]
  ds_read_b64_tr_b16 a[16:17], v7 offset:10240
  v_mfma_f32_16x16x32_bf16 v[36:39], a[20:23], v[180:183], v[36:39]
  ds_read_b64_tr_b16 a[18:19], v7 offset:11520
  s_waitcnt lgkmcnt(6)
  v_mfma_f32_16x16x32_bf16 v[40:43], a[0:3], v[100:103], v[40:43]
  ds_read_b64_tr_b16 a[20:21], v7 offset:10248
  v_mfma_f32_16x16x32_bf16 v[44:47], a[0:3], v[180:183], v[44:47]
  ds_read_b64_tr_b16 a[22:23], v7 offset:11528
  v_mfma_f32_16x16x32_bf16 v[48:51], a[4:7], v[100:103], v[48:51]
  ds_read_b64_tr_b16 a[0:1], v7 offset:10256
  v_mfma_f32_16x16x32_bf16 v[52:55], a[4:7], v[180:183], v[52:55]
  ds_read_b64_tr_b16 a[2:3], v7 offset:11536
  s_waitcnt vmcnt(24)
  s_barrier
  s_waitcnt lgkmcnt(6)
  v_mfma_f32_16x16x32_bf16 v[56:59], a[8:11], v[100:103], v[56:59]
  ds_read_b64_tr_b16 a[4:5], v7 offset:10264
  v_mfma_f32_16x16x32_bf16 v[60:63], a[8:11], v[180:183], v[60:63]
  ds_read_b64_tr_b16 a[6:7], v7 offset:11544
  v_mfma_f32_16x16x32_bf16 v[64:67], a[12:15], v[100:103], v[64:67]
  s_add_u32 s41, s32, s37
  s_add_u32 m0, s40, 122880
  s_nop 0
  buffer_load_dwordx4 v2, s[8:11], s41 offen offset:0 lds
  ds_read_b64_tr_b16 a[8:9], v7 offset:10272
  v_mfma_f32_16x16x32_bf16 v[68:71], a[12:15], v[180:183], v[68:71]
  ds_read_b64_tr_b16 a[10:11], v7 offset:11552
  s_waitcnt lgkmcnt(6)
  v_mfma_f32_16x16x32_bf16 v[32:35], a[16:19], v[104:107], v[32:35]
  ds_read_b64_tr_b16 a[12:13], v7 offset:15360
  v_mfma_f32_16x16x32_bf16 v[36:39], a[16:19], v[184:187], v[36:39]
  ds_read_b64_tr_b16 a[14:15], v7 offset:16640
  v_mfma_f32_16x16x32_bf16 v[40:43], a[20:23], v[104:107], v[40:43]
  ds_read_b64_tr_b16 a[16:17], v7 offset:15368
  v_mfma_f32_16x16x32_bf16 v[44:47], a[20:23], v[184:187], v[44:47]
  ds_read_b64_tr_b16 a[18:19], v7 offset:16648
  s_waitcnt lgkmcnt(6)
  v_mfma_f32_16x16x32_bf16 v[48:51], a[0:3], v[104:107], v[48:51]
  s_add_u32 m0, s40, 122880
  s_nop 0
  buffer_load_dwordx4 v3, s[8:11], s41 offen offset:1024 lds
  ds_read_b64_tr_b16 a[20:21], v7 offset:15376
  v_mfma_f32_16x16x32_bf16 v[52:55], a[0:3], v[184:187], v[52:55]
  ds_read_b64_tr_b16 a[22:23], v7 offset:16656
  v_mfma_f32_16x16x32_bf16 v[56:59], a[4:7], v[104:107], v[56:59]
  ds_read_b64_tr_b16 a[0:1], v7 offset:15384
  v_mfma_f32_16x16x32_bf16 v[60:63], a[4:7], v[184:187], v[60:63]
  ds_read_b64_tr_b16 a[2:3], v7 offset:16664
  s_waitcnt lgkmcnt(6)
  v_mfma_f32_16x16x32_bf16 v[64:67], a[8:11], v[104:107], v[64:67]
  ds_read_b64_tr_b16 a[4:5], v7 offset:15392
  v_mfma_f32_16x16x32_bf16 v[68:71], a[8:11], v[184:187], v[68:71]
  ds_read_b64_tr_b16 a[6:7], v7 offset:16672
  v_mfma_f32_16x16x32_bf16 v[32:35], a[12:15], v[108:111], v[32:35]
  s_add_u32 m0, s40, 122880
  s_nop 0
  buffer_load_dwordx4 v4, s[8:11], s41 offen offset:2048 lds
  ds_read_b64_tr_b16 a[8:9], v7 offset:20480
  v_mfma_f32_16x16x32_bf16 v[36:39], a[12:15], v[188:191], v[36:39]
  ds_read_b64_tr_b16 a[10:11], v7 offset:21760
  s_waitcnt lgkmcnt(6)
  v_mfma_f32_16x16x32_bf16 v[40:43], a[16:19], v[108:111], v[40:43]
  ds_read_b64_tr_b16 a[12:13], v7 offset:20488
  v_mfma_f32_16x16x32_bf16 v[44:47], a[16:19], v[188:191], v[44:47]
  ds_read_b64_tr_b16 a[14:15], v7 offset:21768
  v_mfma_f32_16x16x32_bf16 v[48:51], a[20:23], v[108:111], v[48:51]
  ds_read_b64_tr_b16 a[16:17], v7 offset:20496
  v_mfma_f32_16x16x32_bf16 v[52:55], a[20:23], v[188:191], v[52:55]
  ds_read_b64_tr_b16 a[18:19], v7 offset:21776
  s_waitcnt lgkmcnt(6)
  v_mfma_f32_16x16x32_bf16 v[56:59], a[0:3], v[108:111], v[56:59]
  s_add_u32 m0, s40, 122880
  s_nop 0
  buffer_load_dwordx4 v5, s[8:11], s41 offen offset:3072 lds
  ds_read_b64_tr_b16 a[20:21], v7 offset:20504
  v_mfma_f32_16x16x32_bf16 v[60:63], a[0:3], v[188:191], v[60:63]
  ds_read_b64_tr_b16 a[22:23], v7 offset:21784
  v_mfma_f32_16x16x32_bf16 v[64:67], a[4:7], v[108:111], v[64:67]
  ds_read_b64_tr_b16 a[0:1], v7 offset:20512
  v_mfma_f32_16x16x32_bf16 v[68:71], a[4:7], v[188:191], v[68:71]
  ds_read_b64_tr_b16 a[2:3], v7 offset:21792
  s_waitcnt lgkmcnt(6)
  v_mfma_f32_16x16x32_bf16 v[32:35], a[8:11], v[112:115], v[32:35]
  ds_read_b64_tr_b16 a[4:5], v7 offset:25600
  v_mfma_f32_16x16x32_bf16 v[36:39], a[8:11], v[192:195], v[36:39]
  ds_read_b64_tr_b16 a[6:7], v7 offset:26880
  v_mfma_f32_16x16x32_bf16 v[40:43], a[12:15], v[112:115], v[40:43]
  s_add_u32 m0, s40, 126976
  s_nop 0
  buffer_load_dwordx4 v6, s[8:11], s41 offen offset:0 lds
  ds_read_b64_tr_b16 a[8:9], v7 offset:25608
  v_mfma_f32_16x16x32_bf16 v[44:47], a[12:15], v[192:195], v[44:47]
  ds_read_b64_tr_b16 a[10:11], v7 offset:26888
  s_waitcnt lgkmcnt(6)
  v_mfma_f32_16x16x32_bf16 v[48:51], a[16:19], v[112:115], v[48:51]
  ds_read_b64_tr_b16 a[12:13], v7 offset:25616
  v_mfma_f32_16x16x32_bf16 v[52:55], a[16:19], v[192:195], v[52:55]
  ds_read_b64_tr_b16 a[14:15], v7 offset:26896
  v_mfma_f32_16x16x32_bf16 v[56:59], a[20:23], v[112:115], v[56:59]
  ds_read_b64_tr_b16 a[16:17], v7 offset:25624
  v_mfma_f32_16x16x32_bf16 v[60:63], a[20:23], v[192:195], v[60:63]
  ds_read_b64_tr_b16 a[18:19], v7 offset:26904
  s_waitcnt lgkmcnt(6)
  v_mfma_f32_16x16x32_bf16 v[64:67], a[0:3], v[112:115], v[64:67]
  ds_read_b64_tr_b16 a[20:21], v7 offset:25632
  v_mfma_f32_16x16x32_bf16 v[68:71], a[0:3], v[192:195], v[68:71]
  ds_read_b64_tr_b16 a[22:23], v7 offset:26912
  v_mfma_f32_16x16x32_bf16 v[32:35], a[4:7], v[116:119], v[32:35]
  ds_read_b64_tr_b16 a[0:1], v7 offset:30720
  v_mfma_f32_16x16x32_bf16 v[36:39], a[4:7], v[196:199], v[36:39]
  ds_read_b64_tr_b16 a[2:3], v7 offset:32000
  s_waitcnt lgkmcnt(6)
  v_mfma_f32_16x16x32_bf16 v[40:43], a[8:11], v[116:119], v[40:43]
  ds_read_b64_tr_b16 a[4:5], v7 offset:30728
  v_mfma_f32_16x16x32_bf16 v[44:47], a[8:11], v[196:199], v[44:47]
  ds_read_b64_tr_b16 a[6:7], v7 offset:32008
  v_mfma_f32_16x16x32_bf16 v[48:51], a[12:15], v[116:119], v[48:51]
  ds_read_b64_tr_b16 a[8:9], v7 offset:30736
  v_mfma_f32_16x16x32_bf16 v[52:55], a[12:15], v[196:199], v[52:55]
  ds_read_b64_tr_b16 a[10:11], v7 offset:32016
  s_waitcnt vmcnt(24)
  s_barrier
  s_waitcnt lgkmcnt(6)
  v_mfma_f32_16x16x32_bf16 v[56:59], a[16:19], v[116:119], v[56:59]
  ds_read_b64_tr_b16 a[12:13], v7 offset:30744
  v_mfma_f32_16x16x32_bf16 v[60:63], a[16:19], v[196:199], v[60:63]
  ds_read_b64_tr_b16 a[14:15], v7 offset:32024
  v_mfma_f32_16x16x32_bf16 v[64:67], a[20:23], v[116:119], v[64:67]
  ds_read_b64_tr_b16 a[16:17], v7 offset:30752
  v_mfma_f32_16x16x32_bf16 v[68:71], a[20:23], v[196:199], v[68:71]
  ds_read_b64_tr_b16 a[18:19], v7 offset:32032
  s_waitcnt lgkmcnt(6)
  v_mfma_f32_16x16x32_bf16 v[32:35], a[0:3], v[120:123], v[32:35]
  s_add_u32 s41, s33, s37
  s_add_u32 m0, s40, 0
  s_nop 0
  buffer_load_dwordx4 v2, s[8:11], s41 offen offset:0 lds
  ds_read_b64_tr_b16 a[20:21], v7 offset:35840
  v_mfma_f32_16x16x32_bf16 v[36:39], a[0:3], v[200:203], v[36:39]
  ds_read_b64_tr_b16 a[22:23], v7 offset:37120
  v_mfma_f32_16x16x32_bf16 v[40:43], a[4:7], v[120:123], v[40:43]
  ds_read_b64_tr_b16 a[0:1], v7 offset:35848
  v_mfma_f32_16x16x32_bf16 v[44:47], a[4:7], v[200:203], v[44:47]
  ds_read_b64_tr_b16 a[2:3], v7 offset:37128
  s_waitcnt lgkmcnt(6)
  v_mfma_f32_16x16x32_bf16 v[48:51], a[8:11], v[120:123], v[48:51]
  ds_read_b64_tr_b16 a[4:5], v7 offset:35856
  v_mfma_f32_16x16x32_bf16 v[52:55], a[8:11], v[200:203], v[52:55]
  ds_read_b64_tr_b16 a[6:7], v7 offset:37136
  v_mfma_f32_16x16x32_bf16 v[56:59], a[12:15], v[120:123], v[56:59]
  s_add_u32 m0, s40, 0
  s_nop 0
  buffer_load_dwordx4 v3, s[8:11], s41 offen offset:1024 lds
  ds_read_b64_tr_b16 a[8:9], v7 offset:35864
  v_mfma_f32_16x16x32_bf16 v[60:63], a[12:15], v[200:203], v[60:63]
  ds_read_b64_tr_b16 a[10:11], v7 offset:37144
  s_waitcnt lgkmcnt(6)
  v_mfma_f32_16x16x32_bf16 v[64:67], a[16:19], v[120:123], v[64:67]
  ds_read_b64_tr_b16 a[12:13], v7 offset:35872
  v_mfma_f32_16x16x32_bf16 v[68:71], a[16:19], v[200:203], v[68:71]
  ds_read_b64_tr_b16 a[14:15], v7 offset:37152
  v_mfma_f32_16x16x32_bf16 v[32:35], a[20:23], v[124:127], v[32:35]
  ds_read_b64_tr_b16 a[16:17], v7 offset:40960
  v_mfma_f32_16x16x32_bf16 v[36:39], a[20:23], v[204:207], v[36:39]
  ds_read_b64_tr_b16 a[18:19], v7 offset:42240
  s_waitcnt lgkmcnt(6)
  v_mfma_f32_16x16x32_bf16 v[40:43], a[0:3], v[124:127], v[40:43]
  s_add_u32 m0, s40, 0
  s_nop 0
  buffer_load_dwordx4 v4, s[8:11], s41 offen offset:2048 lds
  ds_read_b64_tr_b16 a[20:21], v7 offset:40968
  v_mfma_f32_16x16x32_bf16 v[44:47], a[0:3], v[204:207], v[44:47]
  ds_read_b64_tr_b16 a[22:23], v7 offset:42248
  v_mfma_f32_16x16x32_bf16 v[48:51], a[4:7], v[124:127], v[48:51]
  ds_read_b64_tr_b16 a[0:1], v7 offset:40976
  v_mfma_f32_16x16x32_bf16 v[52:55], a[4:7], v[204:207], v[52:55]
  ds_read_b64_tr_b16 a[2:3], v7 offset:42256
  s_waitcnt lgkmcnt(6)
  v_mfma_f32_16x16x32_bf16 v[56:59], a[8:11], v[124:127], v[56:59]
  ds_read_b64_tr_b16 a[4:5], v7 offset:40984
  v_mfma_f32_16x16x32_bf16 v[60:63], a[8:11], v[204:207], v[60:63]
  ds_read_b64_tr_b16 a[6:7], v7 offset:42264
  v_mfma_f32_16x16x32_bf16 v[64:67], a[12:15], v[124:127], v[64:67]
  s_add_u32 m0, s40, 0
  s_nop 0
  buffer_load_dwordx4 v5, s[8:11], s41 offen offset:3072 lds
  ds_read_b64_tr_b16 a[8:9], v7 offset:40992
  v_mfma_f32_16x16x32_bf16 v[68:71], a[12:15], v[204:207], v[68:71]
  ds_read_b64_tr_b16 a[10:11], v7 offset:42272
  s_waitcnt lgkmcnt(6)
  v_mfma_f32_16x16x32_bf16 v[32:35], a[16:19], v[128:131], v[32:35]
  ds_read_b64_tr_b16 a[12:13], v7 offset:46080
  v_mfma_f32_16x16x32_bf16 v[36:39], a[16:19], v[208:211], v[36:39]
  ds_read_b64_tr_b16 a[14:15], v7 offset:47360
  v_mfma_f32_16x16x32_bf16 v[40:43], a[20:23], v[128:131], v[40:43]
  ds_read_b64_tr_b16 a[16:17], v7 offset:46088
  v_mfma_f32_16x16x32_bf16 v[44:47], a[20:23], v[208:211], v[44:47]
  ds_read_b64_tr_b16 a[18:19], v7 offset:47368
  s_waitcnt lgkmcnt(6)
  v_mfma_f32_16x16x32_bf16 v[48:51], a[0:3], v[128:131], v[48:51]
  s_add_u32 m0, s40, 4096
  s_nop 0
  buffer_load_dwordx4 v6, s[8:11], s41 offen offset:0 lds
  ds_read_b64_tr_b16 a[20:21], v7 offset:46096
  v_mfma_f32_16x16x32_bf16 v[52:55], a[0:3], v[208:211], v[52:55]
  ds_read_b64_tr_b16 a[22:23], v7 offset:47376
  v_mfma_f32_16x16x32_bf16 v[56:59], a[4:7], v[128:131], v[56:59]
  ds_read_b64_tr_b16 a[0:1], v7 offset:46104
  v_mfma_f32_16x16x32_bf16 v[60:63], a[4:7], v[208:211], v[60:63]
  ds_read_b64_tr_b16 a[2:3], v7 offset:47384
  s_waitcnt lgkmcnt(6)
  v_mfma_f32_16x16x32_bf16 v[64:67], a[8:11], v[128:131], v[64:67]
  ds_read_b64_tr_b16 a[4:5], v7 offset:46112
  v_mfma_f32_16x16x32_bf16 v[68:71], a[8:11], v[208:211], v[68:71]
  ds_read_b64_tr_b16 a[6:7], v7 offset:47392
  v_mfma_f32_16x16x32_bf16 v[32:35], a[12:15], v[132:135], v[32:35]
  ds_read_b64_tr_b16 a[8:9], v7 offset:51200
  v_mfma_f32_16x16x32_bf16 v[36:39], a[12:15], v[212:215], v[36:39]
  ds_read_b64_tr_b16 a[10:11], v7 offset:52480
  s_waitcnt lgkmcnt(6)
  v_mfma_f32_16x16x32_bf16 v[40:43], a[16:19], v[132:135], v[40:43]
  ds_read_b64_tr_b16 a[12:13], v7 offset:51208
  v_mfma_f32_16x16x32_bf16 v[44:47], a[16:19], v[212:215], v[44:47]
  ds_read_b64_tr_b16 a[14:15], v7 offset:52488
  v_mfma_f32_16x16x32_bf16 v[48:51], a[20:23], v[132:135], v[48:51]
  ds_read_b64_tr_b16 a[16:17], v7 offset:51216
  v_mfma_f32_16x16x32_bf16 v[52:55], a[20:23], v[212:215], v[52:55]
  ds_read_b64_tr_b16 a[18:19], v7 offset:52496
  s_waitcnt vmcnt(24)
  s_barrier
  s_waitcnt lgkmcnt(6)
  v_mfma_f32_16x16x32_bf16 v[56:59], a[0:3], v[132:135], v[56:59]
  s_add_u32 s41, s34, s37
  s_add_u32 m0, s40, 20480
  s_nop 0
  buffer_load_dwordx4 v2, s[8:11], s41 offen offset:0 lds
  ds_read_b64_tr_b16 a[20:21], v7 offset:51224
  v_mfma_f32_16x16x32_bf16 v[60:63], a[0:3], v[212:215], v[60:63]
  ds_read_b64_tr_b16 a[22:23], v7 offset:52504
  v_mfma_f32_16x16x32_bf16 v[64:67], a[4:7], v[132:135], v[64:67]
  ds_read_b64_tr_b16 a[0:1], v7 offset:51232
  v_mfma_f32_16x16x32_bf16 v[68:71], a[4:7], v[212:215], v[68:71]
  ds_read_b64_tr_b16 a[2:3], v7 offset:52512
  s_waitcnt lgkmcnt(6)
  v_mfma_f32_16x16x32_bf16 v[32:35], a[8:11], v[136:139], v[32:35]
  ds_read_b64_tr_b16 a[4:5], v7 offset:56320
  v_lshrrev_b32 v12, 4, v1
  v_lshlrev_b32 v12, 3, v12
  v_mfma_f32_16x16x32_bf16 v[36:39], a[8:11], v[216:219], v[36:39]
  ds_read_b64_tr_b16 a[6:7], v7 offset:57600
  v_bfe_u32 v13, v1, 2, 2
  v_add_u32 v12, v12, v13
  v_mfma_f32_16x16x32_bf16 v[40:43], a[12:15], v[136:139], v[40:43]
  s_add_u32 m0, s40, 20480
  s_nop 0
  buffer_load_dwordx4 v3, s[8:11], s41 offen offset:1024 lds
  ds_read_b64_tr_b16 a[8:9], v7 offset:56328
  v_lshlrev_b32 v12, 7, v12
  v_and_b32 v13, 3, v1
  v_mfma_f32_16x16x32_bf16 v[44:47], a[12:15], v[216:219], v[44:47]
  ds_read_b64_tr_b16 a[10:11], v7 offset:57608
  v_lshl_add_u32 v12, v13, 3, v12
  s_lshl_b32 s73, s20, 12
  s_waitcnt lgkmcnt(6)
  v_mfma_f32_16x16x32_bf16 v[48:51], a[16:19], v[136:139], v[48:51]
  ds_read_b64_tr_b16 a[12:13], v7 offset:56336
  s_add_u32 s73, s73, 144384
  v_add_u32 v12, s73, v12
  v_mfma_f32_16x16x32_bf16 v[52:55], a[16:19], v[216:219], v[52:55]
  ds_read_b64_tr_b16 a[14:15], v7 offset:57616
  v_lshlrev_b32 v13, 4, v1
  s_waitcnt vmcnt(15)
  v_mfma_f32_16x16x32_bf16 v[56:59], a[20:23], v[136:139], v[56:59]
  ds_read_b64_tr_b16 a[16:17], v7 offset:56344
  ds_read_b64_tr_b16 a[36:37], v12 offset:0
  ds_read_b64_tr_b16 a[38:39], v12 offset:512
  v_mfma_f32_16x16x32_bf16 v[60:63], a[20:23], v[216:219], v[60:63]
  ds_read_b64_tr_b16 a[18:19], v7 offset:57624
  ds_read_b64_tr_b16 a[40:41], v12 offset:32
  ds_read_b64_tr_b16 a[42:43], v12 offset:544
  s_waitcnt lgkmcnt(10)
  v_mfma_f32_16x16x32_bf16 v[64:67], a[0:3], v[136:139], v[64:67]
  s_add_u32 m0, s40, 20480
  s_nop 0
  buffer_load_dwordx4 v4, s[8:11], s41 offen offset:2048 lds
  ds_read_b64_tr_b16 a[20:21], v7 offset:56352
  ds_read_b64_tr_b16 a[44:45], v12 offset:64
  ds_read_b64_tr_b16 a[46:47], v12 offset:576
  v_mfma_f32_16x16x32_bf16 v[68:71], a[0:3], v[216:219], v[68:71]
  ds_read_b64_tr_b16 a[22:23], v7 offset:57632
  ds_read_b64_tr_b16 a[48:49], v12 offset:96
  ds_read_b64_tr_b16 a[50:51], v12 offset:608
  v_mfma_f32_16x16x32_bf16 v[32:35], a[4:7], v[140:143], v[32:35]
  ds_read_b64_tr_b16 a[0:1], v8 offset:0
  s_add_u32 s16, s70, 10485760
  s_addc_u32 s17, s71, 0
  s_and_b32 s17, s17, 0xffff
  v_mfma_f32_16x16x32_bf16 v[36:39], a[4:7], v[220:223], v[36:39]
  ds_read_b64_tr_b16 a[2:3], v8 offset:1280
  s_cmp_lt_u32 s2, 192
  s_cselect_b32 s18, 3031040, 0
  s_lshl_b32 s73, s97, 2
  s_waitcnt lgkmcnt(14)
  v_mfma_f32_16x16x32_bf16 v[40:43], a[8:11], v[140:143], v[40:43]
  ds_read_b64_tr_b16 a[4:5], v8 offset:8
  s_add_u32 s73, s73, 0
  s_mul_i32 s74, s73, 52
  v_mfma_f32_16x16x32_bf16 v[44:47], a[8:11], v[220:223], v[44:47]
  ds_read_b64_tr_b16 a[6:7], v8 offset:1288
  s_lshr_b32 s74, s74, 8
  s_mul_i32 s75, s74, 5
  v_mfma_f32_16x16x32_bf16 v[48:51], a[12:15], v[140:143], v[48:51]
  s_add_u32 m0, s40, 20480
  s_nop 0
  buffer_load_dwordx4 v5, s[8:11], s41 offen offset:3072 lds
  ds_read_b64_tr_b16 a[8:9], v8 offset:16
  s_sub_u32 s75, s73, s75
  s_mul_i32 s74, s74, 74
  v_mfma_f32_16x16x32_bf16 v[52:55], a[12:15], v[220:223], v[52:55]
  ds_read_b64_tr_b16 a[10:11], v8 offset:1296
  s_add_u32 s74, s74, s96
  s_mul_i32 s74, s74, 5
  s_waitcnt lgkmcnt(8)
  v_mfma_f32_16x16x32_bf16 v[56:59], a[16:19], v[140:143], v[56:59]
  ds_read_b64_tr_b16 a[12:13], v8 offset:24
  s_add_u32 s74, s74, s75
  s_lshl_b32 s74, s74, 10
  v_mfma_f32_16x16x32_bf16 v[60:63], a[16:19], v[220:223], v[60:63]
  ds_read_b64_tr_b16 a[14:15], v8 offset:1304
  buffer_store_dwordx4 a[36:39], v13, s[16:19], s74 offen sc1
  s_lshl_b32 s73, s97, 2
  v_mfma_f32_16x16x32_bf16 v[64:67], a[20:23], v[140:143], v[64:67]
  ds_read_b64_tr_b16 a[16:17], v8 offset:32
  s_add_u32 s73, s73, 1
  s_mul_i32 s74, s73, 52
  v_mfma_f32_16x16x32_bf16 v[68:71], a[20:23], v[220:223], v[68:71]
  ds_read_b64_tr_b16 a[18:19], v8 offset:1312
  s_lshr_b32 s74, s74, 8
  s_mul_i32 s75, s74, 5
  s_waitcnt lgkmcnt(6)
  v_mfma_f32_16x16x32_bf16 v[32:35], a[0:3], v[144:147], v[32:35]
  s_add_u32 m0, s40, 24576
  s_nop 0
  buffer_load_dwordx4 v6, s[8:11], s41 offen offset:0 lds
  ds_read_b64_tr_b16 a[20:21], v8 offset:5120
  s_sub_u32 s75, s73, s75
  s_mul_i32 s74, s74, 74
  v_mfma_f32_16x16x32_bf16 v[36:39], a[0:3], v[224:227], v[36:39]
  ds_read_b64_tr_b16 a[22:23], v8 offset:6400
  s_add_u32 s74, s74, s96
  s_mul_i32 s74, s74, 5
  v_mfma_f32_16x16x32_bf16 v[40:43], a[4:7], v[144:147], v[40:43]
  ds_read_b64_tr_b16 a[0:1], v8 offset:5128
  s_add_u32 s74, s74, s75
  s_lshl_b32 s74, s74, 10
  v_mfma_f32_16x16x32_bf16 v[44:47], a[4:7], v[224:227], v[44:47]
  ds_read_b64_tr_b16 a[2:3], v8 offset:6408
  buffer_store_dwordx4 a[40:43], v13, s[16:19], s74 offen sc1
  s_lshl_b32 s73, s97, 2
  s_waitcnt lgkmcnt(6)
  v_mfma_f32_16x16x32_bf16 v[48:51], a[8:11], v[144:147], v[48:51]
  ds_read_b64_tr_b16 a[4:5], v8 offset:5136
  s_add_u32 s73, s73, 2
  s_mul_i32 s74, s73, 52
  v_mfma_f32_16x16x32_bf16 v[52:55], a[8:11], v[224:227], v[52:55]
  ds_read_b64_tr_b16 a[6:7], v8 offset:6416
  s_lshr_b32 s74, s74, 8
  s_mul_i32 s75, s74, 5
  v_mfma_f32_16x16x32_bf16 v[56:59], a[12:15], v[144:147], v[56:59]
  ds_read_b64_tr_b16 a[8:9], v8 offset:5144
  s_sub_u32 s75, s73, s75
  s_mul_i32 s74, s74, 74
  v_mfma_f32_16x16x32_bf16 v[60:63], a[12:15], v[224:227], v[60:63]
  ds_read_b64_tr_b16 a[10:11], v8 offset:6424
  s_add_u32 s74, s74, s96
  s_mul_i32 s74, s74, 5
  s_waitcnt lgkmcnt(6)
  v_mfma_f32_16x16x32_bf16 v[64:67], a[16:19], v[144:147], v[64:67]
  ds_read_b64_tr_b16 a[12:13], v8 offset:5152
  s_add_u32 s74, s74, s75
  s_lshl_b32 s74, s74, 10
  v_mfma_f32_16x16x32_bf16 v[68:71], a[16:19], v[224:227], v[68:71]
  ds_read_b64_tr_b16 a[14:15], v8 offset:6432
  buffer_store_dwordx4 a[44:47], v13, s[16:19], s74 offen sc1
  s_lshl_b32 s73, s97, 2
  v_mfma_f32_16x16x32_bf16 v[32:35], a[20:23], v[148:151], v[32:35]
  ds_read_b64_tr_b16 a[16:17], v8 offset:10240
  s_add_u32 s73, s73, 3
  s_mul_i32 s74, s73, 52
  v_mfma_f32_16x16x32_bf16 v[36:39], a[20:23], v[228:231], v[36:39]
  ds_read_b64_tr_b16 a[18:19], v8 offset:11520
  s_lshr_b32 s74, s74, 8
  s_mul_i32 s75, s74, 5
  s_waitcnt lgkmcnt(6)
  v_mfma_f32_16x16x32_bf16 v[40:43], a[0:3], v[148:151], v[40:43]
  ds_read_b64_tr_b16 a[20:21], v8 offset:10248
  s_sub_u32 s75, s73, s75
  s_mul_i32 s74, s74, 74
  v_mfma_f32_16x16x32_bf16 v[44:47], a[0:3], v[228:231], v[44:47]
  ds_read_b64_tr_b16 a[22:23], v8 offset:11528
  s_add_u32 s74, s74, s96
  s_mul_i32 s74, s74, 5
  v_mfma_f32_16x16x32_bf16 v[48:51], a[4:7], v[148:151], v[48:51]
  ds_read_b64_tr_b16 a[0:1], v8 offset:10256
  s_add_u32 s74, s74, s75
  s_lshl_b32 s74, s74, 10
  v_mfma_f32_16x16x32_bf16 v[52:55], a[4:7], v[228:231], v[52:55]
  ds_read_b64_tr_b16 a[2:3], v8 offset:11536
  buffer_store_dwordx4 a[48:51], v13, s[16:19], s74 offen sc1
  s_barrier
  s_waitcnt lgkmcnt(6)
  v_mfma_f32_16x16x32_bf16 v[56:59], a[8:11], v[148:151], v[56:59]
  ds_read_b64_tr_b16 a[4:5], v8 offset:10264
  v_mfma_f32_16x16x32_bf16 v[60:63], a[8:11], v[228:231], v[60:63]
  ds_read_b64_tr_b16 a[6:7], v8 offset:11544
  v_mfma_f32_16x16x32_bf16 v[64:67], a[12:15], v[148:151], v[64:67]
  s_add_u32 s41, s35, s37
  s_add_u32 m0, s40, 40960
  s_nop 0
  buffer_load_dwordx4 v2, s[8:11], s41 offen offset:0 lds
  ds_read_b64_tr_b16 a[8:9], v8 offset:10272
  v_mfma_f32_16x16x32_bf16 v[68:71], a[12:15], v[228:231], v[68:71]
  ds_read_b64_tr_b16 a[10:11], v8 offset:11552
  s_waitcnt lgkmcnt(6)
  v_mfma_f32_16x16x32_bf16 v[32:35], a[16:19], v[152:155], v[32:35]
  ds_read_b64_tr_b16 a[12:13], v8 offset:15360
  v_mfma_f32_16x16x32_bf16 v[36:39], a[16:19], v[232:235], v[36:39]
  ds_read_b64_tr_b16 a[14:15], v8 offset:16640
  v_mfma_f32_16x16x32_bf16 v[40:43], a[20:23], v[152:155], v[40:43]
  ds_read_b64_tr_b16 a[16:17], v8 offset:15368
  v_mfma_f32_16x16x32_bf16 v[44:47], a[20:23], v[232:235], v[44:47]
  ds_read_b64_tr_b16 a[18:19], v8 offset:16648
  s_waitcnt lgkmcnt(6)
  v_mfma_f32_16x16x32_bf16 v[48:51], a[0:3], v[152:155], v[48:51]
  s_add_u32 m0, s40, 40960
  s_nop 0
  buffer_load_dwordx4 v3, s[8:11], s41 offen offset:1024 lds
  ds_read_b64_tr_b16 a[20:21], v8 offset:15376
  v_mfma_f32_16x16x32_bf16 v[52:55], a[0:3], v[232:235], v[52:55]
  ds_read_b64_tr_b16 a[22:23], v8 offset:16656
  v_mfma_f32_16x16x32_bf16 v[56:59], a[4:7], v[152:155], v[56:59]
  ds_read_b64_tr_b16 a[0:1], v8 offset:15384
  v_mfma_f32_16x16x32_bf16 v[60:63], a[4:7], v[232:235], v[60:63]
  ds_read_b64_tr_b16 a[2:3], v8 offset:16664
  s_waitcnt lgkmcnt(6)
  v_mfma_f32_16x16x32_bf16 v[64:67], a[8:11], v[152:155], v[64:67]
  ds_read_b64_tr_b16 a[4:5], v8 offset:15392
  v_mfma_f32_16x16x32_bf16 v[68:71], a[8:11], v[232:235], v[68:71]
  ds_read_b64_tr_b16 a[6:7], v8 offset:16672
  v_mfma_f32_16x16x32_bf16 v[32:35], a[12:15], v[156:159], v[32:35]
  s_add_u32 m0, s40, 40960
  s_nop 0
  buffer_load_dwordx4 v4, s[8:11], s41 offen offset:2048 lds
  ds_read_b64_tr_b16 a[8:9], v8 offset:20480
  v_mfma_f32_16x16x32_bf16 v[36:39], a[12:15], v[236:239], v[36:39]
  ds_read_b64_tr_b16 a[10:11], v8 offset:21760
  s_waitcnt lgkmcnt(6)
  v_mfma_f32_16x16x32_bf16 v[40:43], a[16:19], v[156:159], v[40:43]
  ds_read_b64_tr_b16 a[12:13], v8 offset:20488
  v_mfma_f32_16x16x32_bf16 v[44:47], a[16:19], v[236:239], v[44:47]
  ds_read_b64_tr_b16 a[14:15], v8 offset:21768
  v_mfma_f32_16x16x32_bf16 v[48:51], a[20:23], v[156:159], v[48:51]
  ds_read_b64_tr_b16 a[16:17], v8 offset:20496
  v_mfma_f32_16x16x32_bf16 v[52:55], a[20:23], v[236:239], v[52:55]
  ds_read_b64_tr_b16 a[18:19], v8 offset:21776
  s_waitcnt lgkmcnt(6)
  v_mfma_f32_16x16x32_bf16 v[56:59], a[0:3], v[156:159], v[56:59]
  s_add_u32 m0, s40, 40960
  s_nop 0
  buffer_load_dwordx4 v5, s[8:11], s41 offen offset:3072 lds
  ds_read_b64_tr_b16 a[20:21], v8 offset:20504
  v_mfma_f32_16x16x32_bf16 v[60:63], a[0:3], v[236:239], v[60:63]
  ds_read_b64_tr_b16 a[22:23], v8 offset:21784
  v_mfma_f32_16x16x32_bf16 v[64:67], a[4:7], v[156:159], v[64:67]
  ds_read_b64_tr_b16 a[0:1], v8 offset:20512
  v_mfma_f32_16x16x32_bf16 v[68:71], a[4:7], v[236:239], v[68:71]
  ds_read_b64_tr_b16 a[2:3], v8 offset:21792
  s_waitcnt lgkmcnt(6)
  v_mfma_f32_16x16x32_bf16 v[32:35], a[8:11], v[160:163], v[32:35]
  ds_read_b64_tr_b16 a[4:5], v8 offset:25600
  v_mfma_f32_16x16x32_bf16 v[36:39], a[8:11], v[240:243], v[36:39]
  ds_read_b64_tr_b16 a[6:7], v8 offset:26880
  v_mfma_f32_16x16x32_bf16 v[40:43], a[12:15], v[160:163], v[40:43]
  s_add_u32 m0, s40, 45056
  s_nop 0
  buffer_load_dwordx4 v6, s[8:11], s41 offen offset:0 lds
  ds_read_b64_tr_b16 a[8:9], v8 offset:25608
  v_mfma_f32_16x16x32_bf16 v[44:47], a[12:15], v[240:243], v[44:47]
  ds_read_b64_tr_b16 a[10:11], v8 offset:26888
  s_waitcnt lgkmcnt(6)
  v_mfma_f32_16x16x32_bf16 v[48:51], a[16:19], v[160:163], v[48:51]
  ds_read_b64_tr_b16 a[12:13], v8 offset:25616
  v_mfma_f32_16x16x32_bf16 v[52:55], a[16:19], v[240:243], v[52:55]
  ds_read_b64_tr_b16 a[14:15], v8 offset:26896
  v_mfma_f32_16x16x32_bf16 v[56:59], a[20:23], v[160:163], v[56:59]
  ds_read_b64_tr_b16 a[16:17], v8 offset:25624
  v_mfma_f32_16x16x32_bf16 v[60:63], a[20:23], v[240:243], v[60:63]
  ds_read_b64_tr_b16 a[18:19], v8 offset:26904
  s_waitcnt lgkmcnt(6)
  v_mfma_f32_16x16x32_bf16 v[64:67], a[0:3], v[160:163], v[64:67]
  ds_read_b64_tr_b16 a[20:21], v8 offset:25632
  v_mfma_f32_16x16x32_bf16 v[68:71], a[0:3], v[240:243], v[68:71]
  ds_read_b64_tr_b16 a[22:23], v8 offset:26912
  v_mfma_f32_16x16x32_bf16 v[32:35], a[4:7], v[164:167], v[32:35]
  ds_read_b64_tr_b16 a[0:1], v8 offset:30720
  v_mfma_f32_16x16x32_bf16 v[36:39], a[4:7], v[244:247], v[36:39]
  ds_read_b64_tr_b16 a[2:3], v8 offset:32000
  s_waitcnt lgkmcnt(6)
  v_mfma_f32_16x16x32_bf16 v[40:43], a[8:11], v[164:167], v[40:43]
  ds_read_b64_tr_b16 a[4:5], v8 offset:30728
  v_mfma_f32_16x16x32_bf16 v[44:47], a[8:11], v[244:247], v[44:47]
  ds_read_b64_tr_b16 a[6:7], v8 offset:32008
  v_mfma_f32_16x16x32_bf16 v[48:51], a[12:15], v[164:167], v[48:51]
  ds_read_b64_tr_b16 a[8:9], v8 offset:30736
  v_mfma_f32_16x16x32_bf16 v[52:55], a[12:15], v[244:247], v[52:55]
  ds_read_b64_tr_b16 a[10:11], v8 offset:32016
  s_waitcnt vmcnt(24)
  s_barrier
  s_waitcnt lgkmcnt(6)
  v_mfma_f32_16x16x32_bf16 v[56:59], a[16:19], v[164:167], v[56:59]
  ds_read_b64_tr_b16 a[12:13], v8 offset:30744
  v_mfma_f32_16x16x32_bf16 v[60:63], a[16:19], v[244:247], v[60:63]
  ds_read_b64_tr_b16 a[14:15], v8 offset:32024
  v_mfma_f32_16x16x32_bf16 v[64:67], a[20:23], v[164:167], v[64:67]
  ds_read_b64_tr_b16 a[16:17], v8 offset:30752
  v_mfma_f32_16x16x32_bf16 v[68:71], a[20:23], v[244:247], v[68:71]
  ds_read_b64_tr_b16 a[18:19], v8 offset:32032
  s_waitcnt lgkmcnt(6)
  v_mfma_f32_16x16x32_bf16 v[32:35], a[0:3], v[168:171], v[32:35]
  s_add_u32 s41, s31, s38
  s_add_u32 m0, s40, 61440
  s_nop 0
  buffer_load_dwordx4 v2, s[8:11], s41 offen offset:0 lds
  ds_read_b64_tr_b16 a[20:21], v8 offset:35840
  v_mfma_f32_16x16x32_bf16 v[36:39], a[0:3], v[248:251], v[36:39]
  ds_read_b64_tr_b16 a[22:23], v8 offset:37120
  v_mfma_f32_16x16x32_bf16 v[40:43], a[4:7], v[168:171], v[40:43]
  ds_read_b64_tr_b16 a[0:1], v8 offset:35848
  v_mfma_f32_16x16x32_bf16 v[44:47], a[4:7], v[248:251], v[44:47]
  ds_read_b64_tr_b16 a[2:3], v8 offset:37128
  s_waitcnt lgkmcnt(6)
  v_mfma_f32_16x16x32_bf16 v[48:51], a[8:11], v[168:171], v[48:51]
  ds_read_b64_tr_b16 a[4:5], v8 offset:35856
  v_mfma_f32_16x16x32_bf16 v[52:55], a[8:11], v[248:251], v[52:55]
  ds_read_b64_tr_b16 a[6:7], v8 offset:37136
  v_mfma_f32_16x16x32_bf16 v[56:59], a[12:15], v[168:171], v[56:59]
  s_add_u32 m0, s40, 61440
  s_nop 0
  buffer_load_dwordx4 v3, s[8:11], s41 offen offset:1024 lds
  ds_read_b64_tr_b16 a[8:9], v8 offset:35864
  v_mfma_f32_16x16x32_bf16 v[60:63], a[12:15], v[248:251], v[60:63]
  ds_read_b64_tr_b16 a[10:11], v8 offset:37144
  s_waitcnt lgkmcnt(6)
  v_mfma_f32_16x16x32_bf16 v[64:67], a[16:19], v[168:171], v[64:67]
  ds_read_b64_tr_b16 a[12:13], v8 offset:35872
  v_mfma_f32_16x16x32_bf16 v[68:71], a[16:19], v[248:251], v[68:71]
  ds_read_b64_tr_b16 a[14:15], v8 offset:37152
  v_mfma_f32_16x16x32_bf16 v[32:35], a[20:23], v[172:175], v[32:35]
  ds_read_b64_tr_b16 a[16:17], v8 offset:40960
  v_mfma_f32_16x16x32_bf16 v[36:39], a[20:23], v[252:255], v[36:39]
  ds_read_b64_tr_b16 a[18:19], v8 offset:42240
  s_waitcnt lgkmcnt(6)
  v_mfma_f32_16x16x32_bf16 v[40:43], a[0:3], v[172:175], v[40:43]
  s_add_u32 m0, s40, 61440
  s_nop 0
  buffer_load_dwordx4 v4, s[8:11], s41 offen offset:2048 lds
  ds_read_b64_tr_b16 a[20:21], v8 offset:40968
  v_mfma_f32_16x16x32_bf16 v[44:47], a[0:3], v[252:255], v[44:47]
  ds_read_b64_tr_b16 a[22:23], v8 offset:42248
  v_mfma_f32_16x16x32_bf16 v[48:51], a[4:7], v[172:175], v[48:51]
  ds_read_b64_tr_b16 a[0:1], v8 offset:40976
  v_mfma_f32_16x16x32_bf16 v[52:55], a[4:7], v[252:255], v[52:55]
  ds_read_b64_tr_b16 a[2:3], v8 offset:42256
  s_waitcnt lgkmcnt(6)
  v_mfma_f32_16x16x32_bf16 v[56:59], a[8:11], v[172:175], v[56:59]
  ds_read_b64_tr_b16 a[4:5], v8 offset:40984
  v_cvt_pk_bf16_f32 v72, v32, v33
  v_cvt_pk_bf16_f32 v73, v34, v35
  v_mfma_f32_16x16x32_bf16 v[60:63], a[8:11], v[252:255], v[60:63]
  ds_read_b64_tr_b16 a[6:7], v8 offset:42264
  v_cvt_pk_bf16_f32 v82, v36, v37
  v_cvt_pk_bf16_f32 v83, v38, v39
  v_mfma_f32_16x16x32_bf16 v[64:67], a[12:15], v[172:175], v[64:67]
  s_add_u32 m0, s40, 61440
  s_nop 0
  buffer_load_dwordx4 v5, s[8:11], s41 offen offset:3072 lds
  ds_read_b64_tr_b16 a[8:9], v8 offset:40992
  v_cvt_pk_bf16_f32 v74, v40, v41
  v_cvt_pk_bf16_f32 v75, v42, v43
  v_mfma_f32_16x16x32_bf16 v[68:71], a[12:15], v[252:255], v[68:71]
  ds_read_b64_tr_b16 a[10:11], v8 offset:42272
  v_cvt_pk_bf16_f32 v84, v44, v45
  v_cvt_pk_bf16_f32 v85, v46, v47
  s_waitcnt lgkmcnt(6)
  v_mfma_f32_16x16x32_bf16 v[32:35], a[16:19], v[96:99], 0
  ds_read_b64_tr_b16 a[12:13], v8 offset:46080
  v_cvt_pk_bf16_f32 v76, v48, v49
  v_cvt_pk_bf16_f32 v77, v50, v51
  v_mfma_f32_16x16x32_bf16 v[36:39], a[16:19], v[176:179], 0
  ds_read_b64_tr_b16 a[14:15], v8 offset:47360
  v_cvt_pk_bf16_f32 v86, v52, v53
  v_cvt_pk_bf16_f32 v87, v54, v55
  v_mfma_f32_16x16x32_bf16 v[40:43], a[20:23], v[96:99], 0
  ds_read_b64_tr_b16 a[16:17], v8 offset:46088
  v_cvt_pk_bf16_f32 v78, v56, v57
  v_cvt_pk_bf16_f32 v79, v58, v59
  v_mfma_f32_16x16x32_bf16 v[44:47], a[20:23], v[176:179], 0
  ds_read_b64_tr_b16 a[18:19], v8 offset:47368
  v_cvt_pk_bf16_f32 v88, v60, v61
  v_cvt_pk_bf16_f32 v89, v62, v63
  s_waitcnt lgkmcnt(6)
  v_mfma_f32_16x16x32_bf16 v[48:51], a[0:3], v[96:99], 0
  s_add_u32 m0, s40, 65536
  s_nop 0
  buffer_load_dwordx4 v6, s[8:11], s41 offen offset:0 lds
  ds_read_b64_tr_b16 a[20:21], v8 offset:46096
  v_cvt_pk_bf16_f32 v80, v64, v65
  v_cvt_pk_bf16_f32 v81, v66, v67
  v_mfma_f32_16x16x32_bf16 v[52:55], a[0:3], v[176:179], 0
  ds_read_b64_tr_b16 a[22:23], v8 offset:47376
  v_cvt_pk_bf16_f32 v90, v68, v69
  v_cvt_pk_bf16_f32 v91, v70, v71
  v_mfma_f32_16x16x32_bf16 v[56:59], a[4:7], v[96:99], 0
  ds_read_b64_tr_b16 a[0:1], v8 offset:46104
  v_mfma_f32_16x16x32_bf16 v[60:63], a[4:7], v[176:179], 0
  ds_read_b64_tr_b16 a[2:3], v8 offset:47384
  s_waitcnt lgkmcnt(6)
  v_mfma_f32_16x16x32_bf16 v[64:67], a[8:11], v[96:99], 0
  ds_read_b64_tr_b16 a[4:5], v8 offset:46112
  v_mfma_f32_16x16x32_bf16 v[68:71], a[8:11], v[176:179], 0
  ds_read_b64_tr_b16 a[6:7], v8 offset:47392
  v_mfma_f32_16x16x32_bf16 v[32:35], a[12:15], v[100:103], v[32:35]
  ds_read_b64_tr_b16 a[8:9], v8 offset:51200
  v_mfma_f32_16x16x32_bf16 v[36:39], a[12:15], v[180:183], v[36:39]
  ds_read_b64_tr_b16 a[10:11], v8 offset:52480
  s_waitcnt lgkmcnt(6)
  v_mfma_f32_16x16x32_bf16 v[40:43], a[16:19], v[100:103], v[40:43]
  ds_read_b64_tr_b16 a[12:13], v8 offset:51208
  v_mfma_f32_16x16x32_bf16 v[44:47], a[16:19], v[180:183], v[44:47]
  ds_read_b64_tr_b16 a[14:15], v8 offset:52488
  v_mfma_f32_16x16x32_bf16 v[48:51], a[20:23], v[100:103], v[48:51]
  ds_read_b64_tr_b16 a[16:17], v8 offset:51216
  v_mfma_f32_16x16x32_bf16 v[52:55], a[20:23], v[180:183], v[52:55]
  ds_read_b64_tr_b16 a[18:19], v8 offset:52496
  s_waitcnt vmcnt(10)
  s_barrier
  s_lshl_b32 s73, s2, 2
  s_add_u32 s73, s73, 36864
  s_cmp_lt_u32 s2, 192
  s_cselect_b32 s73, s73, 0x40000000
  v_accvgpr_read_b32 v13, a35
  v_mov_b32 v12, 0x40000000
  v_cmp_eq_u32 vcc, 0, v1
  v_readlane_b32 s72, v13, 25
  s_cmp_eq_u32 s20, 0
  s_cselect_b32 s73, s73, 0x40000000
  v_mov_b32 v13, s73
  v_cndmask_b32 v12, v12, v13, vcc
  s_add_u32 s72, s72, 1
  v_mov_b32 v13, s72
  buffer_store_dword v13, v12, s[56:59], 0 offen sc1
  s_waitcnt lgkmcnt(6)
  v_mfma_f32_16x16x32_bf16 v[56:59], a[0:3], v[100:103], v[56:59]
  s_add_u32 s41, s32, s38
  s_add_u32 m0, s40, 81920
  s_nop 0
  buffer_load_dwordx4 v2, s[8:11], s41 offen offset:0 lds
  ds_read_b64_tr_b16 a[20:21], v8 offset:51224
  v_mfma_f32_16x16x32_bf16 v[60:63], a[0:3], v[180:183], v[60:63]
  ds_read_b64_tr_b16 a[22:23], v8 offset:52504
  v_mfma_f32_16x16x32_bf16 v[64:67], a[4:7], v[100:103], v[64:67]
  ds_read_b64_tr_b16 a[0:1], v8 offset:51232
  v_mfma_f32_16x16x32_bf16 v[68:71], a[4:7], v[180:183], v[68:71]
  ds_read_b64_tr_b16 a[2:3], v8 offset:52512
  s_waitcnt lgkmcnt(6)
  v_mfma_f32_16x16x32_bf16 v[32:35], a[8:11], v[104:107], v[32:35]
  ds_read_b64_tr_b16 a[4:5], v8 offset:56320
  v_mfma_f32_16x16x32_bf16 v[36:39], a[8:11], v[184:187], v[36:39]
  ds_read_b64_tr_b16 a[6:7], v8 offset:57600
  s_mov_b64 exec, s[52:53]
  ds_write_b128 v9, v[72:75] offset:0
  ds_write_b128 v9, v[76:79] offset:16
  ds_write_b128 v9, v[80:83] offset:32
  ds_write_b128 v9, v[84:87] offset:48
  ds_write_b128 v9, v[88:91] offset:64
  s_mov_b64 exec, -1
  v_mfma_f32_16x16x32_bf16 v[40:43], a[12:15], v[104:107], v[40:43]
  s_add_u32 m0, s40, 81920
  s_nop 0
  buffer_load_dwordx4 v3, s[8:11], s41 offen offset:1024 lds
  ds_read_b64_tr_b16 a[8:9], v8 offset:56328
  v_mfma_f32_16x16x32_bf16 v[44:47], a[12:15], v[184:187], v[44:47]
  ds_read_b64_tr_b16 a[10:11], v8 offset:57608
  s_waitcnt lgkmcnt(11)
  v_mfma_f32_16x16x32_bf16 v[48:51], a[16:19], v[104:107], v[48:51]
  ds_read_b64_tr_b16 a[12:13], v8 offset:56336
  v_mfma_f32_16x16x32_bf16 v[52:55], a[16:19], v[184:187], v[52:55]
  ds_read_b64_tr_b16 a[14:15], v8 offset:57616
  v_mfma_f32_16x16x32_bf16 v[56:59], a[20:23], v[104:107], v[56:59]
  ds_read_b64_tr_b16 a[16:17], v8 offset:56344
  v_mfma_f32_16x16x32_bf16 v[60:63], a[20:23], v[184:187], v[60:63]
  ds_read_b64_tr_b16 a[18:19], v8 offset:57624
  s_waitcnt lgkmcnt(11)
  v_mfma_f32_16x16x32_bf16 v[64:67], a[0:3], v[104:107], v[64:67]
  s_add_u32 m0, s40, 81920
  s_nop 0
  buffer_load_dwordx4 v4, s[8:11], s41 offen offset:2048 lds
  ds_read_b64_tr_b16 a[20:21], v8 offset:56352
  v_mfma_f32_16x16x32_bf16 v[68:71], a[0:3], v[184:187], v[68:71]
  ds_read_b64_tr_b16 a[22:23], v8 offset:57632
  v_mfma_f32_16x16x32_bf16 v[32:35], a[4:7], v[108:111], v[32:35]
  ds_read_b64_tr_b16 a[0:1], v92 offset:0
  v_mfma_f32_16x16x32_bf16 v[36:39], a[4:7], v[188:191], v[36:39]
  ds_read_b64_tr_b16 a[2:3], v92 offset:1280
  s_waitcnt lgkmcnt(6)
  v_mfma_f32_16x16x32_bf16 v[40:43], a[8:11], v[108:111], v[40:43]
  ds_read_b64_tr_b16 a[4:5], v92 offset:8
  v_mfma_f32_16x16x32_bf16 v[44:47], a[8:11], v[188:191], v[44:47]
  ds_read_b64_tr_b16 a[6:7], v92 offset:1288
  v_mfma_f32_16x16x32_bf16 v[48:51], a[12:15], v[108:111], v[48:51]
  s_add_u32 m0, s40, 81920
  s_nop 0
  buffer_load_dwordx4 v5, s[8:11], s41 offen offset:3072 lds
  ds_read_b64_tr_b16 a[8:9], v92 offset:16
  v_mfma_f32_16x16x32_bf16 v[52:55], a[12:15], v[188:191], v[52:55]
  ds_read_b64_tr_b16 a[10:11], v92 offset:1296
  s_waitcnt lgkmcnt(6)
  v_mfma_f32_16x16x32_bf16 v[56:59], a[16:19], v[108:111], v[56:59]
  ds_read_b64_tr_b16 a[12:13], v92 offset:24
  v_mfma_f32_16x16x32_bf16 v[60:63], a[16:19], v[188:191], v[60:63]
  ds_read_b64_tr_b16 a[14:15], v92 offset:1304
  v_mfma_f32_16x16x32_bf16 v[64:67], a[20:23], v[108:111], v[64:67]
  ds_read_b64_tr_b16 a[16:17], v92 offset:32
  v_mfma_f32_16x16x32_bf16 v[68:71], a[20:23], v[188:191], v[68:71]
  ds_read_b64_tr_b16 a[18:19], v92 offset:1312
  s_waitcnt lgkmcnt(6)
  v_mfma_f32_16x16x32_bf16 v[32:35], a[0:3], v[112:115], v[32:35]
  s_add_u32 m0, s40, 86016
  s_nop 0
  buffer_load_dwordx4 v6, s[8:11], s41 offen offset:0 lds
  ds_read_b64_tr_b16 a[20:21], v92 offset:5120
  v_mfma_f32_16x16x32_bf16 v[36:39], a[0:3], v[192:195], v[36:39]
  ds_read_b64_tr_b16 a[22:23], v92 offset:6400
  v_mfma_f32_16x16x32_bf16 v[40:43], a[4:7], v[112:115], v[40:43]
  ds_read_b64_tr_b16 a[0:1], v92 offset:5128
  v_mfma_f32_16x16x32_bf16 v[44:47], a[4:7], v[192:195], v[44:47]
  ds_read_b64_tr_b16 a[2:3], v92 offset:6408
  s_waitcnt lgkmcnt(6)
  v_mfma_f32_16x16x32_bf16 v[48:51], a[8:11], v[112:115], v[48:51]
  ds_read_b64_tr_b16 a[4:5], v92 offset:5136
  v_mfma_f32_16x16x32_bf16 v[52:55], a[8:11], v[192:195], v[52:55]
  ds_read_b64_tr_b16 a[6:7], v92 offset:6416
  v_mfma_f32_16x16x32_bf16 v[56:59], a[12:15], v[112:115], v[56:59]
  ds_read_b64_tr_b16 a[8:9], v92 offset:5144
  v_mfma_f32_16x16x32_bf16 v[60:63], a[12:15], v[192:195], v[60:63]
  ds_read_b64_tr_b16 a[10:11], v92 offset:6424
  s_waitcnt lgkmcnt(6)
  v_mfma_f32_16x16x32_bf16 v[64:67], a[16:19], v[112:115], v[64:67]
  ds_read_b64_tr_b16 a[12:13], v92 offset:5152
  v_mfma_f32_16x16x32_bf16 v[68:71], a[16:19], v[192:195], v[68:71]
  ds_read_b64_tr_b16 a[14:15], v92 offset:6432
  v_mfma_f32_16x16x32_bf16 v[32:35], a[20:23], v[116:119], v[32:35]
  ds_read_b64_tr_b16 a[16:17], v92 offset:10240
  v_mfma_f32_16x16x32_bf16 v[36:39], a[20:23], v[196:199], v[36:39]
  ds_read_b64_tr_b16 a[18:19], v92 offset:11520
  s_waitcnt lgkmcnt(6)
  v_mfma_f32_16x16x32_bf16 v[40:43], a[0:3], v[116:119], v[40:43]
  ds_read_b64_tr_b16 a[20:21], v92 offset:10248
  v_mfma_f32_16x16x32_bf16 v[44:47], a[0:3], v[196:199], v[44:47]
  ds_read_b64_tr_b16 a[22:23], v92 offset:11528
  v_mfma_f32_16x16x32_bf16 v[48:51], a[4:7], v[116:119], v[48:51]
  ds_read_b64_tr_b16 a[0:1], v92 offset:10256
  v_mfma_f32_16x16x32_bf16 v[52:55], a[4:7], v[196:199], v[52:55]
  ds_read_b64_tr_b16 a[2:3], v92 offset:11536
  s_barrier
  s_waitcnt lgkmcnt(6)
  v_mfma_f32_16x16x32_bf16 v[56:59], a[8:11], v[116:119], v[56:59]
  ds_read_b64_tr_b16 a[4:5], v92 offset:10264
  v_mfma_f32_16x16x32_bf16 v[60:63], a[8:11], v[196:199], v[60:63]
  ds_read_b64_tr_b16 a[6:7], v92 offset:11544
  v_mfma_f32_16x16x32_bf16 v[64:67], a[12:15], v[116:119], v[64:67]
  s_add_u32 s41, s33, s38
  s_add_u32 m0, s40, 102400
  s_nop 0
  buffer_load_dwordx4 v2, s[8:11], s41 offen offset:0 lds
  ds_read_b64_tr_b16 a[8:9], v92 offset:10272
  v_mfma_f32_16x16x32_bf16 v[68:71], a[12:15], v[196:199], v[68:71]
  ds_read_b64_tr_b16 a[10:11], v92 offset:11552
  s_waitcnt lgkmcnt(6)
  v_mfma_f32_16x16x32_bf16 v[32:35], a[16:19], v[120:123], v[32:35]
  ds_read_b64_tr_b16 a[12:13], v92 offset:15360
  v_mfma_f32_16x16x32_bf16 v[36:39], a[16:19], v[200:203], v[36:39]
  ds_read_b64_tr_b16 a[14:15], v92 offset:16640
  v_mfma_f32_16x16x32_bf16 v[40:43], a[20:23], v[120:123], v[40:43]
  ds_read_b64_tr_b16 a[16:17], v92 offset:15368
  v_mfma_f32_16x16x32_bf16 v[44:47], a[20:23], v[200:203], v[44:47]
  ds_read_b64_tr_b16 a[18:19], v92 offset:16648
  s_waitcnt lgkmcnt(6)
  v_mfma_f32_16x16x32_bf16 v[48:51], a[0:3], v[120:123], v[48:51]
  s_add_u32 m0, s40, 102400
  s_nop 0
  buffer_load_dwordx4 v3, s[8:11], s41 offen offset:1024 lds
  ds_read_b64_tr_b16 a[20:21], v92 offset:15376
  v_mfma_f32_16x16x32_bf16 v[52:55], a[0:3], v[200:203], v[52:55]
  ds_read_b64_tr_b16 a[22:23], v92 offset:16656
  v_mfma_f32_16x16x32_bf16 v[56:59], a[4:7], v[120:123], v[56:59]
  ds_read_b64_tr_b16 a[0:1], v92 offset:15384
  v_mfma_f32_16x16x32_bf16 v[60:63], a[4:7], v[200:203], v[60:63]
  ds_read_b64_tr_b16 a[2:3], v92 offset:16664
  s_waitcnt lgkmcnt(6)
  v_mfma_f32_16x16x32_bf16 v[64:67], a[8:11], v[120:123], v[64:67]
  ds_read_b64_tr_b16 a[4:5], v92 offset:15392
  v_mfma_f32_16x16x32_bf16 v[68:71], a[8:11], v[200:203], v[68:71]
  ds_read_b64_tr_b16 a[6:7], v92 offset:16672
  v_mfma_f32_16x16x32_bf16 v[32:35], a[12:15], v[124:127], v[32:35]
  s_add_u32 m0, s40, 102400
  s_nop 0
  buffer_load_dwordx4 v4, s[8:11], s41 offen offset:2048 lds
  ds_read_b64_tr_b16 a[8:9], v7 offset:0
  v_mfma_f32_16x16x32_bf16 v[36:39], a[12:15], v[204:207], v[36:39]
  ds_read_b64_tr_b16 a[10:11], v7 offset:1280
  s_waitcnt lgkmcnt(6)
  v_mfma_f32_16x16x32_bf16 v[40:43], a[16:19], v[124:127], v[40:43]
  ds_read_b64_tr_b16 a[12:13], v7 offset:8
  v_mfma_f32_16x16x32_bf16 v[44:47], a[16:19], v[204:207], v[44:47]
  ds_read_b64_tr_b16 a[14:15], v7 offset:1288
  v_mfma_f32_16x16x32_bf16 v[48:51], a[20:23], v[124:127], v[48:51]
  ds_read_b64_tr_b16 a[16:17], v7 offset:16
  v_mfma_f32_16x16x32_bf16 v[52:55], a[20:23], v[204:207], v[52:55]
  ds_read_b64_tr_b16 a[18:19], v7 offset:1296
  s_waitcnt lgkmcnt(6)
  v_mfma_f32_16x16x32_bf16 v[56:59], a[0:3], v[124:127], v[56:59]
  s_add_u32 m0, s40, 102400
  s_nop 0
  buffer_load_dwordx4 v5, s[8:11], s41 offen offset:3072 lds
  ds_read_b64_tr_b16 a[20:21], v7 offset:24
  v_mfma_f32_16x16x32_bf16 v[60:63], a[0:3], v[204:207], v[60:63]
  ds_read_b64_tr_b16 a[22:23], v7 offset:1304
  v_mfma_f32_16x16x32_bf16 v[64:67], a[4:7], v[124:127], v[64:67]
  ds_read_b64_tr_b16 a[0:1], v7 offset:32
  v_mfma_f32_16x16x32_bf16 v[68:71], a[4:7], v[204:207], v[68:71]
  ds_read_b64_tr_b16 a[2:3], v7 offset:1312
  s_waitcnt lgkmcnt(6)
  v_mfma_f32_16x16x32_bf16 v[32:35], a[8:11], v[128:131], v[32:35]
  ds_read_b64_tr_b16 a[4:5], v7 offset:5120
  v_mfma_f32_16x16x32_bf16 v[36:39], a[8:11], v[208:211], v[36:39]
  ds_read_b64_tr_b16 a[6:7], v7 offset:6400
  v_mfma_f32_16x16x32_bf16 v[40:43], a[12:15], v[128:131], v[40:43]
  s_add_u32 m0, s40, 106496
  s_nop 0
  buffer_load_dwordx4 v6, s[8:11], s41 offen offset:0 lds
  ds_read_b64_tr_b16 a[8:9], v7 offset:5128
  v_mfma_f32_16x16x32_bf16 v[44:47], a[12:15], v[208:211], v[44:47]
  ds_read_b64_tr_b16 a[10:11], v7 offset:6408
  s_waitcnt lgkmcnt(6)
  v_mfma_f32_16x16x32_bf16 v[48:51], a[16:19], v[128:131], v[48:51]
  ds_read_b64_tr_b16 a[12:13], v7 offset:5136
  v_mfma_f32_16x16x32_bf16 v[52:55], a[16:19], v[208:211], v[52:55]
  ds_read_b64_tr_b16 a[14:15], v7 offset:6416
  v_mfma_f32_16x16x32_bf16 v[56:59], a[20:23], v[128:131], v[56:59]
  ds_read_b64_tr_b16 a[16:17], v7 offset:5144
  v_mfma_f32_16x16x32_bf16 v[60:63], a[20:23], v[208:211], v[60:63]
  ds_read_b64_tr_b16 a[18:19], v7 offset:6424
  s_waitcnt lgkmcnt(6)
  v_mfma_f32_16x16x32_bf16 v[64:67], a[0:3], v[128:131], v[64:67]
  ds_read_b64_tr_b16 a[20:21], v7 offset:5152
  v_mfma_f32_16x16x32_bf16 v[68:71], a[0:3], v[208:211], v[68:71]
  ds_read_b64_tr_b16 a[22:23], v7 offset:6432
  v_mfma_f32_16x16x32_bf16 v[32:35], a[4:7], v[132:135], v[32:35]
  ds_read_b64_tr_b16 a[0:1], v7 offset:10240
  v_mfma_f32_16x16x32_bf16 v[36:39], a[4:7], v[212:215], v[36:39]
  ds_read_b64_tr_b16 a[2:3], v7 offset:11520
  s_waitcnt lgkmcnt(6)
  v_mfma_f32_16x16x32_bf16 v[40:43], a[8:11], v[132:135], v[40:43]
  ds_read_b64_tr_b16 a[4:5], v7 offset:10248
  v_mfma_f32_16x16x32_bf16 v[44:47], a[8:11], v[212:215], v[44:47]
  ds_read_b64_tr_b16 a[6:7], v7 offset:11528
  v_mfma_f32_16x16x32_bf16 v[48:51], a[12:15], v[132:135], v[48:51]
  ds_read_b64_tr_b16 a[8:9], v7 offset:10256
  v_mfma_f32_16x16x32_bf16 v[52:55], a[12:15], v[212:215], v[52:55]
  ds_read_b64_tr_b16 a[10:11], v7 offset:11536
  s_barrier
  s_waitcnt lgkmcnt(6)
  v_mfma_f32_16x16x32_bf16 v[56:59], a[16:19], v[132:135], v[56:59]
  ds_read_b64_tr_b16 a[12:13], v7 offset:10264
  v_mfma_f32_16x16x32_bf16 v[60:63], a[16:19], v[212:215], v[60:63]
  ds_read_b64_tr_b16 a[14:15], v7 offset:11544
  v_mfma_f32_16x16x32_bf16 v[64:67], a[20:23], v[132:135], v[64:67]
  ds_read_b64_tr_b16 a[16:17], v7 offset:10272
  v_mfma_f32_16x16x32_bf16 v[68:71], a[20:23], v[212:215], v[68:71]
  ds_read_b64_tr_b16 a[18:19], v7 offset:11552
  s_waitcnt lgkmcnt(6)
  v_mfma_f32_16x16x32_bf16 v[32:35], a[0:3], v[136:139], v[32:35]
  s_add_u32 s41, s34, s38
  s_add_u32 m0, s40, 122880
  s_nop 0
  buffer_load_dwordx4 v2, s[8:11], s41 offen offset:0 lds
  ds_read_b64_tr_b16 a[20:21], v7 offset:15360
  v_mfma_f32_16x16x32_bf16 v[36:39], a[0:3], v[216:219], v[36:39]
  ds_read_b64_tr_b16 a[22:23], v7 offset:16640
  v_mfma_f32_16x16x32_bf16 v[40:43], a[4:7], v[136:139], v[40:43]
  ds_read_b64_tr_b16 a[0:1], v7 offset:15368
  v_mfma_f32_16x16x32_bf16 v[44:47], a[4:7], v[216:219], v[44:47]
  ds_read_b64_tr_b16 a[2:3], v7 offset:16648
  s_waitcnt lgkmcnt(6)
  v_mfma_f32_16x16x32_bf16 v[48:51], a[8:11], v[136:139], v[48:51]
  ds_read_b64_tr_b16 a[4:5], v7 offset:15376
  v_mfma_f32_16x16x32_bf16 v[52:55], a[8:11], v[216:219], v[52:55]
  ds_read_b64_tr_b16 a[6:7], v7 offset:16656
  v_mfma_f32_16x16x32_bf16 v[56:59], a[12:15], v[136:139], v[56:59]
  s_add_u32 m0, s40, 122880
  s_nop 0
  buffer_load_dwordx4 v3, s[8:11], s41 offen offset:1024 lds
  ds_read_b64_tr_b16 a[8:9], v7 offset:15384
  v_mfma_f32_16x16x32_bf16 v[60:63], a[12:15], v[216:219], v[60:63]
  ds_read_b64_tr_b16 a[10:11], v7 offset:16664
  s_waitcnt lgkmcnt(6)
  v_mfma_f32_16x16x32_bf16 v[64:67], a[16:19], v[136:139], v[64:67]
  ds_read_b64_tr_b16 a[12:13], v7 offset:15392
  v_mfma_f32_16x16x32_bf16 v[68:71], a[16:19], v[216:219], v[68:71]
  ds_read_b64_tr_b16 a[14:15], v7 offset:16672
  v_mfma_f32_16x16x32_bf16 v[32:35], a[20:23], v[140:143], v[32:35]
  ds_read_b64_tr_b16 a[16:17], v7 offset:20480
  v_mfma_f32_16x16x32_bf16 v[36:39], a[20:23], v[220:223], v[36:39]
  ds_read_b64_tr_b16 a[18:19], v7 offset:21760
  s_waitcnt lgkmcnt(6)
  v_mfma_f32_16x16x32_bf16 v[40:43], a[0:3], v[140:143], v[40:43]
  s_add_u32 m0, s40, 122880
  s_nop 0
  buffer_load_dwordx4 v4, s[8:11], s41 offen offset:2048 lds
  ds_read_b64_tr_b16 a[20:21], v7 offset:20488
  v_mfma_f32_16x16x32_bf16 v[44:47], a[0:3], v[220:223], v[44:47]
  ds_read_b64_tr_b16 a[22:23], v7 offset:21768
  v_mfma_f32_16x16x32_bf16 v[48:51], a[4:7], v[140:143], v[48:51]
  ds_read_b64_tr_b16 a[0:1], v7 offset:20496
  v_mfma_f32_16x16x32_bf16 v[52:55], a[4:7], v[220:223], v[52:55]
  ds_read_b64_tr_b16 a[2:3], v7 offset:21776
  s_waitcnt lgkmcnt(6)
  v_mfma_f32_16x16x32_bf16 v[56:59], a[8:11], v[140:143], v[56:59]
  ds_read_b64_tr_b16 a[4:5], v7 offset:20504
  v_mfma_f32_16x16x32_bf16 v[60:63], a[8:11], v[220:223], v[60:63]
  ds_read_b64_tr_b16 a[6:7], v7 offset:21784
  v_mfma_f32_16x16x32_bf16 v[64:67], a[12:15], v[140:143], v[64:67]
  s_add_u32 m0, s40, 122880
  s_nop 0
  buffer_load_dwordx4 v5, s[8:11], s41 offen offset:3072 lds
  ds_read_b64_tr_b16 a[8:9], v7 offset:20512
  v_mfma_f32_16x16x32_bf16 v[68:71], a[12:15], v[220:223], v[68:71]
  ds_read_b64_tr_b16 a[10:11], v7 offset:21792
  s_waitcnt lgkmcnt(6)
  v_mfma_f32_16x16x32_bf16 v[32:35], a[16:19], v[144:147], v[32:35]
  ds_read_b64_tr_b16 a[12:13], v7 offset:25600
  v_mfma_f32_16x16x32_bf16 v[36:39], a[16:19], v[224:227], v[36:39]
  ds_read_b64_tr_b16 a[14:15], v7 offset:26880
  v_mfma_f32_16x16x32_bf16 v[40:43], a[20:23], v[144:147], v[40:43]
  ds_read_b64_tr_b16 a[16:17], v7 offset:25608
  v_mfma_f32_16x16x32_bf16 v[44:47], a[20:23], v[224:227], v[44:47]
  ds_read_b64_tr_b16 a[18:19], v7 offset:26888
  s_waitcnt lgkmcnt(6)
  v_mfma_f32_16x16x32_bf16 v[48:51], a[0:3], v[144:147], v[48:51]
  s_add_u32 m0, s40, 126976
  s_nop 0
  buffer_load_dwordx4 v6, s[8:11], s41 offen offset:0 lds
  ds_read_b64_tr_b16 a[20:21], v7 offset:25616
  v_mfma_f32_16x16x32_bf16 v[52:55], a[0:3], v[224:227], v[52:55]
  ds_read_b64_tr_b16 a[22:23], v7 offset:26896
  v_mfma_f32_16x16x32_bf16 v[56:59], a[4:7], v[144:147], v[56:59]
  ds_read_b64_tr_b16 a[0:1], v7 offset:25624
  v_mfma_f32_16x16x32_bf16 v[60:63], a[4:7], v[224:227], v[60:63]
  ds_read_b64_tr_b16 a[2:3], v7 offset:26904
  s_waitcnt lgkmcnt(6)
  v_mfma_f32_16x16x32_bf16 v[64:67], a[8:11], v[144:147], v[64:67]
  ds_read_b64_tr_b16 a[4:5], v7 offset:25632
  v_mfma_f32_16x16x32_bf16 v[68:71], a[8:11], v[224:227], v[68:71]
  ds_read_b64_tr_b16 a[6:7], v7 offset:26912
  v_mfma_f32_16x16x32_bf16 v[32:35], a[12:15], v[148:151], v[32:35]
  ds_read_b64_tr_b16 a[8:9], v7 offset:30720
  v_mfma_f32_16x16x32_bf16 v[36:39], a[12:15], v[228:231], v[36:39]
  ds_read_b64_tr_b16 a[10:11], v7 offset:32000
  s_waitcnt lgkmcnt(6)
  v_mfma_f32_16x16x32_bf16 v[40:43], a[16:19], v[148:151], v[40:43]
  ds_read_b64_tr_b16 a[12:13], v7 offset:30728
  v_mfma_f32_16x16x32_bf16 v[44:47], a[16:19], v[228:231], v[44:47]
  ds_read_b64_tr_b16 a[14:15], v7 offset:32008
  v_mfma_f32_16x16x32_bf16 v[48:51], a[20:23], v[148:151], v[48:51]
  ds_read_b64_tr_b16 a[16:17], v7 offset:30736
  v_mfma_f32_16x16x32_bf16 v[52:55], a[20:23], v[228:231], v[52:55]
  ds_read_b64_tr_b16 a[18:19], v7 offset:32016
  s_waitcnt vmcnt(21)
  s_barrier
  s_waitcnt lgkmcnt(6)
  v_mfma_f32_16x16x32_bf16 v[56:59], a[0:3], v[148:151], v[56:59]
  s_add_u32 s41, s35, s38
  s_add_u32 m0, s40, 0
  s_nop 0
  buffer_load_dwordx4 v2, s[8:11], s41 offen offset:0 lds
  ds_read_b64_tr_b16 a[20:21], v7 offset:30744
  v_mfma_f32_16x16x32_bf16 v[60:63], a[0:3], v[228:231], v[60:63]
  ds_read_b64_tr_b16 a[22:23], v7 offset:32024
  v_mfma_f32_16x16x32_bf16 v[64:67], a[4:7], v[148:151], v[64:67]
  ds_read_b64_tr_b16 a[0:1], v7 offset:30752
  v_mfma_f32_16x16x32_bf16 v[68:71], a[4:7], v[228:231], v[68:71]
  ds_read_b64_tr_b16 a[2:3], v7 offset:32032
  s_waitcnt lgkmcnt(6)
  v_mfma_f32_16x16x32_bf16 v[32:35], a[8:11], v[152:155], v[32:35]
  ds_read_b64_tr_b16 a[4:5], v7 offset:35840
  v_mfma_f32_16x16x32_bf16 v[36:39], a[8:11], v[232:235], v[36:39]
  ds_read_b64_tr_b16 a[6:7], v7 offset:37120
  v_mfma_f32_16x16x32_bf16 v[40:43], a[12:15], v[152:155], v[40:43]
  s_add_u32 m0, s40, 0
  s_nop 0
  buffer_load_dwordx4 v3, s[8:11], s41 offen offset:1024 lds
  ds_read_b64_tr_b16 a[8:9], v7 offset:35848
  v_mfma_f32_16x16x32_bf16 v[44:47], a[12:15], v[232:235], v[44:47]
  ds_read_b64_tr_b16 a[10:11], v7 offset:37128
  s_waitcnt lgkmcnt(6)
  v_mfma_f32_16x16x32_bf16 v[48:51], a[16:19], v[152:155], v[48:51]
  ds_read_b64_tr_b16 a[12:13], v7 offset:35856
  v_mfma_f32_16x16x32_bf16 v[52:55], a[16:19], v[232:235], v[52:55]
  ds_read_b64_tr_b16 a[14:15], v7 offset:37136
  v_mfma_f32_16x16x32_bf16 v[56:59], a[20:23], v[152:155], v[56:59]
  ds_read_b64_tr_b16 a[16:17], v7 offset:35864
  v_mfma_f32_16x16x32_bf16 v[60:63], a[20:23], v[232:235], v[60:63]
  ds_read_b64_tr_b16 a[18:19], v7 offset:37144
  s_waitcnt lgkmcnt(6)
  v_mfma_f32_16x16x32_bf16 v[64:67], a[0:3], v[152:155], v[64:67]
  s_add_u32 m0, s40, 0
  s_nop 0
  buffer_load_dwordx4 v4, s[8:11], s41 offen offset:2048 lds
  ds_read_b64_tr_b16 a[20:21], v7 offset:35872
  v_mfma_f32_16x16x32_bf16 v[68:71], a[0:3], v[232:235], v[68:71]
  ds_read_b64_tr_b16 a[22:23], v7 offset:37152
  v_mfma_f32_16x16x32_bf16 v[32:35], a[4:7], v[156:159], v[32:35]
  ds_read_b64_tr_b16 a[0:1], v7 offset:40960
  v_mfma_f32_16x16x32_bf16 v[36:39], a[4:7], v[236:239], v[36:39]
  ds_read_b64_tr_b16 a[2:3], v7 offset:42240
  s_waitcnt lgkmcnt(6)
  v_mfma_f32_16x16x32_bf16 v[40:43], a[8:11], v[156:159], v[40:43]
  ds_read_b64_tr_b16 a[4:5], v7 offset:40968
  v_mfma_f32_16x16x32_bf16 v[44:47], a[8:11], v[236:239], v[44:47]
  ds_read_b64_tr_b16 a[6:7], v7 offset:42248
  v_mfma_f32_16x16x32_bf16 v[48:51], a[12:15], v[156:159], v[48:51]
  s_add_u32 m0, s40, 0
  s_nop 0
  buffer_load_dwordx4 v5, s[8:11], s41 offen offset:3072 lds
  ds_read_b64_tr_b16 a[8:9], v7 offset:40976
  v_mfma_f32_16x16x32_bf16 v[52:55], a[12:15], v[236:239], v[52:55]
  ds_read_b64_tr_b16 a[10:11], v7 offset:42256
  s_waitcnt lgkmcnt(6)
  v_mfma_f32_16x16x32_bf16 v[56:59], a[16:19], v[156:159], v[56:59]
  ds_read_b64_tr_b16 a[12:13], v7 offset:40984
  v_mfma_f32_16x16x32_bf16 v[60:63], a[16:19], v[236:239], v[60:63]
  ds_read_b64_tr_b16 a[14:15], v7 offset:42264
  v_mfma_f32_16x16x32_bf16 v[64:67], a[20:23], v[156:159], v[64:67]
  ds_read_b64_tr_b16 a[16:17], v7 offset:40992
  v_mfma_f32_16x16x32_bf16 v[68:71], a[20:23], v[236:239], v[68:71]
  ds_read_b64_tr_b16 a[18:19], v7 offset:42272
  s_waitcnt lgkmcnt(6)
  v_mfma_f32_16x16x32_bf16 v[32:35], a[0:3], v[160:163], v[32:35]
  s_add_u32 m0, s40, 4096
  s_nop 0
  buffer_load_dwordx4 v6, s[8:11], s41 offen offset:0 lds
  ds_read_b64_tr_b16 a[20:21], v7 offset:46080
  v_mfma_f32_16x16x32_bf16 v[36:39], a[0:3], v[240:243], v[36:39]
  ds_read_b64_tr_b16 a[22:23], v7 offset:47360
  v_mfma_f32_16x16x32_bf16 v[40:43], a[4:7], v[160:163], v[40:43]
  ds_read_b64_tr_b16 a[0:1], v7 offset:46088
  v_mfma_f32_16x16x32_bf16 v[44:47], a[4:7], v[240:243], v[44:47]
  ds_read_b64_tr_b16 a[2:3], v7 offset:47368
  s_waitcnt lgkmcnt(6)
  v_mfma_f32_16x16x32_bf16 v[48:51], a[8:11], v[160:163], v[48:51]
  ds_read_b64_tr_b16 a[4:5], v7 offset:46096
  v_mfma_f32_16x16x32_bf16 v[52:55], a[8:11], v[240:243], v[52:55]
  ds_read_b64_tr_b16 a[6:7], v7 offset:47376
  v_mfma_f32_16x16x32_bf16 v[56:59], a[12:15], v[160:163], v[56:59]
  ds_read_b64_tr_b16 a[8:9], v7 offset:46104
  v_mfma_f32_16x16x32_bf16 v[60:63], a[12:15], v[240:243], v[60:63]
  ds_read_b64_tr_b16 a[10:11], v7 offset:47384
  s_waitcnt lgkmcnt(6)
  v_mfma_f32_16x16x32_bf16 v[64:67], a[16:19], v[160:163], v[64:67]
  ds_read_b64_tr_b16 a[12:13], v7 offset:46112
  v_mfma_f32_16x16x32_bf16 v[68:71], a[16:19], v[240:243], v[68:71]
  ds_read_b64_tr_b16 a[14:15], v7 offset:47392
  v_mfma_f32_16x16x32_bf16 v[32:35], a[20:23], v[164:167], v[32:35]
  ds_read_b64_tr_b16 a[16:17], v7 offset:51200
  v_mfma_f32_16x16x32_bf16 v[36:39], a[20:23], v[244:247], v[36:39]
  ds_read_b64_tr_b16 a[18:19], v7 offset:52480
  s_waitcnt lgkmcnt(6)
  v_mfma_f32_16x16x32_bf16 v[40:43], a[0:3], v[164:167], v[40:43]
  ds_read_b64_tr_b16 a[20:21], v7 offset:51208
  v_mfma_f32_16x16x32_bf16 v[44:47], a[0:3], v[244:247], v[44:47]
  ds_read_b64_tr_b16 a[22:23], v7 offset:52488
  v_mfma_f32_16x16x32_bf16 v[48:51], a[4:7], v[164:167], v[48:51]
  ds_read_b64_tr_b16 a[0:1], v7 offset:51216
  v_mfma_f32_16x16x32_bf16 v[52:55], a[4:7], v[244:247], v[52:55]
  ds_read_b64_tr_b16 a[2:3], v7 offset:52496
  s_waitcnt vmcnt(21)
  s_barrier
  s_waitcnt lgkmcnt(6)
  v_mfma_f32_16x16x32_bf16 v[56:59], a[8:11], v[164:167], v[56:59]
  ds_read_b64_tr_b16 a[4:5], v7 offset:51224
  v_mfma_f32_16x16x32_bf16 v[60:63], a[8:11], v[244:247], v[60:63]
  ds_read_b64_tr_b16 a[6:7], v7 offset:52504
  v_mfma_f32_16x16x32_bf16 v[64:67], a[12:15], v[164:167], v[64:67]
  ds_read_b64_tr_b16 a[8:9], v7 offset:51232
  v_mfma_f32_16x16x32_bf16 v[68:71], a[12:15], v[244:247], v[68:71]
  ds_read_b64_tr_b16 a[10:11], v7 offset:52512
  s_waitcnt lgkmcnt(6)
  v_mfma_f32_16x16x32_bf16 v[32:35], a[16:19], v[168:171], v[32:35]
  ds_read_b64_tr_b16 a[12:13], v7 offset:56320
  v_mfma_f32_16x16x32_bf16 v[36:39], a[16:19], v[248:251], v[36:39]
  ds_read_b64_tr_b16 a[14:15], v7 offset:57600
  v_mfma_f32_16x16x32_bf16 v[40:43], a[20:23], v[168:171], v[40:43]
  ds_read_b64_tr_b16 a[16:17], v7 offset:56328
  v_mfma_f32_16x16x32_bf16 v[44:47], a[20:23], v[248:251], v[44:47]
  ds_read_b64_tr_b16 a[18:19], v7 offset:57608
  s_waitcnt lgkmcnt(6)
  v_mfma_f32_16x16x32_bf16 v[48:51], a[0:3], v[168:171], v[48:51]
  ds_read_b64_tr_b16 a[20:21], v7 offset:56336
  v_mfma_f32_16x16x32_bf16 v[52:55], a[0:3], v[248:251], v[52:55]
  ds_read_b64_tr_b16 a[22:23], v7 offset:57616
  v_mfma_f32_16x16x32_bf16 v[56:59], a[4:7], v[168:171], v[56:59]
  ds_read_b64_tr_b16 a[0:1], v7 offset:56344
  v_mfma_f32_16x16x32_bf16 v[60:63], a[4:7], v[248:251], v[60:63]
  ds_read_b64_tr_b16 a[2:3], v7 offset:57624
  s_waitcnt lgkmcnt(6)
  v_mfma_f32_16x16x32_bf16 v[64:67], a[8:11], v[168:171], v[64:67]
  ds_read_b64_tr_b16 a[4:5], v7 offset:56352
  v_mfma_f32_16x16x32_bf16 v[68:71], a[8:11], v[248:251], v[68:71]
  ds_read_b64_tr_b16 a[6:7], v7 offset:57632
  v_mfma_f32_16x16x32_bf16 v[32:35], a[12:15], v[172:175], v[32:35]
  ds_read_b64_tr_b16 a[8:9], v8 offset:0
  v_mfma_f32_16x16x32_bf16 v[36:39], a[12:15], v[252:255], v[36:39]
  ds_read_b64_tr_b16 a[10:11], v8 offset:1280
  s_waitcnt lgkmcnt(6)
  v_mfma_f32_16x16x32_bf16 v[40:43], a[16:19], v[172:175], v[40:43]
  ds_read_b64_tr_b16 a[12:13], v8 offset:8
  v_mfma_f32_16x16x32_bf16 v[44:47], a[16:19], v[252:255], v[44:47]
  ds_read_b64_tr_b16 a[14:15], v8 offset:1288
  v_mfma_f32_16x16x32_bf16 v[48:51], a[20:23], v[172:175], v[48:51]
  ds_read_b64_tr_b16 a[16:17], v8 offset:16
  v_mfma_f32_16x16x32_bf16 v[52:55], a[20:23], v[252:255], v[52:55]
  ds_read_b64_tr_b16 a[18:19], v8 offset:1296
  s_waitcnt lgkmcnt(6)
  v_mfma_f32_16x16x32_bf16 v[56:59], a[0:3], v[172:175], v[56:59]
  ds_read_b64_tr_b16 a[20:21], v8 offset:24
  v_cvt_pk_bf16_f32 v12, v32, v36
  v_cvt_pk_bf16_f32 v13, v33, v37
  v_mfma_f32_16x16x32_bf16 v[60:63], a[0:3], v[252:255], v[60:63]
  ds_read_b64_tr_b16 a[22:23], v8 offset:1304
  v_cvt_pk_bf16_f32 v14, v34, v38
  v_cvt_pk_bf16_f32 v15, v35, v39
  v_mfma_f32_16x16x32_bf16 v[64:67], a[4:7], v[172:175], v[64:67]
  ds_read_b64_tr_b16 a[0:1], v8 offset:32
  v_cvt_pk_bf16_f32 v16, v40, v44
  v_cvt_pk_bf16_f32 v17, v41, v45
  v_mfma_f32_16x16x32_bf16 v[68:71], a[4:7], v[252:255], v[68:71]
  ds_read_b64_tr_b16 a[2:3], v8 offset:1312
  v_cvt_pk_bf16_f32 v18, v42, v46
  v_cvt_pk_bf16_f32 v19, v43, v47
  s_waitcnt lgkmcnt(6)
  v_mfma_f32_16x16x32_bf16 v[32:35], a[8:11], v[96:99], 0
  ds_read_b64_tr_b16 a[4:5], v8 offset:5120
  v_cvt_pk_bf16_f32 v20, v48, v52
  v_cvt_pk_bf16_f32 v21, v49, v53
  v_mfma_f32_16x16x32_bf16 v[36:39], a[8:11], v[176:179], 0
  ds_read_b64_tr_b16 a[6:7], v8 offset:6400
  v_cvt_pk_bf16_f32 v22, v50, v54
  v_cvt_pk_bf16_f32 v23, v51, v55
  v_mfma_f32_16x16x32_bf16 v[40:43], a[12:15], v[96:99], 0
  ds_read_b64_tr_b16 a[8:9], v8 offset:5128
  v_cvt_pk_bf16_f32 v24, v56, v60
  v_cvt_pk_bf16_f32 v25, v57, v61
  v_mfma_f32_16x16x32_bf16 v[44:47], a[12:15], v[176:179], 0
  ds_read_b64_tr_b16 a[10:11], v8 offset:6408
  v_cvt_pk_bf16_f32 v26, v58, v62
  v_cvt_pk_bf16_f32 v27, v59, v63
  s_waitcnt lgkmcnt(6)
  v_mfma_f32_16x16x32_bf16 v[48:51], a[16:19], v[96:99], 0
  ds_read_b64_tr_b16 a[12:13], v8 offset:5136
  v_cvt_pk_bf16_f32 v28, v64, v68
  v_cvt_pk_bf16_f32 v29, v65, v69
  v_mfma_f32_16x16x32_bf16 v[52:55], a[16:19], v[176:179], 0
  ds_read_b64_tr_b16 a[14:15], v8 offset:6416
  v_cvt_pk_bf16_f32 v30, v66, v70
  v_cvt_pk_bf16_f32 v31, v67, v71
  v_mfma_f32_16x16x32_bf16 v[56:59], a[20:23], v[96:99], 0
  ds_read_b64_tr_b16 a[16:17], v8 offset:5144
  v_mfma_f32_16x16x32_bf16 v[60:63], a[20:23], v[176:179], 0
  ds_read_b64_tr_b16 a[18:19], v8 offset:6424
  s_waitcnt lgkmcnt(6)
  v_mfma_f32_16x16x32_bf16 v[64:67], a[0:3], v[96:99], 0
  ds_read_b64_tr_b16 a[20:21], v8 offset:5152
  v_mfma_f32_16x16x32_bf16 v[68:71], a[0:3], v[176:179], 0
  ds_read_b64_tr_b16 a[22:23], v8 offset:6432
  v_mfma_f32_16x16x32_bf16 v[32:35], a[4:7], v[100:103], v[32:35]
  ds_read_b64_tr_b16 a[0:1], v8 offset:10240
  v_mfma_f32_16x16x32_bf16 v[36:39], a[4:7], v[180:183], v[36:39]
  ds_read_b64_tr_b16 a[2:3], v8 offset:11520
  s_waitcnt lgkmcnt(6)
  v_mfma_f32_16x16x32_bf16 v[40:43], a[8:11], v[100:103], v[40:43]
  ds_read_b64_tr_b16 a[4:5], v8 offset:10248
  v_mfma_f32_16x16x32_bf16 v[44:47], a[8:11], v[180:183], v[44:47]
  ds_read_b64_tr_b16 a[6:7], v8 offset:11528
  v_mfma_f32_16x16x32_bf16 v[48:51], a[12:15], v[100:103], v[48:51]
  ds_read_b64_tr_b16 a[8:9], v8 offset:10256
  v_mfma_f32_16x16x32_bf16 v[52:55], a[12:15], v[180:183], v[52:55]
  ds_read_b64_tr_b16 a[10:11], v8 offset:11536
  s_waitcnt vmcnt(15)
  s_barrier
  s_cmp_eq_u32 s20, 0
  s_cselect_b32 s72, 36864, 0x40000000
  v_mul_u32_u24 v93, 12, v1
  v_add_u32 v93, s72, v93
  buffer_load_dwordx3 a[24:26], v93, s[56:59], 0 offen sc1
  s_waitcnt lgkmcnt(6)
  v_mfma_f32_16x16x32_bf16 v[56:59], a[16:19], v[100:103], v[56:59]
  ds_read_b64_tr_b16 a[12:13], v8 offset:10264
  v_mfma_f32_16x16x32_bf16 v[60:63], a[16:19], v[180:183], v[60:63]
  ds_read_b64_tr_b16 a[14:15], v8 offset:11544
  v_mfma_f32_16x16x32_bf16 v[64:67], a[20:23], v[100:103], v[64:67]
  ds_read_b64_tr_b16 a[16:17], v8 offset:10272
  v_mfma_f32_16x16x32_bf16 v[68:71], a[20:23], v[180:183], v[68:71]
  ds_read_b64_tr_b16 a[18:19], v8 offset:11552
  s_waitcnt lgkmcnt(6)
  v_mfma_f32_16x16x32_bf16 v[32:35], a[0:3], v[104:107], v[32:35]
  ds_read_b64_tr_b16 a[20:21], v8 offset:15360
  v_mfma_f32_16x16x32_bf16 v[36:39], a[0:3], v[184:187], v[36:39]
  ds_read_b64_tr_b16 a[22:23], v8 offset:16640
  s_mov_b64 exec, s[52:53]
  ds_write_b128 v9, v[12:15] offset:80
  ds_write_b128 v9, v[16:19] offset:96
  ds_write_b128 v9, v[20:23] offset:112
  ds_write_b128 v9, v[24:27] offset:128
  ds_write_b128 v9, v[28:31] offset:144
  s_mov_b64 exec, -1
  v_mfma_f32_16x16x32_bf16 v[40:43], a[4:7], v[104:107], v[40:43]
  ds_read_b64_tr_b16 a[0:1], v8 offset:15368
  v_mfma_f32_16x16x32_bf16 v[44:47], a[4:7], v[184:187], v[44:47]
  ds_read_b64_tr_b16 a[2:3], v8 offset:16648
  s_waitcnt lgkmcnt(11)
  v_mfma_f32_16x16x32_bf16 v[48:51], a[8:11], v[104:107], v[48:51]
  ds_read_b64_tr_b16 a[4:5], v8 offset:15376
  v_mfma_f32_16x16x32_bf16 v[52:55], a[8:11], v[184:187], v[52:55]
  ds_read_b64_tr_b16 a[6:7], v8 offset:16656
  v_mfma_f32_16x16x32_bf16 v[56:59], a[12:15], v[104:107], v[56:59]
  ds_read_b64_tr_b16 a[8:9], v8 offset:15384
  v_mfma_f32_16x16x32_bf16 v[60:63], a[12:15], v[184:187], v[60:63]
  ds_read_b64_tr_b16 a[10:11], v8 offset:16664
  s_waitcnt lgkmcnt(11)
  v_mfma_f32_16x16x32_bf16 v[64:67], a[16:19], v[104:107], v[64:67]
  ds_read_b64_tr_b16 a[12:13], v8 offset:15392
  v_mfma_f32_16x16x32_bf16 v[68:71], a[16:19], v[184:187], v[68:71]
  ds_read_b64_tr_b16 a[14:15], v8 offset:16672
  v_mfma_f32_16x16x32_bf16 v[32:35], a[20:23], v[108:111], v[32:35]
  ds_read_b64_tr_b16 a[16:17], v8 offset:20480
  v_mfma_f32_16x16x32_bf16 v[36:39], a[20:23], v[188:191], v[36:39]
  ds_read_b64_tr_b16 a[18:19], v8 offset:21760
  s_waitcnt lgkmcnt(6)
  v_mfma_f32_16x16x32_bf16 v[40:43], a[0:3], v[108:111], v[40:43]
  ds_read_b64_tr_b16 a[20:21], v8 offset:20488
  v_mfma_f32_16x16x32_bf16 v[44:47], a[0:3], v[188:191], v[44:47]
  ds_read_b64_tr_b16 a[22:23], v8 offset:21768
  v_mfma_f32_16x16x32_bf16 v[48:51], a[4:7], v[108:111], v[48:51]
  ds_read_b64_tr_b16 a[0:1], v8 offset:20496
  v_mfma_f32_16x16x32_bf16 v[52:55], a[4:7], v[188:191], v[52:55]
  ds_read_b64_tr_b16 a[2:3], v8 offset:21776
  s_waitcnt lgkmcnt(6)
  v_mfma_f32_16x16x32_bf16 v[56:59], a[8:11], v[108:111], v[56:59]
  ds_read_b64_tr_b16 a[4:5], v8 offset:20504
  v_mfma_f32_16x16x32_bf16 v[60:63], a[8:11], v[188:191], v[60:63]
  ds_read_b64_tr_b16 a[6:7], v8 offset:21784
  v_mfma_f32_16x16x32_bf16 v[64:67], a[12:15], v[108:111], v[64:67]
  ds_read_b64_tr_b16 a[8:9], v8 offset:20512
  v_mfma_f32_16x16x32_bf16 v[68:71], a[12:15], v[188:191], v[68:71]
  ds_read_b64_tr_b16 a[10:11], v8 offset:21792
  s_waitcnt lgkmcnt(6)
  v_mfma_f32_16x16x32_bf16 v[32:35], a[16:19], v[112:115], v[32:35]
  ds_read_b64_tr_b16 a[12:13], v8 offset:25600
  v_mfma_f32_16x16x32_bf16 v[36:39], a[16:19], v[192:195], v[36:39]
  ds_read_b64_tr_b16 a[14:15], v8 offset:26880
  v_mfma_f32_16x16x32_bf16 v[40:43], a[20:23], v[112:115], v[40:43]
  ds_read_b64_tr_b16 a[16:17], v8 offset:25608
  v_mfma_f32_16x16x32_bf16 v[44:47], a[20:23], v[192:195], v[44:47]
  ds_read_b64_tr_b16 a[18:19], v8 offset:26888
  s_waitcnt lgkmcnt(6)
  v_mfma_f32_16x16x32_bf16 v[48:51], a[0:3], v[112:115], v[48:51]
  ds_read_b64_tr_b16 a[20:21], v8 offset:25616
  v_mfma_f32_16x16x32_bf16 v[52:55], a[0:3], v[192:195], v[52:55]
  ds_read_b64_tr_b16 a[22:23], v8 offset:26896
  v_mfma_f32_16x16x32_bf16 v[56:59], a[4:7], v[112:115], v[56:59]
  ds_read_b64_tr_b16 a[0:1], v8 offset:25624
  v_mfma_f32_16x16x32_bf16 v[60:63], a[4:7], v[192:195], v[60:63]
  ds_read_b64_tr_b16 a[2:3], v8 offset:26904
  s_waitcnt lgkmcnt(6)
  v_mfma_f32_16x16x32_bf16 v[64:67], a[8:11], v[112:115], v[64:67]
  ds_read_b64_tr_b16 a[4:5], v8 offset:25632
  v_mfma_f32_16x16x32_bf16 v[68:71], a[8:11], v[192:195], v[68:71]
  ds_read_b64_tr_b16 a[6:7], v8 offset:26912
  v_mfma_f32_16x16x32_bf16 v[32:35], a[12:15], v[116:119], v[32:35]
  ds_read_b64_tr_b16 a[8:9], v8 offset:30720
  v_mfma_f32_16x16x32_bf16 v[36:39], a[12:15], v[196:199], v[36:39]
  ds_read_b64_tr_b16 a[10:11], v8 offset:32000
  s_waitcnt lgkmcnt(6)
  v_mfma_f32_16x16x32_bf16 v[40:43], a[16:19], v[116:119], v[40:43]
  ds_read_b64_tr_b16 a[12:13], v8 offset:30728
  v_mfma_f32_16x16x32_bf16 v[44:47], a[16:19], v[196:199], v[44:47]
  ds_read_b64_tr_b16 a[14:15], v8 offset:32008
  v_mfma_f32_16x16x32_bf16 v[48:51], a[20:23], v[116:119], v[48:51]
  ds_read_b64_tr_b16 a[16:17], v8 offset:30736
  v_mfma_f32_16x16x32_bf16 v[52:55], a[20:23], v[196:199], v[52:55]
  ds_read_b64_tr_b16 a[18:19], v8 offset:32016
  s_waitcnt vmcnt(0)
  s_cmp_lg_u32 s20, 0
  s_cbranch_scc1 L_ppq_ok
  s_mov_b32 s76, 0
L_ppq:
  v_accvgpr_read_b32 v94, a24
  v_accvgpr_read_b32 v95, a32
  v_cmp_eq_u32 s[72:73], v94, v95
  v_accvgpr_read_b32 v94, a25
  v_accvgpr_read_b32 v95, a33
  v_cmp_eq_u32 s[74:75], v94, v95
  v_accvgpr_read_b32 v94, a26
  v_accvgpr_read_b32 v95, a34
  v_cmp_eq_u32 vcc, v94, v95
  s_or_b64 s[72:73], s[72:73], s[74:75]
  s_nop 1
  s_or_b64 s[72:73], s[72:73], vcc
  s_cbranch_scc0 L_ppq_ok
  s_add_u32 s76, s76, 1
  s_cmp_ge_u32 s76, 0x1000
  s_cbranch_scc1 L_ppq_ok
  s_sleep 16
  buffer_load_dwordx3 a[24:26], v93, s[56:59], 0 offen sc1
  s_waitcnt vmcnt(0)
  s_branch L_ppq
L_ppq_ok:
  s_barrier
  v_accvgpr_write_b32 a27, v2
  v_mov_b32 v2, v1
  s_lshr_b32 s72, s100, 2
  s_mul_i32 s72, s72, 1
  v_subrev_u32 v94, 5, v2
  v_cmp_gt_u32 vcc, 10, v2
  s_nop 1
  v_cndmask_b32 v94, v94, v2, vcc
  v_lshlrev_b32 v94, 2, v94
  v_add_u32 v94, s20, v94
  v_mul_u32_u24 v95, 147, v94
  v_lshrrev_b32 v95, 11, v95
  v_mul_u32_u24 v93, 14, v95
  v_sub_u32 v94, v94, v93
  v_add_u32 v95, s72, v95
  v_and_b32 v95, 3, v95
  v_lshrrev_b32 v93, 1, v94
  v_lshl_add_u32 v95, v93, 2, v95
  v_and_b32 v94, 1, v94
  v_cmp_eq_u32 vcc, 27, v95
  v_min_u32 v95, 26, v95
  v_lshl_add_u32 v95, v95, 1, v94
  v_lshlrev_b32 v95, 10, v95
  v_cndmask_b32 v94, 0, 1, vcc
  v_or_b32 v95, v95, v94
  s_mul_i32 s72, s20, 5
  s_add_u32 s72, s72, 44
  v_add_u32 v94, s72, v2
  v_lshlrev_b32 v94, 10, v94
  v_subrev_u32 v93, 10, v2
  v_cmp_gt_u32 vcc, 5, v93
  s_nop 1
  v_cndmask_b32 v93, v95, v94, vcc
  v_accvgpr_read_b32 v2, a27
  v_lshlrev_b32 v94, 4, v1
  v_add_u32 v95, 4096, v94
  s_waitcnt lgkmcnt(6)
  v_mfma_f32_16x16x32_bf16 v[56:59], a[0:3], v[116:119], v[56:59]
  s_mov_b32 s18, 3031040
  v_readlane_b32 s43, v93, 0
  s_nop 0
  s_mul_i32 s43, s43, 5
  s_add_u32 s43, s43, s63
  s_nop 1
  buffer_load_dwordx4 a[36:39], v94, s[16:19], s43 offen offset:0 sc1
  ds_read_b64_tr_b16 a[20:21], v8 offset:30744
  v_mfma_f32_16x16x32_bf16 v[60:63], a[0:3], v[196:199], v[60:63]
  ds_read_b64_tr_b16 a[22:23], v8 offset:32024
  v_mfma_f32_16x16x32_bf16 v[64:67], a[4:7], v[116:119], v[64:67]
  buffer_load_dwordx4 a[40:43], v94, s[16:19], s43 offen offset:1024 sc1
  ds_read_b64_tr_b16 a[0:1], v8 offset:30752
  v_mfma_f32_16x16x32_bf16 v[68:71], a[4:7], v[196:199], v[68:71]
  ds_read_b64_tr_b16 a[2:3], v8 offset:32032
  s_waitcnt lgkmcnt(6)
  v_mfma_f32_16x16x32_bf16 v[32:35], a[8:11], v[120:123], v[32:35]
  ds_read_b64_tr_b16 a[4:5], v8 offset:35840
  v_mfma_f32_16x16x32_bf16 v[36:39], a[8:11], v[200:203], v[36:39]
  ds_read_b64_tr_b16 a[6:7], v8 offset:37120
  v_mfma_f32_16x16x32_bf16 v[40:43], a[12:15], v[120:123], v[40:43]
  buffer_load_dwordx4 a[44:47], v94, s[16:19], s43 offen offset:2048 sc1
  ds_read_b64_tr_b16 a[8:9], v8 offset:35848
  v_mfma_f32_16x16x32_bf16 v[44:47], a[12:15], v[200:203], v[44:47]
  ds_read_b64_tr_b16 a[10:11], v8 offset:37128
  s_waitcnt lgkmcnt(6)
  v_mfma_f32_16x16x32_bf16 v[48:51], a[16:19], v[120:123], v[48:51]
  buffer_load_dwordx4 a[48:51], v94, s[16:19], s43 offen offset:3072 sc1
  ds_read_b64_tr_b16 a[12:13], v8 offset:35856
  v_mfma_f32_16x16x32_bf16 v[52:55], a[16:19], v[200:203], v[52:55]
  ds_read_b64_tr_b16 a[14:15], v8 offset:37136
  v_mfma_f32_16x16x32_bf16 v[56:59], a[20:23], v[120:123], v[56:59]
  ds_read_b64_tr_b16 a[16:17], v8 offset:35864
  v_mfma_f32_16x16x32_bf16 v[60:63], a[20:23], v[200:203], v[60:63]
  ds_read_b64_tr_b16 a[18:19], v8 offset:37144
  s_waitcnt lgkmcnt(6)
  v_mfma_f32_16x16x32_bf16 v[64:67], a[0:3], v[120:123], v[64:67]
  buffer_load_dwordx4 a[52:55], v95, s[16:19], s43 offen offset:0 sc1
  ds_read_b64_tr_b16 a[20:21], v8 offset:35872
  v_mfma_f32_16x16x32_bf16 v[68:71], a[0:3], v[200:203], v[68:71]
  ds_read_b64_tr_b16 a[22:23], v8 offset:37152
  v_mfma_f32_16x16x32_bf16 v[32:35], a[4:7], v[124:127], v[32:35]
  v_readlane_b32 s43, v93, 1
  s_nop 0
  s_mul_i32 s43, s43, 5
  s_add_u32 s43, s43, s63
  s_nop 1
  buffer_load_dwordx4 a[56:59], v94, s[16:19], s43 offen offset:0 sc1
  ds_read_b64_tr_b16 a[0:1], v8 offset:40960
  v_mfma_f32_16x16x32_bf16 v[36:39], a[4:7], v[204:207], v[36:39]
  ds_read_b64_tr_b16 a[2:3], v8 offset:42240
  s_waitcnt lgkmcnt(6)
  v_mfma_f32_16x16x32_bf16 v[40:43], a[8:11], v[124:127], v[40:43]
  ds_read_b64_tr_b16 a[4:5], v8 offset:40968
  v_mfma_f32_16x16x32_bf16 v[44:47], a[8:11], v[204:207], v[44:47]
  ds_read_b64_tr_b16 a[6:7], v8 offset:42248
  v_mfma_f32_16x16x32_bf16 v[48:51], a[12:15], v[124:127], v[48:51]
  buffer_load_dwordx4 a[60:63], v94, s[16:19], s43 offen offset:1024 sc1
  ds_read_b64_tr_b16 a[8:9], v8 offset:40976
  v_mfma_f32_16x16x32_bf16 v[52:55], a[12:15], v[204:207], v[52:55]
  ds_read_b64_tr_b16 a[10:11], v8 offset:42256
  s_waitcnt lgkmcnt(6)
  v_mfma_f32_16x16x32_bf16 v[56:59], a[16:19], v[124:127], v[56:59]
  buffer_load_dwordx4 a[64:67], v94, s[16:19], s43 offen offset:2048 sc1
  ds_read_b64_tr_b16 a[12:13], v8 offset:40984
  v_mfma_f32_16x16x32_bf16 v[60:63], a[16:19], v[204:207], v[60:63]
  ds_read_b64_tr_b16 a[14:15], v8 offset:42264
  v_mfma_f32_16x16x32_bf16 v[64:67], a[20:23], v[124:127], v[64:67]
  ds_read_b64_tr_b16 a[16:17], v8 offset:40992
  v_mfma_f32_16x16x32_bf16 v[68:71], a[20:23], v[204:207], v[68:71]
  ds_read_b64_tr_b16 a[18:19], v8 offset:42272
  s_waitcnt lgkmcnt(6)
  v_mfma_f32_16x16x32_bf16 v[32:35], a[0:3], v[128:131], v[32:35]
  buffer_load_dwordx4 a[68:71], v94, s[16:19], s43 offen offset:3072 sc1
  ds_read_b64_tr_b16 a[20:21], v8 offset:46080
  v_mfma_f32_16x16x32_bf16 v[36:39], a[0:3], v[208:211], v[36:39]
  ds_read_b64_tr_b16 a[22:23], v8 offset:47360
  v_mfma_f32_16x16x32_bf16 v[40:43], a[4:7], v[128:131], v[40:43]
  buffer_load_dwordx4 a[72:75], v95, s[16:19], s43 offen offset:0 sc1
  ds_read_b64_tr_b16 a[0:1], v8 offset:46088
  v_mfma_f32_16x16x32_bf16 v[44:47], a[4:7], v[208:211], v[44:47]
  ds_read_b64_tr_b16 a[2:3], v8 offset:47368
  s_waitcnt lgkmcnt(6)
  v_mfma_f32_16x16x32_bf16 v[48:51], a[8:11], v[128:131], v[48:51]
  ds_read_b64_tr_b16 a[4:5], v8 offset:46096
  v_mfma_f32_16x16x32_bf16 v[52:55], a[8:11], v[208:211], v[52:55]
  ds_read_b64_tr_b16 a[6:7], v8 offset:47376
  v_mfma_f32_16x16x32_bf16 v[56:59], a[12:15], v[128:131], v[56:59]
  v_readlane_b32 s43, v93, 2
  s_nop 0
  s_mul_i32 s43, s43, 5
  s_add_u32 s43, s43, s63
  s_nop 1
  buffer_load_dwordx4 a[76:79], v94, s[16:19], s43 offen offset:0 sc1
  ds_read_b64_tr_b16 a[8:9], v8 offset:46104
  v_mfma_f32_16x16x32_bf16 v[60:63], a[12:15], v[208:211], v[60:63]
  ds_read_b64_tr_b16 a[10:11], v8 offset:47384
  s_waitcnt lgkmcnt(6)
  v_mfma_f32_16x16x32_bf16 v[64:67], a[16:19], v[128:131], v[64:67]
  buffer_load_dwordx4 a[80:83], v94, s[16:19], s43 offen offset:1024 sc1
  ds_read_b64_tr_b16 a[12:13], v8 offset:46112
  v_mfma_f32_16x16x32_bf16 v[68:71], a[16:19], v[208:211], v[68:71]
  ds_read_b64_tr_b16 a[14:15], v8 offset:47392
  v_mfma_f32_16x16x32_bf16 v[32:35], a[20:23], v[132:135], v[32:35]
  ds_read_b64_tr_b16 a[16:17], v8 offset:51200
  v_mfma_f32_16x16x32_bf16 v[36:39], a[20:23], v[212:215], v[36:39]
  ds_read_b64_tr_b16 a[18:19], v8 offset:52480
  s_waitcnt lgkmcnt(6)
  v_mfma_f32_16x16x32_bf16 v[40:43], a[0:3], v[132:135], v[40:43]
  buffer_load_dwordx4 a[84:87], v94, s[16:19], s43 offen offset:2048 sc1
  ds_read_b64_tr_b16 a[20:21], v8 offset:51208
  v_mfma_f32_16x16x32_bf16 v[44:47], a[0:3], v[212:215], v[44:47]
  ds_read_b64_tr_b16 a[22:23], v8 offset:52488
  v_mfma_f32_16x16x32_bf16 v[48:51], a[4:7], v[132:135], v[48:51]
  buffer_load_dwordx4 a[88:91], v94, s[16:19], s43 offen offset:3072 sc1
  ds_read_b64_tr_b16 a[0:1], v8 offset:51216
  v_mfma_f32_16x16x32_bf16 v[52:55], a[4:7], v[212:215], v[52:55]
  ds_read_b64_tr_b16 a[2:3], v8 offset:52496
  s_barrier
  s_waitcnt lgkmcnt(6)
  v_mfma_f32_16x16x32_bf16 v[56:59], a[8:11], v[132:135], v[56:59]
  ds_read_b64_tr_b16 a[4:5], v8 offset:51224
  v_mfma_f32_16x16x32_bf16 v[60:63], a[8:11], v[212:215], v[60:63]
  ds_read_b64_tr_b16 a[6:7], v8 offset:52504
  v_mfma_f32_16x16x32_bf16 v[64:67], a[12:15], v[132:135], v[64:67]
  buffer_load_dwordx4 a[92:95], v95, s[16:19], s43 offen offset:0 sc1
  ds_read_b64_tr_b16 a[8:9], v8 offset:51232
  v_mfma_f32_16x16x32_bf16 v[68:71], a[12:15], v[212:215], v[68:71]
  ds_read_b64_tr_b16 a[10:11], v8 offset:52512
  s_waitcnt lgkmcnt(6)
  v_mfma_f32_16x16x32_bf16 v[32:35], a[16:19], v[136:139], v[32:35]
  v_readlane_b32 s43, v93, 3
  s_nop 0
  s_and_b32 s43, s43, -2
  s_mul_i32 s43, s43, 5
  s_add_u32 s43, s43, s63
  s_nop 0
  buffer_load_dwordx4 a[96:99], v94, s[16:19], s43 offen offset:0 sc1
  ds_read_b64_tr_b16 a[12:13], v8 offset:56320
  v_mfma_f32_16x16x32_bf16 v[36:39], a[16:19], v[216:219], v[36:39]
  ds_read_b64_tr_b16 a[14:15], v8 offset:57600
  v_mfma_f32_16x16x32_bf16 v[40:43], a[20:23], v[136:139], v[40:43]
  ds_read_b64_tr_b16 a[16:17], v8 offset:56328
  v_mfma_f32_16x16x32_bf16 v[44:47], a[20:23], v[216:219], v[44:47]
  ds_read_b64_tr_b16 a[18:19], v8 offset:57608
  s_waitcnt lgkmcnt(6)
  v_mfma_f32_16x16x32_bf16 v[48:51], a[0:3], v[136:139], v[48:51]
  buffer_load_dwordx4 a[100:103], v94, s[16:19], s43 offen offset:1024 sc1
  ds_read_b64_tr_b16 a[20:21], v8 offset:56336
  v_mfma_f32_16x16x32_bf16 v[52:55], a[0:3], v[216:219], v[52:55]
  ds_read_b64_tr_b16 a[22:23], v8 offset:57616
  v_mfma_f32_16x16x32_bf16 v[56:59], a[4:7], v[136:139], v[56:59]
  buffer_load_dwordx4 a[104:107], v94, s[16:19], s43 offen offset:2048 sc1
  ds_read_b64_tr_b16 a[0:1], v8 offset:56344
  v_mfma_f32_16x16x32_bf16 v[60:63], a[4:7], v[216:219], v[60:63]
  ds_read_b64_tr_b16 a[2:3], v8 offset:57624
  s_waitcnt lgkmcnt(6)
  v_mfma_f32_16x16x32_bf16 v[64:67], a[8:11], v[136:139], v[64:67]
  ds_read_b64_tr_b16 a[4:5], v8 offset:56352
  v_mfma_f32_16x16x32_bf16 v[68:71], a[8:11], v[216:219], v[68:71]
  ds_read_b64_tr_b16 a[6:7], v8 offset:57632
  v_mfma_f32_16x16x32_bf16 v[32:35], a[12:15], v[140:143], v[32:35]
  buffer_load_dwordx4 a[108:111], v94, s[16:19], s43 offen offset:3072 sc1
  ds_read_b64_tr_b16 a[8:9], v92 offset:0
  v_mfma_f32_16x16x32_bf16 v[36:39], a[12:15], v[220:223], v[36:39]
  ds_read_b64_tr_b16 a[10:11], v92 offset:1280
  s_waitcnt lgkmcnt(6)
  v_mfma_f32_16x16x32_bf16 v[40:43], a[16:19], v[140:143], v[40:43]
  buffer_load_dwordx4 a[112:115], v95, s[16:19], s43 offen offset:0 sc1
  ds_read_b64_tr_b16 a[12:13], v92 offset:8
  v_mfma_f32_16x16x32_bf16 v[44:47], a[16:19], v[220:223], v[44:47]
  ds_read_b64_tr_b16 a[14:15], v92 offset:1288
  v_mfma_f32_16x16x32_bf16 v[48:51], a[20:23], v[140:143], v[48:51]
  ds_read_b64_tr_b16 a[16:17], v92 offset:16
  v_mfma_f32_16x16x32_bf16 v[52:55], a[20:23], v[220:223], v[52:55]
  ds_read_b64_tr_b16 a[18:19], v92 offset:1296
  s_waitcnt lgkmcnt(6)
  v_mfma_f32_16x16x32_bf16 v[56:59], a[0:3], v[140:143], v[56:59]
  v_readlane_b32 s43, v93, 4
  s_nop 0
  s_mul_i32 s43, s43, 5
  s_add_u32 s43, s43, s63
  s_nop 1
  buffer_load_dwordx4 a[116:119], v94, s[16:19], s43 offen offset:0 sc1
  ds_read_b64_tr_b16 a[20:21], v92 offset:24
  v_mfma_f32_16x16x32_bf16 v[60:63], a[0:3], v[220:223], v[60:63]
  ds_read_b64_tr_b16 a[22:23], v92 offset:1304
  v_mfma_f32_16x16x32_bf16 v[64:67], a[4:7], v[140:143], v[64:67]
  buffer_load_dwordx4 a[120:123], v94, s[16:19], s43 offen offset:1024 sc1
  ds_read_b64_tr_b16 a[0:1], v92 offset:32
  v_mfma_f32_16x16x32_bf16 v[68:71], a[4:7], v[220:223], v[68:71]
  ds_read_b64_tr_b16 a[2:3], v92 offset:1312
  s_waitcnt lgkmcnt(6)
  v_mfma_f32_16x16x32_bf16 v[32:35], a[8:11], v[144:147], v[32:35]
  ds_read_b64_tr_b16 a[4:5], v92 offset:5120
  v_mfma_f32_16x16x32_bf16 v[36:39], a[8:11], v[224:227], v[36:39]
  ds_read_b64_tr_b16 a[6:7], v92 offset:6400
  v_mfma_f32_16x16x32_bf16 v[40:43], a[12:15], v[144:147], v[40:43]
  buffer_load_dwordx4 a[124:127], v94, s[16:19], s43 offen offset:2048 sc1
  ds_read_b64_tr_b16 a[8:9], v92 offset:5128
  v_mfma_f32_16x16x32_bf16 v[44:47], a[12:15], v[224:227], v[44:47]
  ds_read_b64_tr_b16 a[10:11], v92 offset:6408
  s_waitcnt lgkmcnt(6)
  v_mfma_f32_16x16x32_bf16 v[48:51], a[16:19], v[144:147], v[48:51]
  buffer_load_dwordx4 a[128:131], v94, s[16:19], s43 offen offset:3072 sc1
  ds_read_b64_tr_b16 a[12:13], v92 offset:5136
  v_mfma_f32_16x16x32_bf16 v[52:55], a[16:19], v[224:227], v[52:55]
  ds_read_b64_tr_b16 a[14:15], v92 offset:6416
  v_mfma_f32_16x16x32_bf16 v[56:59], a[20:23], v[144:147], v[56:59]
  ds_read_b64_tr_b16 a[16:17], v92 offset:5144
  v_mfma_f32_16x16x32_bf16 v[60:63], a[20:23], v[224:227], v[60:63]
  ds_read_b64_tr_b16 a[18:19], v92 offset:6424
  s_waitcnt lgkmcnt(6)
  v_mfma_f32_16x16x32_bf16 v[64:67], a[0:3], v[144:147], v[64:67]
  buffer_load_dwordx4 a[132:135], v95, s[16:19], s43 offen offset:0 sc1
  ds_read_b64_tr_b16 a[20:21], v92 offset:5152
  v_mfma_f32_16x16x32_bf16 v[68:71], a[0:3], v[224:227], v[68:71]
  ds_read_b64_tr_b16 a[22:23], v92 offset:6432
  v_mfma_f32_16x16x32_bf16 v[32:35], a[4:7], v[148:151], v[32:35]
  v_readlane_b32 s43, v93, 5
  s_nop 0
  s_mul_i32 s43, s43, 5
  s_add_u32 s43, s43, s63
  s_nop 1
  buffer_load_dwordx4 a[136:139], v94, s[16:19], s43 offen offset:0 sc1
  ds_read_b64_tr_b16 a[0:1], v92 offset:10240
  v_mfma_f32_16x16x32_bf16 v[36:39], a[4:7], v[228:231], v[36:39]
  ds_read_b64_tr_b16 a[2:3], v92 offset:11520
  s_waitcnt lgkmcnt(6)
  v_mfma_f32_16x16x32_bf16 v[40:43], a[8:11], v[148:151], v[40:43]
  ds_read_b64_tr_b16 a[4:5], v92 offset:10248
  v_mfma_f32_16x16x32_bf16 v[44:47], a[8:11], v[228:231], v[44:47]
  ds_read_b64_tr_b16 a[6:7], v92 offset:11528
  v_mfma_f32_16x16x32_bf16 v[48:51], a[12:15], v[148:151], v[48:51]
  buffer_load_dwordx4 a[140:143], v94, s[16:19], s43 offen offset:1024 sc1
  ds_read_b64_tr_b16 a[8:9], v92 offset:10256
  v_mfma_f32_16x16x32_bf16 v[52:55], a[12:15], v[228:231], v[52:55]
  ds_read_b64_tr_b16 a[10:11], v92 offset:11536
  s_barrier
  s_waitcnt lgkmcnt(6)
  v_mfma_f32_16x16x32_bf16 v[56:59], a[16:19], v[148:151], v[56:59]
  buffer_load_dwordx4 a[144:147], v94, s[16:19], s43 offen offset:2048 sc1
  ds_read_b64_tr_b16 a[12:13], v92 offset:10264
  v_mfma_f32_16x16x32_bf16 v[60:63], a[16:19], v[228:231], v[60:63]
  ds_read_b64_tr_b16 a[14:15], v92 offset:11544
  v_mfma_f32_16x16x32_bf16 v[64:67], a[20:23], v[148:151], v[64:67]
  ds_read_b64_tr_b16 a[16:17], v92 offset:10272
  v_mfma_f32_16x16x32_bf16 v[68:71], a[20:23], v[228:231], v[68:71]
  ds_read_b64_tr_b16 a[18:19], v92 offset:11552
  s_waitcnt lgkmcnt(6)
  v_mfma_f32_16x16x32_bf16 v[32:35], a[0:3], v[152:155], v[32:35]
  buffer_load_dwordx4 a[148:151], v94, s[16:19], s43 offen offset:3072 sc1
  ds_read_b64_tr_b16 a[20:21], v92 offset:15360
  v_mfma_f32_16x16x32_bf16 v[36:39], a[0:3], v[232:235], v[36:39]
  ds_read_b64_tr_b16 a[22:23], v92 offset:16640
  v_mfma_f32_16x16x32_bf16 v[40:43], a[4:7], v[152:155], v[40:43]
  buffer_load_dwordx4 a[152:155], v95, s[16:19], s43 offen offset:0 sc1
  ds_read_b64_tr_b16 a[0:1], v92 offset:15368
  v_mfma_f32_16x16x32_bf16 v[44:47], a[4:7], v[232:235], v[44:47]
  ds_read_b64_tr_b16 a[2:3], v92 offset:16648
  s_waitcnt lgkmcnt(6)
  v_mfma_f32_16x16x32_bf16 v[48:51], a[8:11], v[152:155], v[48:51]
  ds_read_b64_tr_b16 a[4:5], v92 offset:15376
  v_mfma_f32_16x16x32_bf16 v[52:55], a[8:11], v[232:235], v[52:55]
  ds_read_b64_tr_b16 a[6:7], v92 offset:16656
  v_mfma_f32_16x16x32_bf16 v[56:59], a[12:15], v[152:155], v[56:59]
  v_readlane_b32 s43, v93, 6
  s_nop 0
  s_and_b32 s43, s43, -2
  s_mul_i32 s43, s43, 5
  s_add_u32 s43, s43, s63
  s_nop 0
  buffer_load_dwordx4 a[156:159], v94, s[16:19], s43 offen offset:0 sc1
  ds_read_b64_tr_b16 a[8:9], v92 offset:15384
  v_mfma_f32_16x16x32_bf16 v[60:63], a[12:15], v[232:235], v[60:63]
  ds_read_b64_tr_b16 a[10:11], v92 offset:16664
  s_waitcnt lgkmcnt(6)
  v_mfma_f32_16x16x32_bf16 v[64:67], a[16:19], v[152:155], v[64:67]
  buffer_load_dwordx4 a[160:163], v94, s[16:19], s43 offen offset:1024 sc1
  ds_read_b64_tr_b16 a[12:13], v92 offset:15392
  v_mfma_f32_16x16x32_bf16 v[68:71], a[16:19], v[232:235], v[68:71]
  ds_read_b64_tr_b16 a[14:15], v92 offset:16672
  v_mfma_f32_16x16x32_bf16 v[32:35], a[20:23], v[156:159], v[32:35]
  ds_read_b64_tr_b16 a[16:17], v7 offset:0
  v_mfma_f32_16x16x32_bf16 v[36:39], a[20:23], v[236:239], v[36:39]
  ds_read_b64_tr_b16 a[18:19], v7 offset:1280
  s_waitcnt lgkmcnt(6)
  v_mfma_f32_16x16x32_bf16 v[40:43], a[0:3], v[156:159], v[40:43]
  buffer_load_dwordx4 a[164:167], v94, s[16:19], s43 offen offset:2048 sc1
  ds_read_b64_tr_b16 a[20:21], v7 offset:8
  v_mfma_f32_16x16x32_bf16 v[44:47], a[0:3], v[236:239], v[44:47]
  ds_read_b64_tr_b16 a[22:23], v7 offset:1288
  v_mfma_f32_16x16x32_bf16 v[48:51], a[4:7], v[156:159], v[48:51]
  buffer_load_dwordx4 a[168:171], v94, s[16:19], s43 offen offset:3072 sc1
  ds_read_b64_tr_b16 a[0:1], v7 offset:16
  v_mfma_f32_16x16x32_bf16 v[52:55], a[4:7], v[236:239], v[52:55]
  ds_read_b64_tr_b16 a[2:3], v7 offset:1296
  s_waitcnt lgkmcnt(6)
  v_mfma_f32_16x16x32_bf16 v[56:59], a[8:11], v[156:159], v[56:59]
  ds_read_b64_tr_b16 a[4:5], v7 offset:24
  v_mfma_f32_16x16x32_bf16 v[60:63], a[8:11], v[236:239], v[60:63]
  ds_read_b64_tr_b16 a[6:7], v7 offset:1304
  v_mfma_f32_16x16x32_bf16 v[64:67], a[12:15], v[156:159], v[64:67]
  buffer_load_dwordx4 a[172:175], v95, s[16:19], s43 offen offset:0 sc1
  ds_read_b64_tr_b16 a[8:9], v7 offset:32
  v_mfma_f32_16x16x32_bf16 v[68:71], a[12:15], v[236:239], v[68:71]
  ds_read_b64_tr_b16 a[10:11], v7 offset:1312
  s_waitcnt lgkmcnt(6)
  v_mfma_f32_16x16x32_bf16 v[32:35], a[16:19], v[160:163], v[32:35]
  v_readlane_b32 s43, v93, 7
  s_nop 0
  s_mul_i32 s43, s43, 5
  s_add_u32 s43, s43, s63
  s_nop 1
  buffer_load_dwordx4 a[176:179], v94, s[16:19], s43 offen offset:0 sc1
  ds_read_b64_tr_b16 a[12:13], v7 offset:5120
  v_mfma_f32_16x16x32_bf16 v[36:39], a[16:19], v[240:243], v[36:39]
  ds_read_b64_tr_b16 a[14:15], v7 offset:6400
  v_mfma_f32_16x16x32_bf16 v[40:43], a[20:23], v[160:163], v[40:43]
  ds_read_b64_tr_b16 a[16:17], v7 offset:5128
  v_mfma_f32_16x16x32_bf16 v[44:47], a[20:23], v[240:243], v[44:47]
  ds_read_b64_tr_b16 a[18:19], v7 offset:6408
  s_waitcnt lgkmcnt(6)
  v_mfma_f32_16x16x32_bf16 v[48:51], a[0:3], v[160:163], v[48:51]
  buffer_load_dwordx4 a[180:183], v94, s[16:19], s43 offen offset:1024 sc1
  ds_read_b64_tr_b16 a[20:21], v7 offset:5136
  v_mfma_f32_16x16x32_bf16 v[52:55], a[0:3], v[240:243], v[52:55]
  ds_read_b64_tr_b16 a[22:23], v7 offset:6416
  v_mfma_f32_16x16x32_bf16 v[56:59], a[4:7], v[160:163], v[56:59]
  buffer_load_dwordx4 a[184:187], v94, s[16:19], s43 offen offset:2048 sc1
  ds_read_b64_tr_b16 a[0:1], v7 offset:5144
  v_mfma_f32_16x16x32_bf16 v[60:63], a[4:7], v[240:243], v[60:63]
  ds_read_b64_tr_b16 a[2:3], v7 offset:6424
  s_waitcnt lgkmcnt(6)
  v_mfma_f32_16x16x32_bf16 v[64:67], a[8:11], v[160:163], v[64:67]
  ds_read_b64_tr_b16 a[4:5], v7 offset:5152
  v_mfma_f32_16x16x32_bf16 v[68:71], a[8:11], v[240:243], v[68:71]
  ds_read_b64_tr_b16 a[6:7], v7 offset:6432
  v_mfma_f32_16x16x32_bf16 v[32:35], a[12:15], v[164:167], v[32:35]
  buffer_load_dwordx4 a[188:191], v94, s[16:19], s43 offen offset:3072 sc1
  ds_read_b64_tr_b16 a[8:9], v7 offset:10240
  v_mfma_f32_16x16x32_bf16 v[36:39], a[12:15], v[244:247], v[36:39]
  ds_read_b64_tr_b16 a[10:11], v7 offset:11520
  ds_read_b128 v[96:99], v10 offset:0
  ds_read_b128 v[100:103], v10 offset:16
  ds_read_b128 v[104:107], v10 offset:32
  ds_read_b128 v[108:111], v10 offset:48
  ds_read_b128 v[112:115], v10 offset:64
  ds_read_b128 v[116:119], v10 offset:80
  ds_read_b128 v[120:123], v10 offset:96
  ds_read_b128 v[124:127], v10 offset:112
  ds_read_b128 v[128:131], v10 offset:128
  ds_read_b128 v[132:135], v10 offset:144
  ds_read_b64 v[136:137], v11 offset:0
  ds_read_b64 v[138:139], v11 offset:8
  ds_read_b64 v[140:141], v11 offset:16
  ds_read_b64 v[142:143], v11 offset:24
  ds_read_b64 v[144:145], v11 offset:32
  s_waitcnt lgkmcnt(15)
  v_mfma_f32_16x16x32_bf16 v[40:43], a[16:19], v[164:167], v[40:43]
  buffer_load_dwordx4 a[192:195], v95, s[16:19], s43 offen offset:0 sc1
  ds_read_b64_tr_b16 a[12:13], v7 offset:10248
  v_mov_b32 v197, 0
  v_mov_b32 v198, 0
  v_mfma_f32_16x16x32_bf16 v[44:47], a[16:19], v[244:247], v[44:47]
  ds_read_b64_tr_b16 a[14:15], v7 offset:11528
  v_mov_b32 v199, 0
  v_mov_b32 v200, 0
  v_mfma_f32_16x16x32_bf16 v[48:51], a[20:23], v[164:167], v[48:51]
  ds_read_b64_tr_b16 a[16:17], v7 offset:10256
  v_mov_b32 v201, 0
  v_mov_b32 v202, 0
  v_mfma_f32_16x16x32_bf16 v[52:55], a[20:23], v[244:247], v[52:55]
  ds_read_b64_tr_b16 a[18:19], v7 offset:11536
  v_mov_b32 v203, 0
  v_mov_b32 v206, 0
  v_mfma_f32_16x16x32_bf16 v[56:59], a[0:3], v[164:167], v[56:59]
  v_readlane_b32 s43, v93, 8
  s_nop 0
  s_mul_i32 s43, s43, 5
  s_add_u32 s43, s43, s63
  s_nop 1
  buffer_load_dwordx4 a[196:199], v94, s[16:19], s43 offen offset:0 sc1
  ds_read_b64_tr_b16 a[20:21], v7 offset:10264
  v_mov_b32 v207, 0
  v_mov_b32 v208, 0
  v_mfma_f32_16x16x32_bf16 v[60:63], a[0:3], v[244:247], v[60:63]
  ds_read_b64_tr_b16 a[22:23], v7 offset:11544
  v_mov_b32 v209, 0
  v_mov_b32 v210, 0
  v_mfma_f32_16x16x32_bf16 v[64:67], a[4:7], v[164:167], v[64:67]
  buffer_load_dwordx4 a[200:203], v94, s[16:19], s43 offen offset:1024 sc1
  ds_read_b64_tr_b16 a[0:1], v7 offset:10272
  v_mov_b32 v211, 0
  v_mfma_f32_16x16x32_bf16 v[68:71], a[4:7], v[244:247], v[68:71]
  ds_read_b64_tr_b16 a[2:3], v7 offset:11552
  s_waitcnt lgkmcnt(6)
  v_mfma_f32_16x16x32_bf16 v[32:35], a[8:11], v[168:171], v[32:35]
  ds_read_b64_tr_b16 a[4:5], v7 offset:15360
  v_mfma_f32_16x16x32_bf16 v[36:39], a[8:11], v[248:251], v[36:39]
  ds_read_b64_tr_b16 a[6:7], v7 offset:16640
  v_mfma_f32_16x16x32_bf16 v[40:43], a[12:15], v[168:171], v[40:43]
  buffer_load_dwordx4 a[204:207], v94, s[16:19], s43 offen offset:2048 sc1
  ds_read_b64_tr_b16 a[8:9], v7 offset:15368
  v_mfma_f32_16x16x32_bf16 v[44:47], a[12:15], v[248:251], v[44:47]
  ds_read_b64_tr_b16 a[10:11], v7 offset:16648
  s_waitcnt lgkmcnt(6)
  v_mfma_f32_16x16x32_bf16 v[48:51], a[16:19], v[168:171], v[48:51]
  buffer_load_dwordx4 a[208:211], v94, s[16:19], s43 offen offset:3072 sc1
  ds_read_b64_tr_b16 a[12:13], v7 offset:15376
  v_mfma_f32_16x16x32_bf16 v[52:55], a[16:19], v[248:251], v[52:55]
  ds_read_b64_tr_b16 a[14:15], v7 offset:16656
  v_mfma_f32_16x16x32_bf16 v[56:59], a[20:23], v[168:171], v[56:59]
  ds_read_b64_tr_b16 a[16:17], v7 offset:15384
  v_mfma_f32_16x16x32_bf16 v[60:63], a[20:23], v[248:251], v[60:63]
  ds_read_b64_tr_b16 a[18:19], v7 offset:16664
  s_waitcnt lgkmcnt(6)
  v_mfma_f32_16x16x32_bf16 v[64:67], a[0:3], v[168:171], v[64:67]
  buffer_load_dwordx4 a[212:215], v95, s[16:19], s43 offen offset:0 sc1
  ds_read_b64_tr_b16 a[20:21], v7 offset:15392
  v_mfma_f32_16x16x32_bf16 v[68:71], a[0:3], v[248:251], v[68:71]
  ds_read_b64_tr_b16 a[22:23], v7 offset:16672
  v_mfma_f32_16x16x32_bf16 v[32:35], a[4:7], v[172:175], v[32:35]
  v_readlane_b32 s43, v93, 9
  s_nop 0
  s_mul_i32 s43, s43, 5
  s_add_u32 s43, s43, s63
  s_nop 1
  buffer_load_dwordx4 a[216:219], v94, s[16:19], s43 offen offset:0 sc1
  v_mfma_f32_16x16x32_bf16 v[36:39], a[4:7], v[252:255], v[36:39]
  s_waitcnt lgkmcnt(4)
  v_mfma_f32_16x16x32_bf16 v[40:43], a[8:11], v[172:175], v[40:43]
  v_mfma_f32_16x16x32_bf16 v[44:47], a[8:11], v[252:255], v[44:47]
  v_mfma_f32_16x16x32_bf16 v[48:51], a[12:15], v[172:175], v[48:51]
  buffer_load_dwordx4 a[220:223], v94, s[16:19], s43 offen offset:1024 sc1
  v_mfma_f32_16x16x32_bf16 v[52:55], a[12:15], v[252:255], v[52:55]
  s_waitcnt lgkmcnt(0)
  v_mfma_f32_16x16x32_bf16 v[56:59], a[16:19], v[172:175], v[56:59]
  buffer_load_dwordx4 a[224:227], v94, s[16:19], s43 offen offset:2048 sc1
  v_cvt_pk_bf16_f32 v176, v32, v33
  v_cvt_pk_bf16_f32 v177, v34, v35
  v_mfma_f32_16x16x32_bf16 v[60:63], a[16:19], v[252:255], v[60:63]
  v_cvt_pk_bf16_f32 v186, v36, v37
  v_cvt_pk_bf16_f32 v187, v38, v39
  v_mfma_f32_16x16x32_bf16 v[64:67], a[20:23], v[172:175], v[64:67]
  v_cvt_pk_bf16_f32 v178, v40, v41
  v_cvt_pk_bf16_f32 v179, v42, v43
  v_mfma_f32_16x16x32_bf16 v[68:71], a[20:23], v[252:255], v[68:71]
  v_cvt_pk_bf16_f32 v188, v44, v45
  v_cvt_pk_bf16_f32 v189, v46, v47
  v_cvt_pk_bf16_f32 v180, v48, v49
  v_cvt_pk_bf16_f32 v181, v50, v51
  v_cvt_pk_bf16_f32 v190, v52, v53
  v_cvt_pk_bf16_f32 v191, v54, v55
  v_cvt_pk_bf16_f32 v182, v56, v57
  v_cvt_pk_bf16_f32 v183, v58, v59
  v_cvt_pk_bf16_f32 v192, v60, v61
  v_cvt_pk_bf16_f32 v193, v62, v63
  v_cvt_pk_bf16_f32 v184, v64, v65
  v_cvt_pk_bf16_f32 v185, v66, v67
  v_cvt_pk_bf16_f32 v194, v68, v69
  v_cvt_pk_bf16_f32 v195, v70, v71
  v_dot2_f32_bf16 v204, v82, v186, 0
  v_dot2_f32_bf16 v205, v72, v186, 0
  v_dot2_f32_bf16 v196, v72, v176, 0
  v_dot2_f32_bf16 v204, v83, v187, v204
  v_dot2_f32_bf16 v205, v73, v187, v205
  v_dot2_f32_bf16 v196, v73, v177, v196
  v_dot2_f32_bf16 v204, v84, v188, v204
  v_dot2_f32_bf16 v205, v74, v188, v205
  v_dot2_f32_bf16 v196, v74, v178, v196
  v_dot2_f32_bf16 v204, v85, v189, v204
  v_dot2_f32_bf16 v205, v75, v189, v205
  buffer_load_dwordx4 a[228:231], v94, s[16:19], s43 offen offset:3072 sc1
  v_dot2_f32_bf16 v196, v75, v179, v196
  v_dot2_f32_bf16 v204, v86, v190, v204
  v_dot2_f32_bf16 v205, v76, v190, v205
  v_dot2_f32_bf16 v196, v76, v180, v196
  v_dot2_f32_bf16 v204, v87, v191, v204
  v_dot2_f32_bf16 v205, v77, v191, v205
  v_dot2_f32_bf16 v196, v77, v181, v196
  v_dot2_f32_bf16 v204, v88, v192, v204
  v_dot2_f32_bf16 v205, v78, v192, v205
  v_dot2_f32_bf16 v196, v78, v182, v196
  v_dot2_f32_bf16 v204, v89, v193, v204
  v_dot2_f32_bf16 v205, v79, v193, v205
  buffer_load_dwordx4 a[232:235], v95, s[16:19], s43 offen offset:0 sc1
  v_dot2_f32_bf16 v196, v79, v183, v196
  v_dot2_f32_bf16 v204, v90, v194, v204
  v_dot2_f32_bf16 v205, v80, v194, v205
  v_dot2_f32_bf16 v196, v80, v184, v196
  v_dot2_f32_bf16 v204, v91, v195, v204
  v_dot2_f32_bf16 v205, v81, v195, v205
  v_dot2_f32_bf16 v196, v81, v185, v196
  s_mov_b32 exec_lo, 0x80008000
  s_mov_b32 exec_hi, 0x80008000
  v_mov_b64 v[72:73], v[96:97]
  v_mov_b64 v[74:75], v[98:99]
  v_mov_b64 v[76:77], v[100:101]
  v_mov_b64 v[78:79], v[102:103]
  v_mov_b64 v[80:81], v[104:105]
  v_mov_b64 v[82:83], v[106:107]
  v_mov_b64 v[84:85], v[108:109]
  v_mov_b64 v[86:87], v[110:111]
  v_mov_b64 v[88:89], v[112:113]
  v_mov_b64 v[90:91], v[114:115]
  s_mov_b64 exec, -1
  v_dot2c_f32_bf16_dpp v206, v82, v186 row_ror:1 row_mask:0xf bank_mask:0xf
  v_dot2c_f32_bf16_dpp v207, v72, v186 row_ror:1 row_mask:0xf bank_mask:0xf
  v_dot2c_f32_bf16_dpp v197, v82, v176 row_ror:1 row_mask:0xf bank_mask:0xf
  v_dot2c_f32_bf16_dpp v198, v72, v176 row_ror:1 row_mask:0xf bank_mask:0xf
  v_dot2c_f32_bf16_dpp v206, v83, v187 row_ror:1 row_mask:0xf bank_mask:0xf
  v_readlane_b32 s43, v93, 10
  s_nop 0
  s_mul_i32 s43, s43, 5
  s_add_u32 s43, s43, s63
  s_nop 1
  buffer_load_dwordx4 a[236:239], v94, s[16:19], s43 offen offset:0 sc1
  v_dot2c_f32_bf16_dpp v207, v73, v187 row_ror:1 row_mask:0xf bank_mask:0xf
  v_dot2c_f32_bf16_dpp v197, v83, v177 row_ror:1 row_mask:0xf bank_mask:0xf
  v_dot2c_f32_bf16_dpp v198, v73, v177 row_ror:1 row_mask:0xf bank_mask:0xf
  v_dot2c_f32_bf16_dpp v206, v84, v188 row_ror:1 row_mask:0xf bank_mask:0xf
  v_dot2c_f32_bf16_dpp v207, v74, v188 row_ror:1 row_mask:0xf bank_mask:0xf
  v_dot2c_f32_bf16_dpp v197, v84, v178 row_ror:1 row_mask:0xf bank_mask:0xf
  v_dot2c_f32_bf16_dpp v198, v74, v178 row_ror:1 row_mask:0xf bank_mask:0xf
  v_dot2c_f32_bf16_dpp v206, v85, v189 row_ror:1 row_mask:0xf bank_mask:0xf
  v_dot2c_f32_bf16_dpp v207, v75, v189 row_ror:1 row_mask:0xf bank_mask:0xf
  v_dot2c_f32_bf16_dpp v197, v85, v179 row_ror:1 row_mask:0xf bank_mask:0xf
  v_dot2c_f32_bf16_dpp v198, v75, v179 row_ror:1 row_mask:0xf bank_mask:0xf
  v_dot2c_f32_bf16_dpp v206, v86, v190 row_ror:1 row_mask:0xf bank_mask:0xf
  buffer_load_dwordx4 a[240:243], v94, s[16:19], s43 offen offset:1024 sc1
  v_dot2c_f32_bf16_dpp v207, v76, v190 row_ror:1 row_mask:0xf bank_mask:0xf
  v_dot2c_f32_bf16_dpp v197, v86, v180 row_ror:1 row_mask:0xf bank_mask:0xf
  v_dot2c_f32_bf16_dpp v198, v76, v180 row_ror:1 row_mask:0xf bank_mask:0xf
  v_dot2c_f32_bf16_dpp v206, v87, v191 row_ror:1 row_mask:0xf bank_mask:0xf
  v_dot2c_f32_bf16_dpp v207, v77, v191 row_ror:1 row_mask:0xf bank_mask:0xf
  v_dot2c_f32_bf16_dpp v197, v87, v181 row_ror:1 row_mask:0xf bank_mask:0xf
  v_dot2c_f32_bf16_dpp v198, v77, v181 row_ror:1 row_mask:0xf bank_mask:0xf
  v_dot2c_f32_bf16_dpp v206, v88, v192 row_ror:1 row_mask:0xf bank_mask:0xf
  v_dot2c_f32_bf16_dpp v207, v78, v192 row_ror:1 row_mask:0xf bank_mask:0xf
  v_dot2c_f32_bf16_dpp v197, v88, v182 row_ror:1 row_mask:0xf bank_mask:0xf
  v_dot2c_f32_bf16_dpp v198, v78, v182 row_ror:1 row_mask:0xf bank_mask:0xf
  v_dot2c_f32_bf16_dpp v206, v89, v193 row_ror:1 row_mask:0xf bank_mask:0xf
  buffer_load_dwordx4 a[244:247], v94, s[16:19], s43 offen offset:2048 sc1
  v_dot2c_f32_bf16_dpp v207, v79, v193 row_ror:1 row_mask:0xf bank_mask:0xf
  v_dot2c_f32_bf16_dpp v197, v89, v183 row_ror:1 row_mask:0xf bank_mask:0xf
  v_dot2c_f32_bf16_dpp v198, v79, v183 row_ror:1 row_mask:0xf bank_mask:0xf
  v_dot2c_f32_bf16_dpp v206, v90, v194 row_ror:1 row_mask:0xf bank_mask:0xf
  v_dot2c_f32_bf16_dpp v207, v80, v194 row_ror:1 row_mask:0xf bank_mask:0xf
  v_dot2c_f32_bf16_dpp v197, v90, v184 row_ror:1 row_mask:0xf bank_mask:0xf
  v_dot2c_f32_bf16_dpp v198, v80, v184 row_ror:1 row_mask:0xf bank_mask:0xf
  v_dot2c_f32_bf16_dpp v206, v91, v195 row_ror:1 row_mask:0xf bank_mask:0xf
  v_dot2c_f32_bf16_dpp v207, v81, v195 row_ror:1 row_mask:0xf bank_mask:0xf
  v_dot2c_f32_bf16_dpp v197, v91, v185 row_ror:1 row_mask:0xf bank_mask:0xf
  v_dot2c_f32_bf16_dpp v198, v81, v185 row_ror:1 row_mask:0xf bank_mask:0xf
  s_mov_b32 exec_lo, 0x40004000
  s_mov_b32 exec_hi, 0x40004000
  v_mov_b64 v[72:73], v[96:97]
  v_mov_b64 v[74:75], v[98:99]
  v_mov_b64 v[76:77], v[100:101]
  v_mov_b64 v[78:79], v[102:103]
  v_mov_b64 v[80:81], v[104:105]
  v_mov_b64 v[82:83], v[106:107]
  v_mov_b64 v[84:85], v[108:109]
  v_mov_b64 v[86:87], v[110:111]
  v_mov_b64 v[88:89], v[112:113]
  v_mov_b64 v[90:91], v[114:115]
  s_mov_b64 exec, -1
  v_dot2c_f32_bf16_dpp v208, v82, v186 row_ror:2 row_mask:0xf bank_mask:0xf
  buffer_load_dwordx4 a[248:251], v94, s[16:19], s43 offen offset:3072 sc1
  v_dot2c_f32_bf16_dpp v209, v72, v186 row_ror:2 row_mask:0xf bank_mask:0xf
  v_dot2c_f32_bf16_dpp v199, v82, v176 row_ror:2 row_mask:0xf bank_mask:0xf
  v_dot2c_f32_bf16_dpp v200, v72, v176 row_ror:2 row_mask:0xf bank_mask:0xf
  v_dot2c_f32_bf16_dpp v208, v83, v187 row_ror:2 row_mask:0xf bank_mask:0xf
  v_dot2c_f32_bf16_dpp v209, v73, v187 row_ror:2 row_mask:0xf bank_mask:0xf
  v_dot2c_f32_bf16_dpp v199, v83, v177 row_ror:2 row_mask:0xf bank_mask:0xf
  v_dot2c_f32_bf16_dpp v200, v73, v177 row_ror:2 row_mask:0xf bank_mask:0xf
  v_dot2c_f32_bf16_dpp v208, v84, v188 row_ror:2 row_mask:0xf bank_mask:0xf
  v_dot2c_f32_bf16_dpp v209, v74, v188 row_ror:2 row_mask:0xf bank_mask:0xf
  v_dot2c_f32_bf16_dpp v199, v84, v178 row_ror:2 row_mask:0xf bank_mask:0xf
  v_dot2c_f32_bf16_dpp v200, v74, v178 row_ror:2 row_mask:0xf bank_mask:0xf
  v_dot2c_f32_bf16_dpp v208, v85, v189 row_ror:2 row_mask:0xf bank_mask:0xf
  buffer_load_dwordx4 a[252:255], v95, s[16:19], s43 offen offset:0 sc1
  v_dot2c_f32_bf16_dpp v209, v75, v189 row_ror:2 row_mask:0xf bank_mask:0xf
  v_dot2c_f32_bf16_dpp v199, v85, v179 row_ror:2 row_mask:0xf bank_mask:0xf
  v_dot2c_f32_bf16_dpp v200, v75, v179 row_ror:2 row_mask:0xf bank_mask:0xf
  v_dot2c_f32_bf16_dpp v208, v86, v190 row_ror:2 row_mask:0xf bank_mask:0xf
  v_dot2c_f32_bf16_dpp v209, v76, v190 row_ror:2 row_mask:0xf bank_mask:0xf
  v_dot2c_f32_bf16_dpp v199, v86, v180 row_ror:2 row_mask:0xf bank_mask:0xf
  v_dot2c_f32_bf16_dpp v200, v76, v180 row_ror:2 row_mask:0xf bank_mask:0xf
  v_dot2c_f32_bf16_dpp v208, v87, v191 row_ror:2 row_mask:0xf bank_mask:0xf
  v_dot2c_f32_bf16_dpp v209, v77, v191 row_ror:2 row_mask:0xf bank_mask:0xf
  v_dot2c_f32_bf16_dpp v199, v87, v181 row_ror:2 row_mask:0xf bank_mask:0xf
  v_dot2c_f32_bf16_dpp v200, v77, v181 row_ror:2 row_mask:0xf bank_mask:0xf
  v_dot2c_f32_bf16_dpp v208, v88, v192 row_ror:2 row_mask:0xf bank_mask:0xf
  v_dot2c_f32_bf16_dpp v209, v78, v192 row_ror:2 row_mask:0xf bank_mask:0xf
  v_dot2c_f32_bf16_dpp v199, v88, v182 row_ror:2 row_mask:0xf bank_mask:0xf
  v_dot2c_f32_bf16_dpp v200, v78, v182 row_ror:2 row_mask:0xf bank_mask:0xf
  v_dot2c_f32_bf16_dpp v208, v89, v193 row_ror:2 row_mask:0xf bank_mask:0xf
  v_dot2c_f32_bf16_dpp v209, v79, v193 row_ror:2 row_mask:0xf bank_mask:0xf
  v_dot2c_f32_bf16_dpp v199, v89, v183 row_ror:2 row_mask:0xf bank_mask:0xf
  v_dot2c_f32_bf16_dpp v200, v79, v183 row_ror:2 row_mask:0xf bank_mask:0xf
  v_dot2c_f32_bf16_dpp v208, v90, v194 row_ror:2 row_mask:0xf bank_mask:0xf
  v_dot2c_f32_bf16_dpp v209, v80, v194 row_ror:2 row_mask:0xf bank_mask:0xf
  v_dot2c_f32_bf16_dpp v199, v90, v184 row_ror:2 row_mask:0xf bank_mask:0xf
  v_dot2c_f32_bf16_dpp v200, v80, v184 row_ror:2 row_mask:0xf bank_mask:0xf
  v_dot2c_f32_bf16_dpp v208, v91, v195 row_ror:2 row_mask:0xf bank_mask:0xf
  v_dot2c_f32_bf16_dpp v209, v81, v195 row_ror:2 row_mask:0xf bank_mask:0xf
  v_dot2c_f32_bf16_dpp v199, v91, v185 row_ror:2 row_mask:0xf bank_mask:0xf
  v_dot2c_f32_bf16_dpp v200, v81, v185 row_ror:2 row_mask:0xf bank_mask:0xf
  s_mov_b32 exec_lo, 0x20002000
  s_mov_b32 exec_hi, 0x20002000
  v_mov_b64 v[72:73], v[96:97]
  v_mov_b64 v[74:75], v[98:99]
  v_mov_b64 v[76:77], v[100:101]
  v_mov_b64 v[78:79], v[102:103]
  v_mov_b64 v[80:81], v[104:105]
  v_mov_b64 v[82:83], v[106:107]
  v_mov_b64 v[84:85], v[108:109]
  v_mov_b64 v[86:87], v[110:111]
  v_mov_b64 v[88:89], v[112:113]
  v_mov_b64 v[90:91], v[114:115]
  s_mov_b64 exec, -1
  v_dot2c_f32_bf16_dpp v210, v82, v186 row_ror:3 row_mask:0xf bank_mask:0xf
  v_dot2c_f32_bf16_dpp v211, v72, v186 row_ror:3 row_mask:0xf bank_mask:0xf
  v_dot2c_f32_bf16_dpp v201, v82, v176 row_ror:3 row_mask:0xf bank_mask:0xf
  v_dot2c_f32_bf16_dpp v202, v72, v176 row_ror:3 row_mask:0xf bank_mask:0xf
  v_dot2c_f32_bf16_dpp v210, v83, v187 row_ror:3 row_mask:0xf bank_mask:0xf
  v_dot2c_f32_bf16_dpp v211, v73, v187 row_ror:3 row_mask:0xf bank_mask:0xf
  v_dot2c_f32_bf16_dpp v201, v83, v177 row_ror:3 row_mask:0xf bank_mask:0xf
  v_dot2c_f32_bf16_dpp v202, v73, v177 row_ror:3 row_mask:0xf bank_mask:0xf
  v_dot2c_f32_bf16_dpp v210, v84, v188 row_ror:3 row_mask:0xf bank_mask:0xf
  v_dot2c_f32_bf16_dpp v211, v74, v188 row_ror:3 row_mask:0xf bank_mask:0xf
  v_dot2c_f32_bf16_dpp v201, v84, v178 row_ror:3 row_mask:0xf bank_mask:0xf
  v_dot2c_f32_bf16_dpp v202, v74, v178 row_ror:3 row_mask:0xf bank_mask:0xf
  v_dot2c_f32_bf16_dpp v210, v85, v189 row_ror:3 row_mask:0xf bank_mask:0xf
  v_dot2c_f32_bf16_dpp v211, v75, v189 row_ror:3 row_mask:0xf bank_mask:0xf
  v_dot2c_f32_bf16_dpp v201, v85, v179 row_ror:3 row_mask:0xf bank_mask:0xf
  v_dot2c_f32_bf16_dpp v202, v75, v179 row_ror:3 row_mask:0xf bank_mask:0xf
  v_dot2c_f32_bf16_dpp v210, v86, v190 row_ror:3 row_mask:0xf bank_mask:0xf
  v_dot2c_f32_bf16_dpp v211, v76, v190 row_ror:3 row_mask:0xf bank_mask:0xf
  v_dot2c_f32_bf16_dpp v201, v86, v180 row_ror:3 row_mask:0xf bank_mask:0xf
  v_dot2c_f32_bf16_dpp v202, v76, v180 row_ror:3 row_mask:0xf bank_mask:0xf
  v_dot2c_f32_bf16_dpp v210, v87, v191 row_ror:3 row_mask:0xf bank_mask:0xf
  v_dot2c_f32_bf16_dpp v211, v77, v191 row_ror:3 row_mask:0xf bank_mask:0xf
  v_dot2c_f32_bf16_dpp v201, v87, v181 row_ror:3 row_mask:0xf bank_mask:0xf
  v_dot2c_f32_bf16_dpp v202, v77, v181 row_ror:3 row_mask:0xf bank_mask:0xf
  v_dot2c_f32_bf16_dpp v210, v88, v192 row_ror:3 row_mask:0xf bank_mask:0xf
  v_dot2c_f32_bf16_dpp v211, v78, v192 row_ror:3 row_mask:0xf bank_mask:0xf
  v_dot2c_f32_bf16_dpp v201, v88, v182 row_ror:3 row_mask:0xf bank_mask:0xf
  v_dot2c_f32_bf16_dpp v202, v78, v182 row_ror:3 row_mask:0xf bank_mask:0xf
  v_dot2c_f32_bf16_dpp v210, v89, v193 row_ror:3 row_mask:0xf bank_mask:0xf
  v_dot2c_f32_bf16_dpp v211, v79, v193 row_ror:3 row_mask:0xf bank_mask:0xf
  v_dot2c_f32_bf16_dpp v201, v89, v183 row_ror:3 row_mask:0xf bank_mask:0xf
  v_dot2c_f32_bf16_dpp v202, v79, v183 row_ror:3 row_mask:0xf bank_mask:0xf
  v_dot2c_f32_bf16_dpp v210, v90, v194 row_ror:3 row_mask:0xf bank_mask:0xf
  v_dot2c_f32_bf16_dpp v211, v80, v194 row_ror:3 row_mask:0xf bank_mask:0xf
  v_dot2c_f32_bf16_dpp v201, v90, v184 row_ror:3 row_mask:0xf bank_mask:0xf
  v_dot2c_f32_bf16_dpp v202, v80, v184 row_ror:3 row_mask:0xf bank_mask:0xf
  v_dot2c_f32_bf16_dpp v210, v91, v195 row_ror:3 row_mask:0xf bank_mask:0xf
  v_dot2c_f32_bf16_dpp v211, v81, v195 row_ror:3 row_mask:0xf bank_mask:0xf
  v_dot2c_f32_bf16_dpp v201, v91, v185 row_ror:3 row_mask:0xf bank_mask:0xf
  v_dot2c_f32_bf16_dpp v202, v81, v185 row_ror:3 row_mask:0xf bank_mask:0xf
  s_mov_b32 exec_lo, 0x10001000
  s_mov_b32 exec_hi, 0x10001000
  v_mov_b64 v[82:83], v[106:107]
  v_mov_b64 v[84:85], v[108:109]
  v_mov_b64 v[86:87], v[110:111]
  v_mov_b64 v[88:89], v[112:113]
  v_mov_b64 v[90:91], v[114:115]
  s_mov_b64 exec, -1
  v_dot2c_f32_bf16_dpp v203, v82, v176 row_ror:4 row_mask:0xf bank_mask:0xf
  s_nop 1
  v_dot2c_f32_bf16_dpp v203, v83, v177 row_ror:4 row_mask:0xf bank_mask:0xf
  s_nop 1
  v_dot2c_f32_bf16_dpp v203, v84, v178 row_ror:4 row_mask:0xf bank_mask:0xf
  s_nop 1
  v_dot2c_f32_bf16_dpp v203, v85, v179 row_ror:4 row_mask:0xf bank_mask:0xf
  s_nop 1
  v_dot2c_f32_bf16_dpp v203, v86, v180 row_ror:4 row_mask:0xf bank_mask:0xf
  s_nop 1
  v_dot2c_f32_bf16_dpp v203, v87, v181 row_ror:4 row_mask:0xf bank_mask:0xf
  s_nop 1
  v_dot2c_f32_bf16_dpp v203, v88, v182 row_ror:4 row_mask:0xf bank_mask:0xf
  s_nop 1
  v_dot2c_f32_bf16_dpp v203, v89, v183 row_ror:4 row_mask:0xf bank_mask:0xf
  s_nop 1
  v_dot2c_f32_bf16_dpp v203, v90, v184 row_ror:4 row_mask:0xf bank_mask:0xf
  s_nop 1
  v_dot2c_f32_bf16_dpp v203, v91, v185 row_ror:4 row_mask:0xf bank_mask:0xf
  v_mul_f32 v196, v196, v144
  v_mul_f32 v197, v197, v143
  v_mul_f32 v198, v198, v142
  v_mul_f32 v199, v199, v141
  v_mul_f32 v200, v200, v140
  v_mul_f32 v201, v201, v139
  v_mul_f32 v202, v202, v138
  v_mul_f32 v203, v203, v137
  v_mul_f32 v204, v204, v145
  v_mul_f32 v205, v205, v144
  v_mul_f32 v206, v206, v143
  v_mul_f32 v207, v207, v142
  v_mul_f32 v208, v208, v141
  v_mul_f32 v209, v209, v140
  v_mul_f32 v210, v210, v139
  v_mul_f32 v211, v211, v138
  s_cmp_lg_u32 s54, -8
  s_cbranch_scc1 L_nomask
  v_and_b32 v146, 15, v1
  v_lshlrev_b32 v146, 1, v146
  v_mov_b32 v147, 0xf149f2ca
  v_cmp_gt_u32 vcc, 9, v146
  s_nop 1
  v_cndmask_b32 v197, v197, v147, vcc
  v_cmp_gt_u32 vcc, 10, v146
  s_nop 1
  v_cndmask_b32 v198, v198, v147, vcc
  v_cmp_gt_u32 vcc, 11, v146
  s_nop 1
  v_cndmask_b32 v199, v199, v147, vcc
  v_cmp_gt_u32 vcc, 12, v146
  s_nop 1
  v_cndmask_b32 v200, v200, v147, vcc
  v_cmp_gt_u32 vcc, 13, v146
  s_nop 1
  v_cndmask_b32 v201, v201, v147, vcc
  v_cmp_gt_u32 vcc, 14, v146
  s_nop 1
  v_cndmask_b32 v202, v202, v147, vcc
  v_cmp_gt_u32 vcc, 15, v146
  s_nop 1
  v_cndmask_b32 v203, v203, v147, vcc
  v_cmp_gt_u32 vcc, 8, v146
  s_nop 1
  v_cndmask_b32 v205, v205, v147, vcc
  v_cmp_gt_u32 vcc, 9, v146
  s_nop 1
  v_cndmask_b32 v206, v206, v147, vcc
  v_cmp_gt_u32 vcc, 10, v146
  s_nop 1
  v_cndmask_b32 v207, v207, v147, vcc
  v_cmp_gt_u32 vcc, 11, v146
  s_nop 1
  v_cndmask_b32 v208, v208, v147, vcc
  v_cmp_gt_u32 vcc, 12, v146
  s_nop 1
  v_cndmask_b32 v209, v209, v147, vcc
  v_cmp_gt_u32 vcc, 13, v146
  s_nop 1
  v_cndmask_b32 v210, v210, v147, vcc
  v_cmp_gt_u32 vcc, 14, v146
  s_nop 1
  v_cndmask_b32 v211, v211, v147, vcc
  s_nop 4
L_nomask:
  v_mul_f32 v146, 0x3ea52b5c, v144
  v_max3_f32 v148, v196, v197, v198
  v_mul_f32 v147, 0x3ea52b5c, v145
  v_max3_f32 v149, v204, v205, v206
  v_max3_f32 v148, v148, v199, v200
  v_max3_f32 v149, v149, v207, v208
  v_max3_f32 v148, v148, v201, v202
  v_max3_f32 v149, v149, v209, v210
  v_max_f32 v148, v148, v203
  v_max_f32 v149, v149, v211
  v_mul_f32 v148, v148, v146
  v_mul_f32 v149, v149, v147
  v_fma_f32 v196, v196, v146, -v148
  v_fma_f32 v204, v204, v147, -v149
  v_fma_f32 v197, v197, v146, -v148
  v_fma_f32 v205, v205, v147, -v149
  v_fma_f32 v198, v198, v146, -v148
  v_fma_f32 v206, v206, v147, -v149
  v_fma_f32 v199, v199, v146, -v148
  v_fma_f32 v207, v207, v147, -v149
  v_fma_f32 v200, v200, v146, -v148
  v_fma_f32 v208, v208, v147, -v149
  v_fma_f32 v201, v201, v146, -v148
  v_fma_f32 v209, v209, v147, -v149
  v_fma_f32 v202, v202, v146, -v148
  v_fma_f32 v210, v210, v147, -v149
  v_fma_f32 v203, v203, v146, -v148
  v_fma_f32 v211, v211, v147, -v149
  v_exp_f32 v196, v196
  v_exp_f32 v204, v204
  v_exp_f32 v197, v197
  v_exp_f32 v205, v205
  v_exp_f32 v198, v198
  v_exp_f32 v206, v206
  v_exp_f32 v199, v199
  v_exp_f32 v207, v207
  v_exp_f32 v200, v200
  v_exp_f32 v208, v208
  v_exp_f32 v201, v201
  v_exp_f32 v209, v209
  v_exp_f32 v202, v202
  v_exp_f32 v210, v210
  v_exp_f32 v203, v203
  v_exp_f32 v211, v211
  v_add_f32 v146, v196, v197
  v_add_f32 v148, v198, v199
  v_add_f32 v147, v204, v205
  v_add_f32 v149, v206, v207
  v_add_f32 v146, v146, v200
  v_add_f32 v148, v148, v201
  v_add_f32 v147, v147, v208
  v_add_f32 v149, v149, v209
  v_add_f32 v146, v146, v202
  v_add_f32 v148, v148, v203
  v_add_f32 v147, v147, v210
  v_add_f32 v149, v149, v211
  v_add_f32 v146, v146, v148
  v_add_f32 v147, v147, v149
  v_rcp_f32 v146, v146
  v_rcp_f32 v147, v147
  v_mul_f32 v196, v196, v144
  v_mul_f32 v204, v204, v145
  v_mul_f32 v197, v197, v143
  v_mul_f32 v205, v205, v144
  v_mul_f32 v198, v198, v142
  v_mul_f32 v206, v206, v143
  v_mul_f32 v199, v199, v141
  v_mul_f32 v207, v207, v142
  v_mul_f32 v200, v200, v140
  v_mul_f32 v208, v208, v141
  v_mul_f32 v201, v201, v139
  v_mul_f32 v209, v209, v140
  v_mul_f32 v202, v202, v138
  v_mul_f32 v210, v210, v139
  v_mul_f32 v203, v203, v137
  v_mul_f32 v211, v211, v138
  v_mul_f32 v196, v196, v146
  v_mul_f32 v204, v204, v147
  v_mul_f32 v197, v197, v146
  v_mul_f32 v205, v205, v147
  v_mul_f32 v198, v198, v146
  v_mul_f32 v206, v206, v147
  v_mul_f32 v199, v199, v146
  v_mul_f32 v207, v207, v147
  v_mul_f32 v200, v200, v146
  v_mul_f32 v208, v208, v147
  v_mul_f32 v201, v201, v146
  v_mul_f32 v209, v209, v147
  v_mul_f32 v202, v202, v146
  v_mul_f32 v210, v210, v147
  v_mul_f32 v203, v203, v146
  v_mul_f32 v211, v211, v147
  v_cvt_pk_bf16_f32 v212, v205, v204
  v_cvt_pk_bf16_f32 v213, v207, v206
  v_cvt_pk_bf16_f32 v214, v209, v208
  v_cvt_pk_bf16_f32 v215, v211, v210
  v_cvt_pk_bf16_f32 v216, v196, 0
  v_cvt_pk_bf16_f32 v217, v198, v197
  v_cvt_pk_bf16_f32 v218, v200, v199
  v_cvt_pk_bf16_f32 v219, v202, v201
  v_cvt_pk_bf16_f32 v220, 0, v203
  s_lshr_b32 s72, s100, 4
  s_and_b32 s73, s100, 15
  s_lshr_b32 s74, s73, 1
  s_lshl_b32 s75, s72, 3
  s_add_u32 s75, s75, s74
  s_mul_i32 s72, s72, 9
  s_add_u32 s72, s72, s74
  s_add_u32 s72, s72, 16
  s_and_b32 s73, s73, 1
  s_add_u32 s73, s73, s72
  v_mov_b32 v6, s73
  v_mov_b32 v7, s72
  v_cmp_gt_u32 vcc, 16, v1
  s_nop 1
  v_cndmask_b32 v6, v6, v7, vcc
  v_mov_b32 v7, s75
  v_cmp_gt_u32 vcc, 8, v1
  s_nop 1
  v_cndmask_b32 v6, v6, v7, vcc
  v_and_b32 v7, 7, v1
  v_lshlrev_b32 v7, 7, v7
  v_lshl_add_u32 v6, v6, 10, v7
  v_bfe_u32 v150, v1, 2, 2
  v_and_b32 v151, 3, v1
  v_lshl_add_u32 v150, v150, 3, v151
  v_add_u32 v150, s54, v150
  s_lshl_b32 s41, s21, 6
  v_lshrrev_b32 v151, 4, v150
  v_add_u32 v151, s41, v151
  v_mul_u32_u24 v151, 75776, v151
  v_and_b32 v152, 15, v150
  v_lshl_add_u32 v151, v152, 4, v151
  s_movk_i32 s41, 1024
  v_cmp_gt_u32 vcc, s41, v150
  v_bfrev_b32 v152, 1
  s_nop 0
  v_cndmask_b32 v151, v152, v151, vcc
  v_cmp_gt_u32 vcc, 4, v0
  v_and_b32 v153, 0xcf, v0
  v_cmp_gt_u32 vcc, 4, v153
  s_nop 1
  v_cndmask_b32 v151, v151, v152, vcc
  v_lshrrev_b32 v153, 4, v1
  v_lshl_add_u32 v154, v153, 8, v151
  v_lshrrev_b32 v155, 1, v153
  v_lshl_add_u32 v155, v155, 8, v151
  v_and_b32 v153, 1, v153
  v_lshl_add_u32 v155, v153, 3, v155
  s_lshr_b32 s41, s23, 1
  s_mul_i32 s41, s41, 5
  s_add_u32 s41, s41, 54
  s_lshl_b32 s41, s41, 10
  s_and_b32 s42, s23, 1
  s_lshl_b32 s74, s42, 11
  s_add_u32 s74, s74, s41
  s_lshl_b32 s42, s42, 9
  s_add_u32 s41, s41, s42
  s_add_u32 s41, s41, 4096
  v_dot2_f32_bf16 v52, v12, v212, 0
  v_dot2_f32_bf16 v32, v12, v216, 0
  v_dot2_f32_bf16 v53, v13, v212, 0
  v_dot2_f32_bf16 v33, v13, v216, 0
  v_dot2_f32_bf16 v54, v14, v212, 0
  v_dot2_f32_bf16 v34, v14, v216, 0
  v_dot2_f32_bf16 v55, v15, v212, 0
  v_dot2_f32_bf16 v35, v15, v216, 0
  v_dot2_f32_bf16 v56, v16, v212, 0
  v_dot2_f32_bf16 v36, v16, v216, 0
  v_dot2_f32_bf16 v57, v17, v212, 0
  v_dot2_f32_bf16 v37, v17, v216, 0
  v_dot2_f32_bf16 v58, v18, v212, 0
  v_dot2_f32_bf16 v38, v18, v216, 0
  v_dot2_f32_bf16 v59, v19, v212, 0
  v_dot2_f32_bf16 v39, v19, v216, 0
  v_dot2_f32_bf16 v60, v20, v212, 0
  v_dot2_f32_bf16 v40, v20, v216, 0
  v_dot2_f32_bf16 v61, v21, v212, 0
  v_dot2_f32_bf16 v41, v21, v216, 0
  v_dot2_f32_bf16 v62, v22, v212, 0
  v_dot2_f32_bf16 v42, v22, v216, 0
  v_dot2_f32_bf16 v63, v23, v212, 0
  v_dot2_f32_bf16 v43, v23, v216, 0
  v_dot2_f32_bf16 v64, v24, v212, 0
  v_dot2_f32_bf16 v44, v24, v216, 0
  v_dot2_f32_bf16 v65, v25, v212, 0
  v_dot2_f32_bf16 v45, v25, v216, 0
  v_dot2_f32_bf16 v66, v26, v212, 0
  v_dot2_f32_bf16 v46, v26, v216, 0
  v_dot2_f32_bf16 v67, v27, v212, 0
  v_dot2_f32_bf16 v47, v27, v216, 0
  v_dot2_f32_bf16 v68, v28, v212, 0
  v_dot2_f32_bf16 v48, v28, v216, 0
  v_dot2_f32_bf16 v69, v29, v212, 0
  v_dot2_f32_bf16 v49, v29, v216, 0
  v_dot2_f32_bf16 v70, v30, v212, 0
  v_dot2_f32_bf16 v50, v30, v216, 0
  v_dot2_f32_bf16 v71, v31, v212, 0
  v_dot2_f32_bf16 v51, v31, v216, 0
  s_mov_b32 exec_lo, 0x80008000
  s_mov_b32 exec_hi, 0x80008000
  v_mov_b64 v[12:13], v[116:117]
  v_mov_b64 v[14:15], v[118:119]
  v_mov_b64 v[16:17], v[120:121]
  v_mov_b64 v[18:19], v[122:123]
  v_mov_b64 v[20:21], v[124:125]
  v_mov_b64 v[22:23], v[126:127]
  v_mov_b64 v[24:25], v[128:129]
  v_mov_b64 v[26:27], v[130:131]
  v_mov_b64 v[28:29], v[132:133]
  v_mov_b64 v[30:31], v[134:135]
  s_mov_b64 exec, -1
  v_dot2c_f32_bf16_dpp v52, v12, v213 row_ror:1 row_mask:0xf bank_mask:0xf
  v_dot2c_f32_bf16_dpp v32, v12, v217 row_ror:1 row_mask:0xf bank_mask:0xf
  v_dot2c_f32_bf16_dpp v53, v13, v213 row_ror:1 row_mask:0xf bank_mask:0xf
  v_dot2c_f32_bf16_dpp v33, v13, v217 row_ror:1 row_mask:0xf bank_mask:0xf
  v_dot2c_f32_bf16_dpp v54, v14, v213 row_ror:1 row_mask:0xf bank_mask:0xf
  v_dot2c_f32_bf16_dpp v34, v14, v217 row_ror:1 row_mask:0xf bank_mask:0xf
  v_dot2c_f32_bf16_dpp v55, v15, v213 row_ror:1 row_mask:0xf bank_mask:0xf
  v_dot2c_f32_bf16_dpp v35, v15, v217 row_ror:1 row_mask:0xf bank_mask:0xf
  v_dot2c_f32_bf16_dpp v56, v16, v213 row_ror:1 row_mask:0xf bank_mask:0xf
  v_dot2c_f32_bf16_dpp v36, v16, v217 row_ror:1 row_mask:0xf bank_mask:0xf
  v_dot2c_f32_bf16_dpp v57, v17, v213 row_ror:1 row_mask:0xf bank_mask:0xf
  v_dot2c_f32_bf16_dpp v37, v17, v217 row_ror:1 row_mask:0xf bank_mask:0xf
  v_dot2c_f32_bf16_dpp v58, v18, v213 row_ror:1 row_mask:0xf bank_mask:0xf
  v_dot2c_f32_bf16_dpp v38, v18, v217 row_ror:1 row_mask:0xf bank_mask:0xf
  v_dot2c_f32_bf16_dpp v59, v19, v213 row_ror:1 row_mask:0xf bank_mask:0xf
  v_dot2c_f32_bf16_dpp v39, v19, v217 row_ror:1 row_mask:0xf bank_mask:0xf
  v_dot2c_f32_bf16_dpp v60, v20, v213 row_ror:1 row_mask:0xf bank_mask:0xf
  v_dot2c_f32_bf16_dpp v40, v20, v217 row_ror:1 row_mask:0xf bank_mask:0xf
  v_dot2c_f32_bf16_dpp v61, v21, v213 row_ror:1 row_mask:0xf bank_mask:0xf
  v_dot2c_f32_bf16_dpp v41, v21, v217 row_ror:1 row_mask:0xf bank_mask:0xf
  v_dot2c_f32_bf16_dpp v62, v22, v213 row_ror:1 row_mask:0xf bank_mask:0xf
  v_dot2c_f32_bf16_dpp v42, v22, v217 row_ror:1 row_mask:0xf bank_mask:0xf
  v_dot2c_f32_bf16_dpp v63, v23, v213 row_ror:1 row_mask:0xf bank_mask:0xf
  v_dot2c_f32_bf16_dpp v43, v23, v217 row_ror:1 row_mask:0xf bank_mask:0xf
  v_dot2c_f32_bf16_dpp v64, v24, v213 row_ror:1 row_mask:0xf bank_mask:0xf
  v_dot2c_f32_bf16_dpp v44, v24, v217 row_ror:1 row_mask:0xf bank_mask:0xf
  v_dot2c_f32_bf16_dpp v65, v25, v213 row_ror:1 row_mask:0xf bank_mask:0xf
  v_dot2c_f32_bf16_dpp v45, v25, v217 row_ror:1 row_mask:0xf bank_mask:0xf
  v_dot2c_f32_bf16_dpp v66, v26, v213 row_ror:1 row_mask:0xf bank_mask:0xf
  v_dot2c_f32_bf16_dpp v46, v26, v217 row_ror:1 row_mask:0xf bank_mask:0xf
  v_dot2c_f32_bf16_dpp v67, v27, v213 row_ror:1 row_mask:0xf bank_mask:0xf
  v_dot2c_f32_bf16_dpp v47, v27, v217 row_ror:1 row_mask:0xf bank_mask:0xf
  v_dot2c_f32_bf16_dpp v68, v28, v213 row_ror:1 row_mask:0xf bank_mask:0xf
  v_dot2c_f32_bf16_dpp v48, v28, v217 row_ror:1 row_mask:0xf bank_mask:0xf
  v_dot2c_f32_bf16_dpp v69, v29, v213 row_ror:1 row_mask:0xf bank_mask:0xf
  v_dot2c_f32_bf16_dpp v49, v29, v217 row_ror:1 row_mask:0xf bank_mask:0xf
  v_dot2c_f32_bf16_dpp v70, v30, v213 row_ror:1 row_mask:0xf bank_mask:0xf
  v_dot2c_f32_bf16_dpp v50, v30, v217 row_ror:1 row_mask:0xf bank_mask:0xf
  v_dot2c_f32_bf16_dpp v71, v31, v213 row_ror:1 row_mask:0xf bank_mask:0xf
  v_dot2c_f32_bf16_dpp v51, v31, v217 row_ror:1 row_mask:0xf bank_mask:0xf
  s_mov_b32 exec_lo, 0x40004000
  s_mov_b32 exec_hi, 0x40004000
  v_mov_b64 v[12:13], v[116:117]
  v_mov_b64 v[14:15], v[118:119]
  v_mov_b64 v[16:17], v[120:121]
  v_mov_b64 v[18:19], v[122:123]
  v_mov_b64 v[20:21], v[124:125]
  v_mov_b64 v[22:23], v[126:127]
  v_mov_b64 v[24:25], v[128:129]
  v_mov_b64 v[26:27], v[130:131]
  v_mov_b64 v[28:29], v[132:133]
  v_mov_b64 v[30:31], v[134:135]
  s_mov_b64 exec, -1
  v_dot2c_f32_bf16_dpp v52, v12, v214 row_ror:2 row_mask:0xf bank_mask:0xf
  v_dot2c_f32_bf16_dpp v32, v12, v218 row_ror:2 row_mask:0xf bank_mask:0xf
  v_dot2c_f32_bf16_dpp v53, v13, v214 row_ror:2 row_mask:0xf bank_mask:0xf
  v_dot2c_f32_bf16_dpp v33, v13, v218 row_ror:2 row_mask:0xf bank_mask:0xf
  v_dot2c_f32_bf16_dpp v54, v14, v214 row_ror:2 row_mask:0xf bank_mask:0xf
  v_dot2c_f32_bf16_dpp v34, v14, v218 row_ror:2 row_mask:0xf bank_mask:0xf
  v_dot2c_f32_bf16_dpp v55, v15, v214 row_ror:2 row_mask:0xf bank_mask:0xf
  v_dot2c_f32_bf16_dpp v35, v15, v218 row_ror:2 row_mask:0xf bank_mask:0xf
  v_dot2c_f32_bf16_dpp v56, v16, v214 row_ror:2 row_mask:0xf bank_mask:0xf
  v_dot2c_f32_bf16_dpp v36, v16, v218 row_ror:2 row_mask:0xf bank_mask:0xf
  v_dot2c_f32_bf16_dpp v57, v17, v214 row_ror:2 row_mask:0xf bank_mask:0xf
  v_dot2c_f32_bf16_dpp v37, v17, v218 row_ror:2 row_mask:0xf bank_mask:0xf
  v_dot2c_f32_bf16_dpp v58, v18, v214 row_ror:2 row_mask:0xf bank_mask:0xf
  v_dot2c_f32_bf16_dpp v38, v18, v218 row_ror:2 row_mask:0xf bank_mask:0xf
  v_dot2c_f32_bf16_dpp v59, v19, v214 row_ror:2 row_mask:0xf bank_mask:0xf
  v_dot2c_f32_bf16_dpp v39, v19, v218 row_ror:2 row_mask:0xf bank_mask:0xf
  v_dot2c_f32_bf16_dpp v60, v20, v214 row_ror:2 row_mask:0xf bank_mask:0xf
  v_dot2c_f32_bf16_dpp v40, v20, v218 row_ror:2 row_mask:0xf bank_mask:0xf
  v_dot2c_f32_bf16_dpp v61, v21, v214 row_ror:2 row_mask:0xf bank_mask:0xf
  v_dot2c_f32_bf16_dpp v41, v21, v218 row_ror:2 row_mask:0xf bank_mask:0xf
  v_dot2c_f32_bf16_dpp v62, v22, v214 row_ror:2 row_mask:0xf bank_mask:0xf
  v_dot2c_f32_bf16_dpp v42, v22, v218 row_ror:2 row_mask:0xf bank_mask:0xf
  v_dot2c_f32_bf16_dpp v63, v23, v214 row_ror:2 row_mask:0xf bank_mask:0xf
  v_dot2c_f32_bf16_dpp v43, v23, v218 row_ror:2 row_mask:0xf bank_mask:0xf
  v_dot2c_f32_bf16_dpp v64, v24, v214 row_ror:2 row_mask:0xf bank_mask:0xf
  v_dot2c_f32_bf16_dpp v44, v24, v218 row_ror:2 row_mask:0xf bank_mask:0xf
  v_dot2c_f32_bf16_dpp v65, v25, v214 row_ror:2 row_mask:0xf bank_mask:0xf
  v_dot2c_f32_bf16_dpp v45, v25, v218 row_ror:2 row_mask:0xf bank_mask:0xf
  v_dot2c_f32_bf16_dpp v66, v26, v214 row_ror:2 row_mask:0xf bank_mask:0xf
  v_dot2c_f32_bf16_dpp v46, v26, v218 row_ror:2 row_mask:0xf bank_mask:0xf
  v_dot2c_f32_bf16_dpp v67, v27, v214 row_ror:2 row_mask:0xf bank_mask:0xf
  v_dot2c_f32_bf16_dpp v47, v27, v218 row_ror:2 row_mask:0xf bank_mask:0xf
  v_dot2c_f32_bf16_dpp v68, v28, v214 row_ror:2 row_mask:0xf bank_mask:0xf
  v_dot2c_f32_bf16_dpp v48, v28, v218 row_ror:2 row_mask:0xf bank_mask:0xf
  v_dot2c_f32_bf16_dpp v69, v29, v214 row_ror:2 row_mask:0xf bank_mask:0xf
  v_dot2c_f32_bf16_dpp v49, v29, v218 row_ror:2 row_mask:0xf bank_mask:0xf
  v_dot2c_f32_bf16_dpp v70, v30, v214 row_ror:2 row_mask:0xf bank_mask:0xf
  v_dot2c_f32_bf16_dpp v50, v30, v218 row_ror:2 row_mask:0xf bank_mask:0xf
  v_dot2c_f32_bf16_dpp v71, v31, v214 row_ror:2 row_mask:0xf bank_mask:0xf
  v_dot2c_f32_bf16_dpp v51, v31, v218 row_ror:2 row_mask:0xf bank_mask:0xf
  s_mov_b32 exec_lo, 0x20002000
  s_mov_b32 exec_hi, 0x20002000
  v_mov_b64 v[12:13], v[116:117]
  v_mov_b64 v[14:15], v[118:119]
  v_mov_b64 v[16:17], v[120:121]
  v_mov_b64 v[18:19], v[122:123]
  v_mov_b64 v[20:21], v[124:125]
  v_mov_b64 v[22:23], v[126:127]
  v_mov_b64 v[24:25], v[128:129]
  v_mov_b64 v[26:27], v[130:131]
  v_mov_b64 v[28:29], v[132:133]
  v_mov_b64 v[30:31], v[134:135]
  s_mov_b64 exec, -1
  v_dot2c_f32_bf16_dpp v52, v12, v215 row_ror:3 row_mask:0xf bank_mask:0xf
  v_dot2c_f32_bf16_dpp v32, v12, v219 row_ror:3 row_mask:0xf bank_mask:0xf
  v_dot2c_f32_bf16_dpp v53, v13, v215 row_ror:3 row_mask:0xf bank_mask:0xf
  v_dot2c_f32_bf16_dpp v33, v13, v219 row_ror:3 row_mask:0xf bank_mask:0xf
  v_dot2c_f32_bf16_dpp v54, v14, v215 row_ror:3 row_mask:0xf bank_mask:0xf
  v_dot2c_f32_bf16_dpp v34, v14, v219 row_ror:3 row_mask:0xf bank_mask:0xf
  v_dot2c_f32_bf16_dpp v55, v15, v215 row_ror:3 row_mask:0xf bank_mask:0xf
  v_dot2c_f32_bf16_dpp v35, v15, v219 row_ror:3 row_mask:0xf bank_mask:0xf
  v_dot2c_f32_bf16_dpp v56, v16, v215 row_ror:3 row_mask:0xf bank_mask:0xf
  v_dot2c_f32_bf16_dpp v36, v16, v219 row_ror:3 row_mask:0xf bank_mask:0xf
  v_dot2c_f32_bf16_dpp v57, v17, v215 row_ror:3 row_mask:0xf bank_mask:0xf
  v_dot2c_f32_bf16_dpp v37, v17, v219 row_ror:3 row_mask:0xf bank_mask:0xf
  v_dot2c_f32_bf16_dpp v58, v18, v215 row_ror:3 row_mask:0xf bank_mask:0xf
  v_dot2c_f32_bf16_dpp v38, v18, v219 row_ror:3 row_mask:0xf bank_mask:0xf
  v_dot2c_f32_bf16_dpp v59, v19, v215 row_ror:3 row_mask:0xf bank_mask:0xf
  v_dot2c_f32_bf16_dpp v39, v19, v219 row_ror:3 row_mask:0xf bank_mask:0xf
  v_dot2c_f32_bf16_dpp v60, v20, v215 row_ror:3 row_mask:0xf bank_mask:0xf
  v_dot2c_f32_bf16_dpp v40, v20, v219 row_ror:3 row_mask:0xf bank_mask:0xf
  v_dot2c_f32_bf16_dpp v61, v21, v215 row_ror:3 row_mask:0xf bank_mask:0xf
  v_dot2c_f32_bf16_dpp v41, v21, v219 row_ror:3 row_mask:0xf bank_mask:0xf
  v_dot2c_f32_bf16_dpp v62, v22, v215 row_ror:3 row_mask:0xf bank_mask:0xf
  v_dot2c_f32_bf16_dpp v42, v22, v219 row_ror:3 row_mask:0xf bank_mask:0xf
  v_dot2c_f32_bf16_dpp v63, v23, v215 row_ror:3 row_mask:0xf bank_mask:0xf
  v_dot2c_f32_bf16_dpp v43, v23, v219 row_ror:3 row_mask:0xf bank_mask:0xf
  v_dot2c_f32_bf16_dpp v64, v24, v215 row_ror:3 row_mask:0xf bank_mask:0xf
  v_dot2c_f32_bf16_dpp v44, v24, v219 row_ror:3 row_mask:0xf bank_mask:0xf
  v_dot2c_f32_bf16_dpp v65, v25, v215 row_ror:3 row_mask:0xf bank_mask:0xf
  v_dot2c_f32_bf16_dpp v45, v25, v219 row_ror:3 row_mask:0xf bank_mask:0xf
  v_dot2c_f32_bf16_dpp v66, v26, v215 row_ror:3 row_mask:0xf bank_mask:0xf
  v_dot2c_f32_bf16_dpp v46, v26, v219 row_ror:3 row_mask:0xf bank_mask:0xf
  v_dot2c_f32_bf16_dpp v67, v27, v215 row_ror:3 row_mask:0xf bank_mask:0xf
  v_dot2c_f32_bf16_dpp v47, v27, v219 row_ror:3 row_mask:0xf bank_mask:0xf
  v_dot2c_f32_bf16_dpp v68, v28, v215 row_ror:3 row_mask:0xf bank_mask:0xf
  v_dot2c_f32_bf16_dpp v48, v28, v219 row_ror:3 row_mask:0xf bank_mask:0xf
  v_dot2c_f32_bf16_dpp v69, v29, v215 row_ror:3 row_mask:0xf bank_mask:0xf
  v_dot2c_f32_bf16_dpp v49, v29, v219 row_ror:3 row_mask:0xf bank_mask:0xf
  v_dot2c_f32_bf16_dpp v70, v30, v215 row_ror:3 row_mask:0xf bank_mask:0xf
  v_dot2c_f32_bf16_dpp v50, v30, v219 row_ror:3 row_mask:0xf bank_mask:0xf
  v_dot2c_f32_bf16_dpp v71, v31, v215 row_ror:3 row_mask:0xf bank_mask:0xf
  v_dot2c_f32_bf16_dpp v51, v31, v219 row_ror:3 row_mask:0xf bank_mask:0xf
  s_mov_b64 exec, 0x7f
  buffer_load_dword v8, v6, s[56:59], 0 offen sc1
  s_mov_b64 exec, -1
  v_cvt_pk_bf16_f32 v72, v52, v53
  v_cvt_pk_bf16_f32 v73, v54, v55
  v_cvt_pk_bf16_f32 v74, v56, v57
  v_cvt_pk_bf16_f32 v75, v58, v59
  v_cvt_pk_bf16_f32 v76, v60, v61
  v_cvt_pk_bf16_f32 v77, v62, v63
  v_cvt_pk_bf16_f32 v78, v64, v65
  v_cvt_pk_bf16_f32 v79, v66, v67
  v_cvt_pk_bf16_f32 v80, v68, v69
  v_cvt_pk_bf16_f32 v81, v70, v71
  buffer_store_dwordx4 v[72:75], v154, s[12:15], s74 offen offset:64 sc1
  buffer_store_dwordx4 v[76:79], v154, s[12:15], s74 offen offset:1088 sc1
  buffer_store_dwordx2 v[80:81], v155, s[12:15], s41 offen offset:64 sc1
  s_mov_b32 exec_lo, 0x10001000
  s_mov_b32 exec_hi, 0x10001000
  v_mov_b64 v[12:13], v[116:117]
  v_mov_b64 v[14:15], v[118:119]
  v_mov_b64 v[16:17], v[120:121]
  v_mov_b64 v[18:19], v[122:123]
  v_mov_b64 v[20:21], v[124:125]
  v_mov_b64 v[22:23], v[126:127]
  v_mov_b64 v[24:25], v[128:129]
  v_mov_b64 v[26:27], v[130:131]
  v_mov_b64 v[28:29], v[132:133]
  v_mov_b64 v[30:31], v[134:135]
  s_mov_b64 exec, -1
  v_dot2c_f32_bf16_dpp v32, v12, v220 row_ror:4 row_mask:0xf bank_mask:0xf
  v_dot2c_f32_bf16_dpp v33, v13, v220 row_ror:4 row_mask:0xf bank_mask:0xf
  v_dot2c_f32_bf16_dpp v34, v14, v220 row_ror:4 row_mask:0xf bank_mask:0xf
  v_dot2c_f32_bf16_dpp v35, v15, v220 row_ror:4 row_mask:0xf bank_mask:0xf
  v_dot2c_f32_bf16_dpp v36, v16, v220 row_ror:4 row_mask:0xf bank_mask:0xf
  v_dot2c_f32_bf16_dpp v37, v17, v220 row_ror:4 row_mask:0xf bank_mask:0xf
  v_dot2c_f32_bf16_dpp v38, v18, v220 row_ror:4 row_mask:0xf bank_mask:0xf
  v_dot2c_f32_bf16_dpp v39, v19, v220 row_ror:4 row_mask:0xf bank_mask:0xf
  v_dot2c_f32_bf16_dpp v40, v20, v220 row_ror:4 row_mask:0xf bank_mask:0xf
  v_dot2c_f32_bf16_dpp v41, v21, v220 row_ror:4 row_mask:0xf bank_mask:0xf
  v_dot2c_f32_bf16_dpp v42, v22, v220 row_ror:4 row_mask:0xf bank_mask:0xf
  v_dot2c_f32_bf16_dpp v43, v23, v220 row_ror:4 row_mask:0xf bank_mask:0xf
  v_dot2c_f32_bf16_dpp v44, v24, v220 row_ror:4 row_mask:0xf bank_mask:0xf
  v_dot2c_f32_bf16_dpp v45, v25, v220 row_ror:4 row_mask:0xf bank_mask:0xf
  v_dot2c_f32_bf16_dpp v46, v26, v220 row_ror:4 row_mask:0xf bank_mask:0xf
  v_dot2c_f32_bf16_dpp v47, v27, v220 row_ror:4 row_mask:0xf bank_mask:0xf
  v_dot2c_f32_bf16_dpp v48, v28, v220 row_ror:4 row_mask:0xf bank_mask:0xf
  v_dot2c_f32_bf16_dpp v49, v29, v220 row_ror:4 row_mask:0xf bank_mask:0xf
  v_dot2c_f32_bf16_dpp v50, v30, v220 row_ror:4 row_mask:0xf bank_mask:0xf
  v_dot2c_f32_bf16_dpp v51, v31, v220 row_ror:4 row_mask:0xf bank_mask:0xf
  v_cvt_pk_bf16_f32 v82, v32, v33
  v_cvt_pk_bf16_f32 v83, v34, v35
  v_cvt_pk_bf16_f32 v84, v36, v37
  v_cvt_pk_bf16_f32 v85, v38, v39
  v_cvt_pk_bf16_f32 v86, v40, v41
  v_cvt_pk_bf16_f32 v87, v42, v43
  v_cvt_pk_bf16_f32 v88, v44, v45
  v_cvt_pk_bf16_f32 v89, v46, v47
  v_cvt_pk_bf16_f32 v90, v48, v49
  v_cvt_pk_bf16_f32 v91, v50, v51
  buffer_store_dwordx4 v[82:85], v154, s[12:15], s74 offen sc1
  buffer_store_dwordx4 v[86:89], v154, s[12:15], s74 offen offset:1024 sc1
  buffer_store_dwordx2 v[90:91], v155, s[12:15], s41 offen sc1
  s_mul_i32 s41, s21, 9
  s_add_u32 s41, s41, s22
  s_add_u32 s41, s41, 16
  s_lshl_b32 s41, s41, 10
  s_lshl_b32 s42, s23, 7
  s_add_u32 s41, s41, s42
  s_mov_b32 s42, 1
  s_load_dwordx4 s[64:67], s[0:1], 56
  v_mov_b32 v12, v1
  s_lshr_b32 s72, s100, 2
  s_mul_i32 s72, s72, 1
  v_subrev_u32 v10, 5, v12
  v_cmp_gt_u32 vcc, 10, v12
  s_nop 1
  v_cndmask_b32 v10, v10, v12, vcc
  v_lshlrev_b32 v10, 2, v10
  v_add_u32 v10, s20, v10
  v_mul_u32_u24 v11, 147, v10
  v_lshrrev_b32 v11, 11, v11
  v_mul_u32_u24 v15, 14, v11
  v_sub_u32 v10, v10, v15
  v_add_u32 v11, s72, v11
  v_and_b32 v11, 3, v11
  v_lshrrev_b32 v15, 1, v10
  v_lshl_add_u32 v11, v15, 2, v11
  v_and_b32 v10, 1, v10
  v_cmp_eq_u32 vcc, 27, v11
  v_min_u32 v11, 26, v11
  v_lshl_add_u32 v11, v11, 1, v10
  v_lshlrev_b32 v11, 10, v11
  v_cndmask_b32 v10, 0, 1, vcc
  v_or_b32 v11, v11, v10
  s_mul_i32 s72, s20, 5
  s_add_u32 s72, s72, 44
  v_add_u32 v10, s72, v12
  v_lshlrev_b32 v10, 10, v10
  v_subrev_u32 v15, 10, v12
  v_cmp_gt_u32 vcc, 5, v15
  s_nop 1
  v_cndmask_b32 v15, v11, v10, vcc
  v_accvgpr_read_b32 v7, a35
  v_lshlrev_b32 v248, 4, v1
  v_add_u32 v249, 4096, v248
  v_add_u32 v250, 75776, v248
  v_add_u32 v251, 151552, v248
  v_add_u32 v252, 227328, v248
  s_lshr_b32 s48, s20, 1
  s_lshl_b32 s48, 0x15, s48
  s_lshl_b32 s49, s20, 1
  s_lshl_b32 s49, 0x30300, s49
  s_cmp_lt_u32 s20, 2
  s_mov_b32 s50, 0x55
  s_cselect_b32 s50, 0x6a, s50
  s_waitcnt vmcnt(6)
  s_mov_b32 s74, 0
L_plq1:
  v_sub_u32 v9, v8, v7
  v_cmp_gt_u32 vcc, 1, v9
  s_add_u32 s74, s74, 1
  s_nop 2
  s_and_b32 s72, vcc_lo, 0x7f
  s_cbranch_scc0 L_plq1_ok
  s_cmp_ge_u32 s74, 0x10000
  s_cbranch_scc1 L_plq1_ok
  s_sleep 8
  buffer_load_dword v8, v6, s[56:59], 0 offen sc1
  s_waitcnt vmcnt(0)
  s_branch L_plq1
L_plq1_ok:
  v_readlane_b32 s72, v15, 0
  s_nop 0
  s_add_u32 s72, s72, s62
  s_nop 2
  buffer_load_dwordx4 a[0:3], v248, s[12:15], s72 offen sc1
  buffer_load_dwordx4 a[4:7], v250, s[12:15], s72 offen sc1
  buffer_load_dwordx4 a[8:11], v251, s[12:15], s72 offen sc1
  buffer_load_dwordx4 a[12:15], v252, s[12:15], s72 offen sc1
  v_readlane_b32 s72, v15, 1
  s_nop 0
  s_add_u32 s72, s72, s62
  s_nop 2
  buffer_load_dwordx4 a[16:19], v248, s[12:15], s72 offen sc1
  buffer_load_dwordx4 a[20:23], v250, s[12:15], s72 offen sc1
  buffer_load_dwordx4 a[24:27], v251, s[12:15], s72 offen sc1
  buffer_load_dwordx4 a[28:31], v252, s[12:15], s72 offen sc1
  v_readlane_b32 s72, v15, 2
  s_nop 0
  s_add_u32 s72, s72, s62
  s_nop 2
  buffer_load_dwordx4 v[216:219], v248, s[12:15], s72 offen sc1
  buffer_load_dwordx4 v[220:223], v250, s[12:15], s72 offen sc1
  buffer_load_dwordx4 v[224:227], v251, s[12:15], s72 offen sc1
  buffer_load_dwordx4 v[228:231], v252, s[12:15], s72 offen sc1
  v_readlane_b32 s72, v15, 3
  s_bitcmp1_b32 s72, 0
  s_cselect_b32 s14, 0, 9699328
  s_and_b32 s72, s72, -2
  s_add_u32 s72, s72, s62
  s_nop 0
  buffer_load_dwordx4 v[232:235], v248, s[12:15], s72 offen sc1
  buffer_load_dwordx4 v[236:239], v250, s[12:15], s72 offen sc1
  buffer_load_dwordx4 v[240:243], v251, s[12:15], s72 offen sc1
  buffer_load_dwordx4 v[244:247], v252, s[12:15], s72 offen sc1
  s_waitcnt vmcnt(16)
  s_barrier
  s_mov_b32 exec_lo, s48
  s_mov_b32 exec_hi, 0
  buffer_load_dword v8, v6, s[56:59], 0 offen sc1
  s_mov_b64 exec, -1
  s_waitcnt lgkmcnt(0)
  s_mov_b32 s8, s66
  s_and_b32 s9, s67, 0xffff
  s_mov_b32 s10, 2621440
  s_mov_b32 s11, 0x20000
  s_mov_b32 s76, s64
  s_and_b32 s77, s65, 0xffff
  s_mov_b32 s78, 1280
  s_mov_b32 s79, 0x20000
  s_lshl_b32 s31, s100, 6
  s_lshl_b32 s26, s20, 4
  s_add_u32 s31, s31, s26
  s_lshr_b32 s26, s31, 10
  s_and_b32 s31, s31, 1023
  s_lshl_b32 s31, s31, 1
  s_add_u32 s26, s26, s31
  s_mul_i32 s36, s20, 21504
  s_mul_i32 s31, s101, 160
  s_waitcnt vmcnt(16)
  v_mfma_f32_16x16x32_bf16 v[16:19], a[36:39], a[0:3], 0
  v_readlane_b32 s72, v15, 4
  s_mov_b32 s14, 9699328
  s_add_u32 s72, s72, s62
  v_mfma_f32_16x16x32_bf16 v[20:23], a[40:43], a[0:3], 0
  v_mfma_f32_16x16x32_bf16 v[24:27], a[44:47], a[0:3], 0
  v_readlane_b32 s43, v15, 11
  s_nop 0
  s_mul_i32 s43, s43, 5
  s_add_u32 s43, s43, s63
  s_nop 1
  buffer_load_dwordx4 v[96:99], v248, s[16:19], s43 offen offset:0 sc1
  v_mfma_f32_16x16x32_bf16 v[28:31], a[48:51], a[0:3], 0
  v_mfma_f32_16x16x32_bf16 v[32:35], a[52:55], a[0:3], 0
  buffer_load_dwordx4 a[0:3], v248, s[12:15], s72 offen sc1
  s_waitcnt vmcnt(17)
  v_mfma_f32_16x16x32_bf16 v[36:39], a[36:39], a[4:7], 0
  v_mfma_f32_16x16x32_bf16 v[40:43], a[40:43], a[4:7], 0
  v_mfma_f32_16x16x32_bf16 v[44:47], a[44:47], a[4:7], 0
  buffer_load_dwordx4 v[100:103], v248, s[16:19], s43 offen offset:1024 sc1
  v_mfma_f32_16x16x32_bf16 v[48:51], a[48:51], a[4:7], 0
  v_mfma_f32_16x16x32_bf16 v[52:55], a[52:55], a[4:7], 0
  buffer_load_dwordx4 a[4:7], v250, s[12:15], s72 offen sc1
  s_waitcnt vmcnt(18)
  v_mfma_f32_16x16x32_bf16 v[56:59], a[36:39], a[8:11], 0
  v_mfma_f32_16x16x32_bf16 v[60:63], a[40:43], a[8:11], 0
  v_mfma_f32_16x16x32_bf16 v[64:67], a[44:47], a[8:11], 0
  buffer_load_dwordx4 v[104:107], v248, s[16:19], s43 offen offset:2048 sc1
  v_mfma_f32_16x16x32_bf16 v[68:71], a[48:51], a[8:11], 0
  v_mfma_f32_16x16x32_bf16 v[72:75], a[52:55], a[8:11], 0
  buffer_load_dwordx4 a[8:11], v251, s[12:15], s72 offen sc1
  s_waitcnt vmcnt(19)
  v_mfma_f32_16x16x32_bf16 v[76:79], a[36:39], a[12:15], 0
  v_mfma_f32_16x16x32_bf16 v[80:83], a[40:43], a[12:15], 0
  v_mfma_f32_16x16x32_bf16 v[84:87], a[44:47], a[12:15], 0
  buffer_load_dwordx4 v[108:111], v248, s[16:19], s43 offen offset:3072 sc1
  v_mfma_f32_16x16x32_bf16 v[88:91], a[48:51], a[12:15], 0
  v_mfma_f32_16x16x32_bf16 v[92:95], a[52:55], a[12:15], 0
  buffer_load_dwordx4 a[12:15], v252, s[12:15], s72 offen sc1
  v_accvgpr_read_b32 v11, a35
  v_mov_b32 v10, 0x40000000
  v_cmp_eq_u32 vcc, 0, v1
  v_readlane_b32 s72, v11, 24
  s_cmp_eq_u32 s20, 0
  s_cselect_b32 s41, s41, 0x40000000
  v_mov_b32 v11, s41
  v_cndmask_b32 v10, v10, v11, vcc
  s_add_u32 s72, s72, s42
  v_mov_b32 v11, s72
  buffer_store_dword v11, v10, s[56:59], 0 offen sc1
  s_waitcnt vmcnt(21)
  v_mfma_f32_16x16x32_bf16 v[16:19], a[56:59], a[16:19], v[16:19]
  v_readlane_b32 s72, v15, 5
  s_nop 0
  s_add_u32 s72, s72, s62
  v_mfma_f32_16x16x32_bf16 v[20:23], a[60:63], a[16:19], v[20:23]
  v_mfma_f32_16x16x32_bf16 v[24:27], a[64:67], a[16:19], v[24:27]
  buffer_load_dwordx4 v[112:115], v249, s[16:19], s43 offen offset:0 sc1
  v_mfma_f32_16x16x32_bf16 v[28:31], a[68:71], a[16:19], v[28:31]
  v_mfma_f32_16x16x32_bf16 v[32:35], a[72:75], a[16:19], v[32:35]
  buffer_load_dwordx4 a[16:19], v248, s[12:15], s72 offen sc1
  s_waitcnt vmcnt(22)
  v_mfma_f32_16x16x32_bf16 v[36:39], a[56:59], a[20:23], v[36:39]
  v_mfma_f32_16x16x32_bf16 v[40:43], a[60:63], a[20:23], v[40:43]
  v_mfma_f32_16x16x32_bf16 v[44:47], a[64:67], a[20:23], v[44:47]
  v_readlane_b32 s43, v15, 12
  s_nop 0
  s_mul_i32 s43, s43, 5
  s_add_u32 s43, s43, s63
  s_nop 1
  buffer_load_dwordx4 v[116:119], v248, s[16:19], s43 offen offset:0 sc1
  v_mfma_f32_16x16x32_bf16 v[48:51], a[68:71], a[20:23], v[48:51]
  v_mfma_f32_16x16x32_bf16 v[52:55], a[72:75], a[20:23], v[52:55]
  buffer_load_dwordx4 a[20:23], v250, s[12:15], s72 offen sc1
  s_waitcnt vmcnt(23)
  v_mfma_f32_16x16x32_bf16 v[56:59], a[56:59], a[24:27], v[56:59]
  v_mfma_f32_16x16x32_bf16 v[60:63], a[60:63], a[24:27], v[60:63]
  v_mfma_f32_16x16x32_bf16 v[64:67], a[64:67], a[24:27], v[64:67]
  buffer_load_dwordx4 v[120:123], v248, s[16:19], s43 offen offset:1024 sc1
  v_mfma_f32_16x16x32_bf16 v[68:71], a[68:71], a[24:27], v[68:71]
  v_mfma_f32_16x16x32_bf16 v[72:75], a[72:75], a[24:27], v[72:75]
  buffer_load_dwordx4 a[24:27], v251, s[12:15], s72 offen sc1
  s_waitcnt vmcnt(24)
  v_mfma_f32_16x16x32_bf16 v[76:79], a[56:59], a[28:31], v[76:79]
  v_mfma_f32_16x16x32_bf16 v[80:83], a[60:63], a[28:31], v[80:83]
  v_mfma_f32_16x16x32_bf16 v[84:87], a[64:67], a[28:31], v[84:87]
  buffer_load_dwordx4 v[124:127], v248, s[16:19], s43 offen offset:2048 sc1
  v_mfma_f32_16x16x32_bf16 v[88:91], a[68:71], a[28:31], v[88:91]
  v_mfma_f32_16x16x32_bf16 v[92:95], a[72:75], a[28:31], v[92:95]
  buffer_load_dwordx4 a[28:31], v252, s[12:15], s72 offen sc1
  s_waitcnt vmcnt(25)
  v_mfma_f32_16x16x32_bf16 v[16:19], a[76:79], v[216:219], v[16:19]
  v_readlane_b32 s72, v15, 6
  s_bitcmp1_b32 s72, 0
  s_cselect_b32 s14, 0, 9699328
  s_and_b32 s72, s72, -2
  s_add_u32 s72, s72, s62
  v_mfma_f32_16x16x32_bf16 v[20:23], a[80:83], v[216:219], v[20:23]
  v_mfma_f32_16x16x32_bf16 v[24:27], a[84:87], v[216:219], v[24:27]
  buffer_load_dwordx4 v[128:131], v248, s[16:19], s43 offen offset:3072 sc1
  v_mfma_f32_16x16x32_bf16 v[28:31], a[88:91], v[216:219], v[28:31]
  v_mfma_f32_16x16x32_bf16 v[32:35], a[92:95], v[216:219], v[32:35]
  buffer_load_dwordx4 v[216:219], v248, s[12:15], s72 offen sc1
  s_waitcnt vmcnt(26)
  v_mfma_f32_16x16x32_bf16 v[36:39], a[76:79], v[220:223], v[36:39]
  v_mfma_f32_16x16x32_bf16 v[40:43], a[80:83], v[220:223], v[40:43]
  v_mfma_f32_16x16x32_bf16 v[44:47], a[84:87], v[220:223], v[44:47]
  buffer_load_dwordx4 v[132:135], v249, s[16:19], s43 offen offset:0 sc1
  v_mfma_f32_16x16x32_bf16 v[48:51], a[88:91], v[220:223], v[48:51]
  v_mfma_f32_16x16x32_bf16 v[52:55], a[92:95], v[220:223], v[52:55]
  buffer_load_dwordx4 v[220:223], v250, s[12:15], s72 offen sc1
  s_waitcnt vmcnt(27)
  v_mfma_f32_16x16x32_bf16 v[56:59], a[76:79], v[224:227], v[56:59]
  v_mfma_f32_16x16x32_bf16 v[60:63], a[80:83], v[224:227], v[60:63]
  v_mfma_f32_16x16x32_bf16 v[64:67], a[84:87], v[224:227], v[64:67]
  v_readlane_b32 s43, v15, 13
  s_nop 0
  s_mul_i32 s43, s43, 5
  s_add_u32 s43, s43, s63
  s_nop 1
  buffer_load_dwordx4 v[136:139], v248, s[16:19], s43 offen offset:0 sc1
  v_mfma_f32_16x16x32_bf16 v[68:71], a[88:91], v[224:227], v[68:71]
  v_mfma_f32_16x16x32_bf16 v[72:75], a[92:95], v[224:227], v[72:75]
  buffer_load_dwordx4 v[224:227], v251, s[12:15], s72 offen sc1
  s_waitcnt vmcnt(28)
  v_mfma_f32_16x16x32_bf16 v[76:79], a[76:79], v[228:231], v[76:79]
  v_mfma_f32_16x16x32_bf16 v[80:83], a[80:83], v[228:231], v[80:83]
  v_mfma_f32_16x16x32_bf16 v[84:87], a[84:87], v[228:231], v[84:87]
  buffer_load_dwordx4 v[140:143], v248, s[16:19], s43 offen offset:1024 sc1
  v_mfma_f32_16x16x32_bf16 v[88:91], a[88:91], v[228:231], v[88:91]
  v_mfma_f32_16x16x32_bf16 v[92:95], a[92:95], v[228:231], v[92:95]
  buffer_load_dwordx4 v[228:231], v252, s[12:15], s72 offen sc1
  s_waitcnt vmcnt(25)
  s_mov_b32 s74, 0
L_plq2:
  v_sub_u32 v9, v8, v7
  v_cmp_gt_u32 vcc, 2, v9
  s_add_u32 s74, s74, 1
  s_nop 2
  s_and_b32 s72, vcc_lo, s48
  s_cbranch_scc0 L_plq2_ok
  s_cmp_ge_u32 s74, 0x10000
  s_cbranch_scc1 L_plq2_ok
  s_sleep 8
  buffer_load_dword v8, v6, s[56:59], 0 offen sc1
  s_waitcnt vmcnt(0)
  s_branch L_plq2
L_plq2_ok:
  v_mfma_f32_16x16x32_bf16 v[16:19], a[96:99], v[232:235], v[16:19]
  v_readlane_b32 s72, v15, 7
  s_mov_b32 s14, 9699328
  s_add_u32 s72, s72, s62
  v_mfma_f32_16x16x32_bf16 v[20:23], a[100:103], v[232:235], v[20:23]
  v_mfma_f32_16x16x32_bf16 v[24:27], a[104:107], v[232:235], v[24:27]
  buffer_load_dwordx4 v[144:147], v248, s[16:19], s43 offen offset:2048 sc1
  v_mfma_f32_16x16x32_bf16 v[28:31], a[108:111], v[232:235], v[28:31]
  v_mfma_f32_16x16x32_bf16 v[32:35], a[112:115], v[232:235], v[32:35]
  buffer_load_dwordx4 v[232:235], v248, s[12:15], s72 offen sc1
  v_mfma_f32_16x16x32_bf16 v[36:39], a[96:99], v[236:239], v[36:39]
  v_mfma_f32_16x16x32_bf16 v[40:43], a[100:103], v[236:239], v[40:43]
  v_mfma_f32_16x16x32_bf16 v[44:47], a[104:107], v[236:239], v[44:47]
  buffer_load_dwordx4 v[148:151], v248, s[16:19], s43 offen offset:3072 sc1
  v_mfma_f32_16x16x32_bf16 v[48:51], a[108:111], v[236:239], v[48:51]
  v_mfma_f32_16x16x32_bf16 v[52:55], a[112:115], v[236:239], v[52:55]
  buffer_load_dwordx4 v[236:239], v250, s[12:15], s72 offen sc1
  v_mfma_f32_16x16x32_bf16 v[56:59], a[96:99], v[240:243], v[56:59]
  v_mfma_f32_16x16x32_bf16 v[60:63], a[100:103], v[240:243], v[60:63]
  v_mfma_f32_16x16x32_bf16 v[64:67], a[104:107], v[240:243], v[64:67]
  buffer_load_dwordx4 v[152:155], v249, s[16:19], s43 offen offset:0 sc1
  v_mfma_f32_16x16x32_bf16 v[68:71], a[108:111], v[240:243], v[68:71]
  v_mfma_f32_16x16x32_bf16 v[72:75], a[112:115], v[240:243], v[72:75]
  buffer_load_dwordx4 v[240:243], v251, s[12:15], s72 offen sc1
  v_mfma_f32_16x16x32_bf16 v[76:79], a[96:99], v[244:247], v[76:79]
  v_mfma_f32_16x16x32_bf16 v[80:83], a[100:103], v[244:247], v[80:83]
  v_mfma_f32_16x16x32_bf16 v[84:87], a[104:107], v[244:247], v[84:87]
  v_readlane_b32 s43, v15, 14
  s_nop 0
  s_mul_i32 s43, s43, 5
  s_add_u32 s43, s43, s63
  s_nop 1
  buffer_load_dwordx4 v[156:159], v248, s[16:19], s43 offen offset:0 sc1
  v_mfma_f32_16x16x32_bf16 v[88:91], a[108:111], v[244:247], v[88:91]
  v_mfma_f32_16x16x32_bf16 v[92:95], a[112:115], v[244:247], v[92:95]
  buffer_load_dwordx4 v[244:247], v252, s[12:15], s72 offen sc1
  s_mov_b32 exec_lo, s49
  s_mov_b32 exec_hi, 0
  buffer_load_dword v8, v6, s[56:59], 0 offen sc1
  s_mov_b64 exec, -1
  s_waitcnt vmcnt(32)
  v_mfma_f32_16x16x32_bf16 v[16:19], a[116:119], a[0:3], v[16:19]
  v_readlane_b32 s72, v15, 8
  s_nop 0
  s_add_u32 s72, s72, s62
  v_mfma_f32_16x16x32_bf16 v[20:23], a[120:123], a[0:3], v[20:23]
  v_mfma_f32_16x16x32_bf16 v[24:27], a[124:127], a[0:3], v[24:27]
  buffer_load_dwordx4 v[160:163], v248, s[16:19], s43 offen offset:1024 sc1
  v_mfma_f32_16x16x32_bf16 v[28:31], a[128:131], a[0:3], v[28:31]
  v_mfma_f32_16x16x32_bf16 v[32:35], a[132:135], a[0:3], v[32:35]
  buffer_load_dwordx4 a[0:3], v248, s[12:15], s72 offen sc1
  s_waitcnt vmcnt(32)
  v_mfma_f32_16x16x32_bf16 v[36:39], a[116:119], a[4:7], v[36:39]
  v_mfma_f32_16x16x32_bf16 v[40:43], a[120:123], a[4:7], v[40:43]
  v_mfma_f32_16x16x32_bf16 v[44:47], a[124:127], a[4:7], v[44:47]
  buffer_load_dwordx4 v[164:167], v248, s[16:19], s43 offen offset:2048 sc1
  v_mfma_f32_16x16x32_bf16 v[48:51], a[128:131], a[4:7], v[48:51]
  v_mfma_f32_16x16x32_bf16 v[52:55], a[132:135], a[4:7], v[52:55]
  buffer_load_dwordx4 a[4:7], v250, s[12:15], s72 offen sc1
  s_waitcnt vmcnt(32)
  v_mfma_f32_16x16x32_bf16 v[56:59], a[116:119], a[8:11], v[56:59]
  v_mfma_f32_16x16x32_bf16 v[60:63], a[120:123], a[8:11], v[60:63]
  v_mfma_f32_16x16x32_bf16 v[64:67], a[124:127], a[8:11], v[64:67]
  buffer_load_dwordx4 v[168:171], v248, s[16:19], s43 offen offset:3072 sc1
  v_mfma_f32_16x16x32_bf16 v[68:71], a[128:131], a[8:11], v[68:71]
  v_mfma_f32_16x16x32_bf16 v[72:75], a[132:135], a[8:11], v[72:75]
  buffer_load_dwordx4 a[8:11], v251, s[12:15], s72 offen sc1
  s_waitcnt vmcnt(32)
  v_mfma_f32_16x16x32_bf16 v[76:79], a[116:119], a[12:15], v[76:79]
  v_mfma_f32_16x16x32_bf16 v[80:83], a[120:123], a[12:15], v[80:83]
  v_mfma_f32_16x16x32_bf16 v[84:87], a[124:127], a[12:15], v[84:87]
  buffer_load_dwordx4 v[172:175], v249, s[16:19], s43 offen offset:0 sc1
  v_mfma_f32_16x16x32_bf16 v[88:91], a[128:131], a[12:15], v[88:91]
  v_mfma_f32_16x16x32_bf16 v[92:95], a[132:135], a[12:15], v[92:95]
  buffer_load_dwordx4 a[12:15], v252, s[12:15], s72 offen sc1
  s_waitcnt vmcnt(31)
  v_mfma_f32_16x16x32_bf16 v[16:19], a[136:139], a[16:19], v[16:19]
  v_readlane_b32 s72, v15, 9
  s_nop 0
  s_add_u32 s72, s72, s62
  v_mfma_f32_16x16x32_bf16 v[20:23], a[140:143], a[16:19], v[20:23]
  v_mfma_f32_16x16x32_bf16 v[24:27], a[144:147], a[16:19], v[24:27]
  v_readlane_b32 s43, v15, 15
  s_nop 0
  s_and_b32 s43, s43, -2
  s_mul_i32 s43, s43, 5
  s_add_u32 s43, s43, s63
  s_nop 0
  buffer_load_dwordx4 v[176:179], v248, s[16:19], s43 offen offset:0 sc1
  v_mfma_f32_16x16x32_bf16 v[28:31], a[148:151], a[16:19], v[28:31]
  v_mfma_f32_16x16x32_bf16 v[32:35], a[152:155], a[16:19], v[32:35]
  buffer_load_dwordx4 a[16:19], v248, s[12:15], s72 offen sc1
  s_waitcnt vmcnt(31)
  v_mfma_f32_16x16x32_bf16 v[36:39], a[136:139], a[20:23], v[36:39]
  v_mfma_f32_16x16x32_bf16 v[40:43], a[140:143], a[20:23], v[40:43]
  v_mfma_f32_16x16x32_bf16 v[44:47], a[144:147], a[20:23], v[44:47]
  buffer_load_dwordx4 v[180:183], v248, s[16:19], s43 offen offset:1024 sc1
  v_mfma_f32_16x16x32_bf16 v[48:51], a[148:151], a[20:23], v[48:51]
  v_mfma_f32_16x16x32_bf16 v[52:55], a[152:155], a[20:23], v[52:55]
  buffer_load_dwordx4 a[20:23], v250, s[12:15], s72 offen sc1
  s_waitcnt vmcnt(31)
  v_mfma_f32_16x16x32_bf16 v[56:59], a[136:139], a[24:27], v[56:59]
  v_mfma_f32_16x16x32_bf16 v[60:63], a[140:143], a[24:27], v[60:63]
  v_mfma_f32_16x16x32_bf16 v[64:67], a[144:147], a[24:27], v[64:67]
  buffer_load_dwordx4 v[184:187], v248, s[16:19], s43 offen offset:2048 sc1
  v_mfma_f32_16x16x32_bf16 v[68:71], a[148:151], a[24:27], v[68:71]
  v_mfma_f32_16x16x32_bf16 v[72:75], a[152:155], a[24:27], v[72:75]
  buffer_load_dwordx4 a[24:27], v251, s[12:15], s72 offen sc1
  s_waitcnt vmcnt(31)
  v_mfma_f32_16x16x32_bf16 v[76:79], a[136:139], a[28:31], v[76:79]
  v_mfma_f32_16x16x32_bf16 v[80:83], a[140:143], a[28:31], v[80:83]
  v_mfma_f32_16x16x32_bf16 v[84:87], a[144:147], a[28:31], v[84:87]
  buffer_load_dwordx4 v[188:191], v248, s[16:19], s43 offen offset:3072 sc1
  v_mfma_f32_16x16x32_bf16 v[88:91], a[148:151], a[28:31], v[88:91]
  v_mfma_f32_16x16x32_bf16 v[92:95], a[152:155], a[28:31], v[92:95]
  buffer_load_dwordx4 a[28:31], v252, s[12:15], s72 offen sc1
  s_waitcnt vmcnt(16)
  s_mov_b32 s74, 0
L_plq3:
  v_sub_u32 v9, v8, v7
  v_cmp_gt_u32 vcc, 1, v9
  s_add_u32 s74, s74, 1
  s_nop 2
  s_and_b32 s72, vcc_lo, s49
  s_cbranch_scc0 L_plq3_ok
  s_cmp_ge_u32 s74, 0x80000
  s_cbranch_scc1 L_plq3_ok
  s_sleep 8
  buffer_load_dword v8, v6, s[56:59], 0 offen sc1
  s_waitcnt vmcnt(0)
  s_branch L_plq3
L_plq3_ok:
  v_mfma_f32_16x16x32_bf16 v[16:19], a[156:159], v[216:219], v[16:19]
  v_readlane_b32 s72, v15, 10
  s_nop 0
  s_add_u32 s72, s72, s62
  v_mfma_f32_16x16x32_bf16 v[20:23], a[160:163], v[216:219], v[20:23]
  v_mfma_f32_16x16x32_bf16 v[24:27], a[164:167], v[216:219], v[24:27]
  buffer_load_dwordx4 v[192:195], v249, s[16:19], s43 offen offset:0 sc1
  v_mfma_f32_16x16x32_bf16 v[28:31], a[168:171], v[216:219], v[28:31]
  v_mfma_f32_16x16x32_bf16 v[32:35], a[172:175], v[216:219], v[32:35]
  buffer_load_dwordx4 v[216:219], v248, s[12:15], s72 offen sc1
  v_mfma_f32_16x16x32_bf16 v[36:39], a[156:159], v[220:223], v[36:39]
  v_mfma_f32_16x16x32_bf16 v[40:43], a[160:163], v[220:223], v[40:43]
  v_mfma_f32_16x16x32_bf16 v[44:47], a[164:167], v[220:223], v[44:47]
  v_readlane_b32 s43, v15, 16
  s_nop 0
  s_mul_i32 s43, s43, 5
  s_add_u32 s43, s43, s63
  s_nop 1
  buffer_load_dwordx4 v[196:199], v248, s[16:19], s43 offen offset:0 sc1
  v_mfma_f32_16x16x32_bf16 v[48:51], a[168:171], v[220:223], v[48:51]
  v_mfma_f32_16x16x32_bf16 v[52:55], a[172:175], v[220:223], v[52:55]
  buffer_load_dwordx4 v[220:223], v250, s[12:15], s72 offen sc1
  v_mfma_f32_16x16x32_bf16 v[56:59], a[156:159], v[224:227], v[56:59]
  v_mfma_f32_16x16x32_bf16 v[60:63], a[160:163], v[224:227], v[60:63]
  v_mfma_f32_16x16x32_bf16 v[64:67], a[164:167], v[224:227], v[64:67]
  buffer_load_dwordx4 v[200:203], v248, s[16:19], s43 offen offset:1024 sc1
  v_mfma_f32_16x16x32_bf16 v[68:71], a[168:171], v[224:227], v[68:71]
  v_mfma_f32_16x16x32_bf16 v[72:75], a[172:175], v[224:227], v[72:75]
  buffer_load_dwordx4 v[224:227], v251, s[12:15], s72 offen sc1
  v_mfma_f32_16x16x32_bf16 v[76:79], a[156:159], v[228:231], v[76:79]
  v_mfma_f32_16x16x32_bf16 v[80:83], a[160:163], v[228:231], v[80:83]
  v_mfma_f32_16x16x32_bf16 v[84:87], a[164:167], v[228:231], v[84:87]
  buffer_load_dwordx4 v[204:207], v248, s[16:19], s43 offen offset:2048 sc1
  v_mfma_f32_16x16x32_bf16 v[88:91], a[168:171], v[228:231], v[88:91]
  v_mfma_f32_16x16x32_bf16 v[92:95], a[172:175], v[228:231], v[92:95]
  buffer_load_dwordx4 v[228:231], v252, s[12:15], s72 offen sc1
  v_mfma_f32_16x16x32_bf16 v[16:19], a[176:179], v[232:235], v[16:19]
  v_readlane_b32 s72, v15, 11
  s_nop 0
  s_add_u32 s72, s72, s62
  v_mfma_f32_16x16x32_bf16 v[20:23], a[180:183], v[232:235], v[20:23]
  v_mfma_f32_16x16x32_bf16 v[24:27], a[184:187], v[232:235], v[24:27]
  buffer_load_dwordx4 v[208:211], v248, s[16:19], s43 offen offset:3072 sc1
  v_mfma_f32_16x16x32_bf16 v[28:31], a[188:191], v[232:235], v[28:31]
  v_mfma_f32_16x16x32_bf16 v[32:35], a[192:195], v[232:235], v[32:35]
  buffer_load_dwordx4 v[232:235], v248, s[12:15], s72 offen sc1
  v_mfma_f32_16x16x32_bf16 v[36:39], a[176:179], v[236:239], v[36:39]
  v_mfma_f32_16x16x32_bf16 v[40:43], a[180:183], v[236:239], v[40:43]
  v_mfma_f32_16x16x32_bf16 v[44:47], a[184:187], v[236:239], v[44:47]
  buffer_load_dwordx4 v[212:215], v249, s[16:19], s43 offen offset:0 sc1
  v_mfma_f32_16x16x32_bf16 v[48:51], a[188:191], v[236:239], v[48:51]
  v_mfma_f32_16x16x32_bf16 v[52:55], a[192:195], v[236:239], v[52:55]
  buffer_load_dwordx4 v[236:239], v250, s[12:15], s72 offen sc1
  v_mfma_f32_16x16x32_bf16 v[56:59], a[176:179], v[240:243], v[56:59]
  v_mfma_f32_16x16x32_bf16 v[60:63], a[180:183], v[240:243], v[60:63]
  v_mfma_f32_16x16x32_bf16 v[64:67], a[184:187], v[240:243], v[64:67]
  v_mfma_f32_16x16x32_bf16 v[68:71], a[188:191], v[240:243], v[68:71]
  v_mfma_f32_16x16x32_bf16 v[72:75], a[192:195], v[240:243], v[72:75]
  buffer_load_dwordx4 v[240:243], v251, s[12:15], s72 offen sc1
  v_mfma_f32_16x16x32_bf16 v[76:79], a[176:179], v[244:247], v[76:79]
  v_mfma_f32_16x16x32_bf16 v[80:83], a[180:183], v[244:247], v[80:83]
  v_mfma_f32_16x16x32_bf16 v[84:87], a[184:187], v[244:247], v[84:87]
  v_mfma_f32_16x16x32_bf16 v[88:91], a[188:191], v[244:247], v[88:91]
  v_mfma_f32_16x16x32_bf16 v[92:95], a[192:195], v[244:247], v[92:95]
  buffer_load_dwordx4 v[244:247], v252, s[12:15], s72 offen sc1
  s_waitcnt vmcnt(28)
  v_mfma_f32_16x16x32_bf16 v[16:19], a[196:199], a[0:3], v[16:19]
  v_readlane_b32 s72, v15, 12
  s_nop 0
  s_add_u32 s72, s72, s62
  v_mfma_f32_16x16x32_bf16 v[20:23], a[200:203], a[0:3], v[20:23]
  v_mfma_f32_16x16x32_bf16 v[24:27], a[204:207], a[0:3], v[24:27]
  v_readlane_b32 s43, v15, 17
  s_nop 0
  s_mul_i32 s43, s43, 5
  s_add_u32 s43, s43, s63
  s_nop 1
  buffer_load_dwordx4 a[36:39], v248, s[16:19], s43 offen offset:0 sc1
  v_mfma_f32_16x16x32_bf16 v[28:31], a[208:211], a[0:3], v[28:31]
  v_mfma_f32_16x16x32_bf16 v[32:35], a[212:215], a[0:3], v[32:35]
  buffer_load_dwordx4 a[0:3], v248, s[12:15], s72 offen sc1
  s_waitcnt vmcnt(28)
  v_mfma_f32_16x16x32_bf16 v[36:39], a[196:199], a[4:7], v[36:39]
  v_mfma_f32_16x16x32_bf16 v[40:43], a[200:203], a[4:7], v[40:43]
  v_mfma_f32_16x16x32_bf16 v[44:47], a[204:207], a[4:7], v[44:47]
  buffer_load_dwordx4 a[40:43], v248, s[16:19], s43 offen offset:1024 sc1
  v_mfma_f32_16x16x32_bf16 v[48:51], a[208:211], a[4:7], v[48:51]
  v_mfma_f32_16x16x32_bf16 v[52:55], a[212:215], a[4:7], v[52:55]
  buffer_load_dwordx4 a[4:7], v250, s[12:15], s72 offen sc1
  s_waitcnt vmcnt(28)
  v_mfma_f32_16x16x32_bf16 v[56:59], a[196:199], a[8:11], v[56:59]
  v_mfma_f32_16x16x32_bf16 v[60:63], a[200:203], a[8:11], v[60:63]
  v_mfma_f32_16x16x32_bf16 v[64:67], a[204:207], a[8:11], v[64:67]
  buffer_load_dwordx4 a[44:47], v248, s[16:19], s43 offen offset:2048 sc1
  v_mfma_f32_16x16x32_bf16 v[68:71], a[208:211], a[8:11], v[68:71]
  v_mfma_f32_16x16x32_bf16 v[72:75], a[212:215], a[8:11], v[72:75]
  buffer_load_dwordx4 a[8:11], v251, s[12:15], s72 offen sc1
  s_waitcnt vmcnt(28)
  v_mfma_f32_16x16x32_bf16 v[76:79], a[196:199], a[12:15], v[76:79]
  v_mfma_f32_16x16x32_bf16 v[80:83], a[200:203], a[12:15], v[80:83]
  v_mfma_f32_16x16x32_bf16 v[84:87], a[204:207], a[12:15], v[84:87]
  buffer_load_dwordx4 a[48:51], v248, s[16:19], s43 offen offset:3072 sc1
  v_mfma_f32_16x16x32_bf16 v[88:91], a[208:211], a[12:15], v[88:91]
  v_mfma_f32_16x16x32_bf16 v[92:95], a[212:215], a[12:15], v[92:95]
  buffer_load_dwordx4 a[12:15], v252, s[12:15], s72 offen sc1
  s_mov_b32 exec_lo, s50
  s_mov_b32 exec_hi, 0
  buffer_load_dword v8, v6, s[56:59], 0 offen sc1
  s_mov_b64 exec, -1
  s_waitcnt vmcnt(29)
  v_mfma_f32_16x16x32_bf16 v[16:19], a[216:219], a[16:19], v[16:19]
  v_readlane_b32 s72, v15, 13
  s_nop 0
  s_add_u32 s72, s72, s62
  v_mfma_f32_16x16x32_bf16 v[20:23], a[220:223], a[16:19], v[20:23]
  v_mfma_f32_16x16x32_bf16 v[24:27], a[224:227], a[16:19], v[24:27]
  buffer_load_dwordx4 a[52:55], v249, s[16:19], s43 offen offset:0 sc1
  v_mfma_f32_16x16x32_bf16 v[28:31], a[228:231], a[16:19], v[28:31]
  v_mfma_f32_16x16x32_bf16 v[32:35], a[232:235], a[16:19], v[32:35]
  buffer_load_dwordx4 a[16:19], v248, s[12:15], s72 offen sc1
  s_waitcnt vmcnt(29)
  v_mfma_f32_16x16x32_bf16 v[36:39], a[216:219], a[20:23], v[36:39]
  v_mfma_f32_16x16x32_bf16 v[40:43], a[220:223], a[20:23], v[40:43]
  v_mfma_f32_16x16x32_bf16 v[44:47], a[224:227], a[20:23], v[44:47]
  v_readlane_b32 s43, v15, 18
  s_nop 0
  s_and_b32 s43, s43, -2
  s_mul_i32 s43, s43, 5
  s_add_u32 s43, s43, s63
  s_nop 0
  buffer_load_dwordx4 a[56:59], v248, s[16:19], s43 offen offset:0 sc1
  v_mfma_f32_16x16x32_bf16 v[48:51], a[228:231], a[20:23], v[48:51]
  v_mfma_f32_16x16x32_bf16 v[52:55], a[232:235], a[20:23], v[52:55]
  buffer_load_dwordx4 a[20:23], v250, s[12:15], s72 offen sc1
  s_waitcnt vmcnt(29)
  v_mfma_f32_16x16x32_bf16 v[56:59], a[216:219], a[24:27], v[56:59]
  v_mfma_f32_16x16x32_bf16 v[60:63], a[220:223], a[24:27], v[60:63]
  v_mfma_f32_16x16x32_bf16 v[64:67], a[224:227], a[24:27], v[64:67]
  buffer_load_dwordx4 a[60:63], v248, s[16:19], s43 offen offset:1024 sc1
  v_mfma_f32_16x16x32_bf16 v[68:71], a[228:231], a[24:27], v[68:71]
  v_mfma_f32_16x16x32_bf16 v[72:75], a[232:235], a[24:27], v[72:75]
  buffer_load_dwordx4 a[24:27], v251, s[12:15], s72 offen sc1
  s_waitcnt vmcnt(29)
  v_mfma_f32_16x16x32_bf16 v[76:79], a[216:219], a[28:31], v[76:79]
  v_mfma_f32_16x16x32_bf16 v[80:83], a[220:223], a[28:31], v[80:83]
  v_mfma_f32_16x16x32_bf16 v[84:87], a[224:227], a[28:31], v[84:87]
  buffer_load_dwordx4 a[64:67], v248, s[16:19], s43 offen offset:2048 sc1
  v_mfma_f32_16x16x32_bf16 v[88:91], a[228:231], a[28:31], v[88:91]
  v_mfma_f32_16x16x32_bf16 v[92:95], a[232:235], a[28:31], v[92:95]
  buffer_load_dwordx4 a[28:31], v252, s[12:15], s72 offen sc1
  s_waitcnt vmcnt(29)
  v_mfma_f32_16x16x32_bf16 v[16:19], a[236:239], v[216:219], v[16:19]
  v_readlane_b32 s72, v15, 14
  s_nop 0
  s_add_u32 s72, s72, s62
  v_mfma_f32_16x16x32_bf16 v[20:23], a[240:243], v[216:219], v[20:23]
  v_mfma_f32_16x16x32_bf16 v[24:27], a[244:247], v[216:219], v[24:27]
  buffer_load_dwordx4 a[68:71], v248, s[16:19], s43 offen offset:3072 sc1
  v_mfma_f32_16x16x32_bf16 v[28:31], a[248:251], v[216:219], v[28:31]
  v_mfma_f32_16x16x32_bf16 v[32:35], a[252:255], v[216:219], v[32:35]
  buffer_load_dwordx4 v[216:219], v248, s[12:15], s72 offen sc1
  s_waitcnt vmcnt(29)
  v_mfma_f32_16x16x32_bf16 v[36:39], a[236:239], v[220:223], v[36:39]
  v_mfma_f32_16x16x32_bf16 v[40:43], a[240:243], v[220:223], v[40:43]
  v_mfma_f32_16x16x32_bf16 v[44:47], a[244:247], v[220:223], v[44:47]
  buffer_load_dwordx4 a[72:75], v249, s[16:19], s43 offen offset:0 sc1
  v_mfma_f32_16x16x32_bf16 v[48:51], a[248:251], v[220:223], v[48:51]
  v_mfma_f32_16x16x32_bf16 v[52:55], a[252:255], v[220:223], v[52:55]
  buffer_load_dwordx4 v[220:223], v250, s[12:15], s72 offen sc1
  s_waitcnt vmcnt(29)
  v_mfma_f32_16x16x32_bf16 v[56:59], a[236:239], v[224:227], v[56:59]
  v_mfma_f32_16x16x32_bf16 v[60:63], a[240:243], v[224:227], v[60:63]
  v_mfma_f32_16x16x32_bf16 v[64:67], a[244:247], v[224:227], v[64:67]
  v_mfma_f32_16x16x32_bf16 v[68:71], a[248:251], v[224:227], v[68:71]
  v_mfma_f32_16x16x32_bf16 v[72:75], a[252:255], v[224:227], v[72:75]
  buffer_load_dwordx4 v[224:227], v251, s[12:15], s72 offen sc1
  s_waitcnt vmcnt(28)
  v_mfma_f32_16x16x32_bf16 v[76:79], a[236:239], v[228:231], v[76:79]
  v_mfma_f32_16x16x32_bf16 v[80:83], a[240:243], v[228:231], v[80:83]
  v_mfma_f32_16x16x32_bf16 v[84:87], a[244:247], v[228:231], v[84:87]
  v_mfma_f32_16x16x32_bf16 v[88:91], a[248:251], v[228:231], v[88:91]
  v_mfma_f32_16x16x32_bf16 v[92:95], a[252:255], v[228:231], v[92:95]
  buffer_load_dwordx4 v[228:231], v252, s[12:15], s72 offen sc1
  s_waitcnt vmcnt(14)
  s_mov_b32 s74, 0
L_plq4:
  v_sub_u32 v9, v8, v7
  v_cmp_gt_u32 vcc, 3, v9
  s_add_u32 s74, s74, 1
  s_nop 2
  s_and_b32 s72, vcc_lo, s50
  s_cbranch_scc0 L_plq4_ok
  s_cmp_ge_u32 s74, 0x80000
  s_cbranch_scc1 L_plq4_ok
  s_sleep 8
  buffer_load_dword v8, v6, s[56:59], 0 offen sc1
  s_waitcnt vmcnt(0)
  s_branch L_plq4
L_plq4_ok:
  v_mfma_f32_16x16x32_bf16 v[16:19], v[96:99], v[232:235], v[16:19]
  v_readlane_b32 s72, v15, 15
  s_bitcmp1_b32 s72, 0
  s_cselect_b32 s14, 0, 9699328
  s_and_b32 s72, s72, -2
  s_add_u32 s72, s72, s62
  v_mfma_f32_16x16x32_bf16 v[20:23], v[100:103], v[232:235], v[20:23]
  v_mfma_f32_16x16x32_bf16 v[24:27], v[104:107], v[232:235], v[24:27]
  v_mfma_f32_16x16x32_bf16 v[28:31], v[108:111], v[232:235], v[28:31]
  v_mfma_f32_16x16x32_bf16 v[32:35], v[112:115], v[232:235], v[32:35]
  buffer_load_dwordx4 v[232:235], v248, s[12:15], s72 offen sc1
  v_mfma_f32_16x16x32_bf16 v[36:39], v[96:99], v[236:239], v[36:39]
  v_mfma_f32_16x16x32_bf16 v[40:43], v[100:103], v[236:239], v[40:43]
  v_mfma_f32_16x16x32_bf16 v[44:47], v[104:107], v[236:239], v[44:47]
  v_mfma_f32_16x16x32_bf16 v[48:51], v[108:111], v[236:239], v[48:51]
  v_mfma_f32_16x16x32_bf16 v[52:55], v[112:115], v[236:239], v[52:55]
  buffer_load_dwordx4 v[236:239], v250, s[12:15], s72 offen sc1
  v_mfma_f32_16x16x32_bf16 v[56:59], v[96:99], v[240:243], v[56:59]
  v_mfma_f32_16x16x32_bf16 v[60:63], v[100:103], v[240:243], v[60:63]
  v_mfma_f32_16x16x32_bf16 v[64:67], v[104:107], v[240:243], v[64:67]
  v_mfma_f32_16x16x32_bf16 v[68:71], v[108:111], v[240:243], v[68:71]
  v_mfma_f32_16x16x32_bf16 v[72:75], v[112:115], v[240:243], v[72:75]
  buffer_load_dwordx4 v[240:243], v251, s[12:15], s72 offen sc1
  v_mfma_f32_16x16x32_bf16 v[76:79], v[96:99], v[244:247], v[76:79]
  v_mfma_f32_16x16x32_bf16 v[80:83], v[100:103], v[244:247], v[80:83]
  v_mfma_f32_16x16x32_bf16 v[84:87], v[104:107], v[244:247], v[84:87]
  v_mfma_f32_16x16x32_bf16 v[88:91], v[108:111], v[244:247], v[88:91]
  v_mfma_f32_16x16x32_bf16 v[92:95], v[112:115], v[244:247], v[92:95]
  buffer_load_dwordx4 v[244:247], v252, s[12:15], s72 offen sc1
  v_mfma_f32_16x16x32_bf16 v[16:19], v[116:119], a[0:3], v[16:19]
  v_readlane_b32 s72, v15, 16
  s_mov_b32 s14, 9699328
  s_add_u32 s72, s72, s62
  v_mfma_f32_16x16x32_bf16 v[20:23], v[120:123], a[0:3], v[20:23]
  v_mfma_f32_16x16x32_bf16 v[24:27], v[124:127], a[0:3], v[24:27]
  v_mfma_f32_16x16x32_bf16 v[28:31], v[128:131], a[0:3], v[28:31]
  v_mfma_f32_16x16x32_bf16 v[32:35], v[132:135], a[0:3], v[32:35]
  buffer_load_dwordx4 a[0:3], v248, s[12:15], s72 offen sc1
  v_add_u32 v14, 0, v1
  v_mul_u32_u24 v0, 3277, v14
  v_lshrrev_b32 v0, 16, v0
  v_mul_u32_u24 v96, 20, v0
  v_sub_u32 v14, v14, v96
  v_mul_u32_u24 v96, 336, v0
  v_lshl_add_u32 v96, v14, 4, v96
  v_add_u32 v2, s36, v96
  v_lshlrev_b32 v7, 3, v14
  v_and_b32 v96, 8, v0
  v_and_b32 v97, 3, v0
  v_lshl_add_u32 v96, v97, 1, v96
  v_bfe_u32 v97, v0, 2, 1
  v_add_u32 v96, v96, v97
  v_lshlrev_b32 v96, 1, v96
  v_add_u32 v96, s26, v96
  v_mul_u32_u24 v96, 1280, v96
  v_add_u32 v253, v96, v7
  v_mfma_f32_16x16x32_bf16 v[36:39], v[116:119], a[4:7], v[36:39]
  v_mfma_f32_16x16x32_bf16 v[40:43], v[120:123], a[4:7], v[40:43]
  v_mfma_f32_16x16x32_bf16 v[44:47], v[124:127], a[4:7], v[44:47]
  v_mfma_f32_16x16x32_bf16 v[48:51], v[128:131], a[4:7], v[48:51]
  v_mfma_f32_16x16x32_bf16 v[52:55], v[132:135], a[4:7], v[52:55]
  buffer_load_dwordx4 a[4:7], v250, s[12:15], s72 offen sc1
  v_add_u32 v14, 64, v1
  v_mul_u32_u24 v0, 3277, v14
  v_lshrrev_b32 v0, 16, v0
  v_mul_u32_u24 v96, 20, v0
  v_sub_u32 v14, v14, v96
  v_mul_u32_u24 v96, 336, v0
  v_lshl_add_u32 v96, v14, 4, v96
  v_add_u32 v3, s36, v96
  v_lshlrev_b32 v8, 3, v14
  v_and_b32 v96, 8, v0
  v_and_b32 v97, 3, v0
  v_lshl_add_u32 v96, v97, 1, v96
  v_bfe_u32 v97, v0, 2, 1
  v_add_u32 v96, v96, v97
  v_lshlrev_b32 v96, 1, v96
  v_add_u32 v96, s26, v96
  v_mul_u32_u24 v96, 1280, v96
  v_add_u32 v254, v96, v8
  v_mfma_f32_16x16x32_bf16 v[56:59], v[116:119], a[8:11], v[56:59]
  v_mfma_f32_16x16x32_bf16 v[60:63], v[120:123], a[8:11], v[60:63]
  v_mfma_f32_16x16x32_bf16 v[64:67], v[124:127], a[8:11], v[64:67]
  v_mfma_f32_16x16x32_bf16 v[68:71], v[128:131], a[8:11], v[68:71]
  v_mfma_f32_16x16x32_bf16 v[72:75], v[132:135], a[8:11], v[72:75]
  buffer_load_dwordx4 a[8:11], v251, s[12:15], s72 offen sc1
  v_add_u32 v14, 128, v1
  v_mul_u32_u24 v0, 3277, v14
  v_lshrrev_b32 v0, 16, v0
  v_mul_u32_u24 v96, 20, v0
  v_sub_u32 v14, v14, v96
  v_mul_u32_u24 v96, 336, v0
  v_lshl_add_u32 v96, v14, 4, v96
  v_add_u32 v4, s36, v96
  v_lshlrev_b32 v9, 3, v14
  v_and_b32 v96, 8, v0
  v_and_b32 v97, 3, v0
  v_lshl_add_u32 v96, v97, 1, v96
  v_bfe_u32 v97, v0, 2, 1
  v_add_u32 v96, v96, v97
  v_lshlrev_b32 v96, 1, v96
  v_add_u32 v96, s26, v96
  v_mul_u32_u24 v96, 1280, v96
  v_add_u32 v255, v96, v9
  v_mfma_f32_16x16x32_bf16 v[76:79], v[116:119], a[12:15], v[76:79]
  v_mfma_f32_16x16x32_bf16 v[80:83], v[120:123], a[12:15], v[80:83]
  v_mfma_f32_16x16x32_bf16 v[84:87], v[124:127], a[12:15], v[84:87]
  v_mfma_f32_16x16x32_bf16 v[88:91], v[128:131], a[12:15], v[88:91]
  v_mfma_f32_16x16x32_bf16 v[92:95], v[132:135], a[12:15], v[92:95]
  buffer_load_dwordx4 a[12:15], v252, s[12:15], s72 offen sc1
  v_add_u32 v14, 192, v1
  v_mul_u32_u24 v0, 3277, v14
  v_lshrrev_b32 v0, 16, v0
  v_mul_u32_u24 v96, 20, v0
  v_sub_u32 v14, v14, v96
  v_mul_u32_u24 v96, 336, v0
  v_lshl_add_u32 v96, v14, 4, v96
  v_add_u32 v5, s36, v96
  v_lshlrev_b32 v10, 3, v14
  v_and_b32 v96, 8, v0
  v_and_b32 v97, 3, v0
  v_lshl_add_u32 v96, v97, 1, v96
  v_bfe_u32 v97, v0, 2, 1
  v_add_u32 v96, v96, v97
  v_lshlrev_b32 v96, 1, v96
  v_add_u32 v96, s26, v96
  v_mul_u32_u24 v96, 1280, v96
  v_add_u32 v12, v96, v10
  s_waitcnt vmcnt(20)
  v_mfma_f32_16x16x32_bf16 v[16:19], v[136:139], a[16:19], v[16:19]
  v_readlane_b32 s72, v15, 17
  s_nop 0
  s_add_u32 s72, s72, s62
  v_mfma_f32_16x16x32_bf16 v[20:23], v[140:143], a[16:19], v[20:23]
  v_mfma_f32_16x16x32_bf16 v[24:27], v[144:147], a[16:19], v[24:27]
  v_mfma_f32_16x16x32_bf16 v[28:31], v[148:151], a[16:19], v[28:31]
  v_mfma_f32_16x16x32_bf16 v[32:35], v[152:155], a[16:19], v[32:35]
  buffer_load_dwordx4 a[16:19], v248, s[12:15], s72 offen sc1
  v_add_u32 v14, 256, v1
  v_mul_u32_u24 v0, 3277, v14
  v_lshrrev_b32 v0, 16, v0
  v_mul_u32_u24 v96, 20, v0
  v_sub_u32 v14, v14, v96
  v_mul_u32_u24 v96, 336, v0
  v_lshl_add_u32 v96, v14, 4, v96
  v_add_u32 v6, s36, v96
  v_lshlrev_b32 v11, 3, v14
  v_and_b32 v96, 8, v0
  v_and_b32 v97, 3, v0
  v_lshl_add_u32 v96, v97, 1, v96
  v_bfe_u32 v97, v0, 2, 1
  v_add_u32 v96, v96, v97
  v_lshlrev_b32 v96, 1, v96
  v_add_u32 v96, s26, v96
  v_mul_u32_u24 v96, 1280, v96
  v_add_u32 v13, v96, v11
  s_mul_i32 s26, s20, 5376
  v_and_b32 v14, 15, v1
  v_mul_u32_u24 v14, 336, v14
  v_lshrrev_b32 v0, 4, v1
  v_lshl_add_u32 v14, v0, 4, v14
  v_add_u32 v14, s26, v14
  s_waitcnt vmcnt(19)
  v_mfma_f32_16x16x32_bf16 v[36:39], v[136:139], a[20:23], v[36:39]
  v_mfma_f32_16x16x32_bf16 v[40:43], v[140:143], a[20:23], v[40:43]
  v_mfma_f32_16x16x32_bf16 v[44:47], v[144:147], a[20:23], v[44:47]
  v_mfma_f32_16x16x32_bf16 v[48:51], v[148:151], a[20:23], v[48:51]
  v_mfma_f32_16x16x32_bf16 v[52:55], v[152:155], a[20:23], v[52:55]
  buffer_load_dwordx4 a[20:23], v250, s[12:15], s72 offen sc1
  s_waitcnt vmcnt(18)
  v_mfma_f32_16x16x32_bf16 v[56:59], v[136:139], a[24:27], v[56:59]
  v_mfma_f32_16x16x32_bf16 v[60:63], v[140:143], a[24:27], v[60:63]
  v_mfma_f32_16x16x32_bf16 v[64:67], v[144:147], a[24:27], v[64:67]
  v_mfma_f32_16x16x32_bf16 v[68:71], v[148:151], a[24:27], v[68:71]
  v_mfma_f32_16x16x32_bf16 v[72:75], v[152:155], a[24:27], v[72:75]
  buffer_load_dwordx4 a[24:27], v251, s[12:15], s72 offen sc1
  s_waitcnt vmcnt(17)
  v_mfma_f32_16x16x32_bf16 v[76:79], v[136:139], a[28:31], v[76:79]
  v_mfma_f32_16x16x32_bf16 v[80:83], v[140:143], a[28:31], v[80:83]
  v_mfma_f32_16x16x32_bf16 v[84:87], v[144:147], a[28:31], v[84:87]
  v_mfma_f32_16x16x32_bf16 v[88:91], v[148:151], a[28:31], v[88:91]
  v_mfma_f32_16x16x32_bf16 v[92:95], v[152:155], a[28:31], v[92:95]
  buffer_load_dwordx4 a[28:31], v252, s[12:15], s72 offen sc1
  buffer_load_dwordx2 v[96:97], v253, s[4:7], s31 offen
  buffer_load_dwordx2 v[98:99], v254, s[4:7], s31 offen
  buffer_load_dwordx2 v[100:101], v255, s[4:7], s31 offen
  buffer_load_dwordx2 v[102:103], v12, s[4:7], s31 offen
  buffer_load_dwordx2 v[104:105], v13, s[4:7], s31 offen
  buffer_load_dwordx2 v[106:107], v7, s[76:79], s31 offen
  buffer_load_dwordx2 v[108:109], v8, s[76:79], s31 offen
  buffer_load_dwordx2 v[110:111], v9, s[76:79], s31 offen
  buffer_load_dwordx2 v[112:113], v10, s[76:79], s31 offen
  buffer_load_dwordx2 v[114:115], v11, s[76:79], s31 offen
  s_waitcnt vmcnt(26)
  v_mfma_f32_16x16x32_bf16 v[16:19], v[156:159], v[216:219], v[16:19]
  v_readlane_b32 s72, v15, 18
  s_bitcmp1_b32 s72, 0
  s_cselect_b32 s14, 0, 9699328
  s_and_b32 s72, s72, -2
  s_add_u32 s72, s72, s62
  v_mfma_f32_16x16x32_bf16 v[20:23], v[160:163], v[216:219], v[20:23]
  v_mfma_f32_16x16x32_bf16 v[24:27], v[164:167], v[216:219], v[24:27]
  v_mfma_f32_16x16x32_bf16 v[28:31], v[168:171], v[216:219], v[28:31]
  v_mfma_f32_16x16x32_bf16 v[32:35], v[172:175], v[216:219], v[32:35]
  buffer_load_dwordx4 v[216:219], v248, s[12:15], s72 offen sc1
  s_waitcnt vmcnt(25)
  v_mfma_f32_16x16x32_bf16 v[36:39], v[156:159], v[220:223], v[36:39]
  v_mfma_f32_16x16x32_bf16 v[40:43], v[160:163], v[220:223], v[40:43]
  v_mfma_f32_16x16x32_bf16 v[44:47], v[164:167], v[220:223], v[44:47]
  v_mfma_f32_16x16x32_bf16 v[48:51], v[168:171], v[220:223], v[48:51]
  v_mfma_f32_16x16x32_bf16 v[52:55], v[172:175], v[220:223], v[52:55]
  buffer_load_dwordx4 v[220:223], v250, s[12:15], s72 offen sc1
  s_waitcnt vmcnt(25)
  v_mfma_f32_16x16x32_bf16 v[56:59], v[156:159], v[224:227], v[56:59]
  v_mfma_f32_16x16x32_bf16 v[60:63], v[160:163], v[224:227], v[60:63]
  v_mfma_f32_16x16x32_bf16 v[64:67], v[164:167], v[224:227], v[64:67]
  v_mfma_f32_16x16x32_bf16 v[68:71], v[168:171], v[224:227], v[68:71]
  v_mfma_f32_16x16x32_bf16 v[72:75], v[172:175], v[224:227], v[72:75]
  buffer_load_dwordx4 v[224:227], v251, s[12:15], s72 offen sc1
  s_waitcnt vmcnt(25)
  v_mfma_f32_16x16x32_bf16 v[76:79], v[156:159], v[228:231], v[76:79]
  v_mfma_f32_16x16x32_bf16 v[80:83], v[160:163], v[228:231], v[80:83]
  v_mfma_f32_16x16x32_bf16 v[84:87], v[164:167], v[228:231], v[84:87]
  v_mfma_f32_16x16x32_bf16 v[88:91], v[168:171], v[228:231], v[88:91]
  v_mfma_f32_16x16x32_bf16 v[92:95], v[172:175], v[228:231], v[92:95]
  buffer_load_dwordx4 v[228:231], v252, s[12:15], s72 offen sc1
  s_waitcnt vmcnt(25)
  v_mfma_f32_16x16x32_bf16 v[16:19], v[176:179], v[232:235], v[16:19]
  v_mfma_f32_16x16x32_bf16 v[20:23], v[180:183], v[232:235], v[20:23]
  v_mfma_f32_16x16x32_bf16 v[24:27], v[184:187], v[232:235], v[24:27]
  v_mfma_f32_16x16x32_bf16 v[28:31], v[188:191], v[232:235], v[28:31]
  v_mfma_f32_16x16x32_bf16 v[32:35], v[192:195], v[232:235], v[32:35]
  s_waitcnt vmcnt(24)
  v_mfma_f32_16x16x32_bf16 v[36:39], v[176:179], v[236:239], v[36:39]
  v_mfma_f32_16x16x32_bf16 v[40:43], v[180:183], v[236:239], v[40:43]
  v_mfma_f32_16x16x32_bf16 v[44:47], v[184:187], v[236:239], v[44:47]
  v_mfma_f32_16x16x32_bf16 v[48:51], v[188:191], v[236:239], v[48:51]
  v_mfma_f32_16x16x32_bf16 v[52:55], v[192:195], v[236:239], v[52:55]
  s_waitcnt vmcnt(23)
  v_mfma_f32_16x16x32_bf16 v[56:59], v[176:179], v[240:243], v[56:59]
  v_mfma_f32_16x16x32_bf16 v[60:63], v[180:183], v[240:243], v[60:63]
  v_mfma_f32_16x16x32_bf16 v[64:67], v[184:187], v[240:243], v[64:67]
  v_mfma_f32_16x16x32_bf16 v[68:71], v[188:191], v[240:243], v[68:71]
  v_mfma_f32_16x16x32_bf16 v[72:75], v[192:195], v[240:243], v[72:75]
  s_waitcnt vmcnt(22)
  v_mfma_f32_16x16x32_bf16 v[76:79], v[176:179], v[244:247], v[76:79]
  v_mfma_f32_16x16x32_bf16 v[80:83], v[180:183], v[244:247], v[80:83]
  v_mfma_f32_16x16x32_bf16 v[84:87], v[184:187], v[244:247], v[84:87]
  v_mfma_f32_16x16x32_bf16 v[88:91], v[188:191], v[244:247], v[88:91]
  v_mfma_f32_16x16x32_bf16 v[92:95], v[192:195], v[244:247], v[92:95]
  s_waitcnt vmcnt(21)
  v_mfma_f32_16x16x32_bf16 v[16:19], v[196:199], a[0:3], v[16:19]
  v_mfma_f32_16x16x32_bf16 v[20:23], v[200:203], a[0:3], v[20:23]
  v_mfma_f32_16x16x32_bf16 v[24:27], v[204:207], a[0:3], v[24:27]
  v_mfma_f32_16x16x32_bf16 v[28:31], v[208:211], a[0:3], v[28:31]
  v_mfma_f32_16x16x32_bf16 v[32:35], v[212:215], a[0:3], v[32:35]
  s_waitcnt vmcnt(20)
  v_mfma_f32_16x16x32_bf16 v[36:39], v[196:199], a[4:7], v[36:39]
  v_mfma_f32_16x16x32_bf16 v[40:43], v[200:203], a[4:7], v[40:43]
  v_mfma_f32_16x16x32_bf16 v[44:47], v[204:207], a[4:7], v[44:47]
  v_mfma_f32_16x16x32_bf16 v[48:51], v[208:211], a[4:7], v[48:51]
  v_mfma_f32_16x16x32_bf16 v[52:55], v[212:215], a[4:7], v[52:55]
  s_waitcnt vmcnt(19)
  v_mfma_f32_16x16x32_bf16 v[56:59], v[196:199], a[8:11], v[56:59]
  v_mfma_f32_16x16x32_bf16 v[60:63], v[200:203], a[8:11], v[60:63]
  v_mfma_f32_16x16x32_bf16 v[64:67], v[204:207], a[8:11], v[64:67]
  v_mfma_f32_16x16x32_bf16 v[68:71], v[208:211], a[8:11], v[68:71]
  v_mfma_f32_16x16x32_bf16 v[72:75], v[212:215], a[8:11], v[72:75]
  s_waitcnt vmcnt(18)
  v_mfma_f32_16x16x32_bf16 v[76:79], v[196:199], a[12:15], v[76:79]
  v_mfma_f32_16x16x32_bf16 v[80:83], v[200:203], a[12:15], v[80:83]
  v_mfma_f32_16x16x32_bf16 v[84:87], v[204:207], a[12:15], v[84:87]
  v_mfma_f32_16x16x32_bf16 v[88:91], v[208:211], a[12:15], v[88:91]
  v_mfma_f32_16x16x32_bf16 v[92:95], v[212:215], a[12:15], v[92:95]
  s_waitcnt vmcnt(17)
  v_mfma_f32_16x16x32_bf16 v[16:19], a[36:39], a[16:19], v[16:19]
  v_mfma_f32_16x16x32_bf16 v[20:23], a[40:43], a[16:19], v[20:23]
  v_mfma_f32_16x16x32_bf16 v[24:27], a[44:47], a[16:19], v[24:27]
  v_mfma_f32_16x16x32_bf16 v[28:31], a[48:51], a[16:19], v[28:31]
  v_mfma_f32_16x16x32_bf16 v[32:35], a[52:55], a[16:19], v[32:35]
  s_waitcnt vmcnt(16)
  v_mfma_f32_16x16x32_bf16 v[36:39], a[36:39], a[20:23], v[36:39]
  v_mfma_f32_16x16x32_bf16 v[40:43], a[40:43], a[20:23], v[40:43]
  v_mfma_f32_16x16x32_bf16 v[44:47], a[44:47], a[20:23], v[44:47]
  v_mfma_f32_16x16x32_bf16 v[48:51], a[48:51], a[20:23], v[48:51]
  v_mfma_f32_16x16x32_bf16 v[52:55], a[52:55], a[20:23], v[52:55]
  s_waitcnt vmcnt(15)
  v_mfma_f32_16x16x32_bf16 v[56:59], a[36:39], a[24:27], v[56:59]
  v_mfma_f32_16x16x32_bf16 v[60:63], a[40:43], a[24:27], v[60:63]
  v_mfma_f32_16x16x32_bf16 v[64:67], a[44:47], a[24:27], v[64:67]
  v_mfma_f32_16x16x32_bf16 v[68:71], a[48:51], a[24:27], v[68:71]
  v_mfma_f32_16x16x32_bf16 v[72:75], a[52:55], a[24:27], v[72:75]
  s_waitcnt vmcnt(14)
  v_mfma_f32_16x16x32_bf16 v[76:79], a[36:39], a[28:31], v[76:79]
  v_mfma_f32_16x16x32_bf16 v[80:83], a[40:43], a[28:31], v[80:83]
  v_mfma_f32_16x16x32_bf16 v[84:87], a[44:47], a[28:31], v[84:87]
  v_mfma_f32_16x16x32_bf16 v[88:91], a[48:51], a[28:31], v[88:91]
  v_mfma_f32_16x16x32_bf16 v[92:95], a[52:55], a[28:31], v[92:95]
  s_waitcnt vmcnt(13)
  v_lshlrev_b32 v120, 16, v96
  v_and_b32 v121, 0xffff0000, v96
  s_waitcnt vmcnt(8)
  v_lshlrev_b32 v140, 16, v106
  v_and_b32 v141, 0xffff0000, v106
  v_lshlrev_b32 v122, 16, v97
  v_and_b32 v123, 0xffff0000, v97
  v_lshlrev_b32 v142, 16, v107
  v_and_b32 v143, 0xffff0000, v107
  v_lshlrev_b32 v124, 16, v98
  v_and_b32 v125, 0xffff0000, v98
  s_waitcnt vmcnt(7)
  v_lshlrev_b32 v144, 16, v108
  v_and_b32 v145, 0xffff0000, v108
  v_lshlrev_b32 v126, 16, v99
  v_and_b32 v127, 0xffff0000, v99
  v_lshlrev_b32 v146, 16, v109
  v_and_b32 v147, 0xffff0000, v109
  v_lshlrev_b32 v128, 16, v100
  v_and_b32 v129, 0xffff0000, v100
  s_waitcnt vmcnt(6)
  v_lshlrev_b32 v148, 16, v110
  v_and_b32 v149, 0xffff0000, v110
  v_lshlrev_b32 v130, 16, v101
  v_and_b32 v131, 0xffff0000, v101
  v_lshlrev_b32 v150, 16, v111
  v_and_b32 v151, 0xffff0000, v111
  v_lshlrev_b32 v132, 16, v102
  v_and_b32 v133, 0xffff0000, v102
  s_waitcnt vmcnt(5)
  v_lshlrev_b32 v152, 16, v112
  v_and_b32 v153, 0xffff0000, v112
  v_lshlrev_b32 v134, 16, v103
  v_and_b32 v135, 0xffff0000, v103
  v_lshlrev_b32 v154, 16, v113
  v_and_b32 v155, 0xffff0000, v113
  v_lshlrev_b32 v136, 16, v104
  v_and_b32 v137, 0xffff0000, v104
  s_waitcnt vmcnt(4)
  v_lshlrev_b32 v156, 16, v114
  v_and_b32 v157, 0xffff0000, v114
  v_lshlrev_b32 v138, 16, v105
  v_and_b32 v139, 0xffff0000, v105
  v_lshlrev_b32 v158, 16, v115
  v_and_b32 v159, 0xffff0000, v115
  v_add_f32 v120, v120, v140
  v_add_f32 v121, v121, v141
  v_add_f32 v122, v122, v142
  v_add_f32 v123, v123, v143
  v_add_f32 v124, v124, v144
  v_add_f32 v125, v125, v145
  v_add_f32 v126, v126, v146
  v_add_f32 v127, v127, v147
  v_add_f32 v128, v128, v148
  v_add_f32 v129, v129, v149
  v_add_f32 v130, v130, v150
  v_add_f32 v131, v131, v151
  v_add_f32 v132, v132, v152
  v_add_f32 v133, v133, v153
  v_add_f32 v134, v134, v154
  v_add_f32 v135, v135, v155
  v_add_f32 v136, v136, v156
  v_add_f32 v137, v137, v157
  v_add_f32 v138, v138, v158
  v_add_f32 v139, v139, v159
  s_waitcnt vmcnt(3)
  v_mfma_f32_16x16x32_bf16 v[16:19], a[56:59], v[216:219], v[16:19]
  v_mfma_f32_16x16x32_bf16 v[20:23], a[60:63], v[216:219], v[20:23]
  v_mfma_f32_16x16x32_bf16 v[24:27], a[64:67], v[216:219], v[24:27]
  v_mfma_f32_16x16x32_bf16 v[28:31], a[68:71], v[216:219], v[28:31]
  v_mfma_f32_16x16x32_bf16 v[32:35], a[72:75], v[216:219], v[32:35]
  s_waitcnt vmcnt(2)
  v_mfma_f32_16x16x32_bf16 v[36:39], a[56:59], v[220:223], v[36:39]
  s_nop 1
  ds_write_b128 v14, v[16:19] offset:0
  v_mfma_f32_16x16x32_bf16 v[40:43], a[60:63], v[220:223], v[40:43]
  ds_write_b128 v14, v[20:23] offset:64
  v_mfma_f32_16x16x32_bf16 v[44:47], a[64:67], v[220:223], v[44:47]
  ds_write_b128 v14, v[24:27] offset:128
  v_mfma_f32_16x16x32_bf16 v[48:51], a[68:71], v[220:223], v[48:51]
  ds_write_b128 v14, v[28:31] offset:192
  v_mfma_f32_16x16x32_bf16 v[52:55], a[72:75], v[220:223], v[52:55]
  ds_write_b128 v14, v[32:35] offset:256
  s_waitcnt vmcnt(1)
  v_mfma_f32_16x16x32_bf16 v[56:59], a[56:59], v[224:227], v[56:59]
  ds_write_b128 v14, v[36:39] offset:21504
  v_mfma_f32_16x16x32_bf16 v[60:63], a[60:63], v[224:227], v[60:63]
  ds_write_b128 v14, v[40:43] offset:21568
  v_mfma_f32_16x16x32_bf16 v[64:67], a[64:67], v[224:227], v[64:67]
  ds_write_b128 v14, v[44:47] offset:21632
  v_mfma_f32_16x16x32_bf16 v[68:71], a[68:71], v[224:227], v[68:71]
  ds_write_b128 v14, v[48:51] offset:21696
  v_mfma_f32_16x16x32_bf16 v[72:75], a[72:75], v[224:227], v[72:75]
  ds_write_b128 v14, v[52:55] offset:21760
  s_waitcnt vmcnt(0)
  v_mfma_f32_16x16x32_bf16 v[76:79], a[56:59], v[228:231], v[76:79]
  ds_write_b128 v14, v[56:59] offset:43008
  v_mfma_f32_16x16x32_bf16 v[80:83], a[60:63], v[228:231], v[80:83]
  ds_write_b128 v14, v[60:63] offset:43072
  v_mfma_f32_16x16x32_bf16 v[84:87], a[64:67], v[228:231], v[84:87]
  ds_write_b128 v14, v[64:67] offset:43136
  v_mfma_f32_16x16x32_bf16 v[88:91], a[68:71], v[228:231], v[88:91]
  ds_write_b128 v14, v[68:71] offset:43200
  v_mfma_f32_16x16x32_bf16 v[92:95], a[72:75], v[228:231], v[92:95]
  ds_write_b128 v14, v[72:75] offset:43264
  ds_write_b128 v14, v[76:79] offset:64512
  ds_write_b128 v14, v[80:83] offset:64576
  s_nop 0
  ds_write_b128 v14, v[84:87] offset:64640
  s_nop 0
  ds_write_b128 v14, v[88:91] offset:64704
  s_nop 0
  ds_write_b128 v14, v[92:95] offset:64768
  s_waitcnt lgkmcnt(0)
  s_barrier
  ds_read_b128 v[16:19], v2 offset:0
  ds_read_b128 v[36:39], v2 offset:5376
  ds_read_b128 v[56:59], v2 offset:10752
  ds_read_b128 v[76:79], v2 offset:16128
  ds_read_b128 v[20:23], v3 offset:0
  ds_read_b128 v[40:43], v3 offset:5376
  ds_read_b128 v[60:63], v3 offset:10752
  ds_read_b128 v[80:83], v3 offset:16128
  ds_read_b128 v[24:27], v4 offset:0
  ds_read_b128 v[44:47], v4 offset:5376
  ds_read_b128 v[64:67], v4 offset:10752
  ds_read_b128 v[84:87], v4 offset:16128
  ds_read_b128 v[28:31], v5 offset:0
  ds_read_b128 v[48:51], v5 offset:5376
  ds_read_b128 v[68:71], v5 offset:10752
  ds_read_b128 v[88:91], v5 offset:16128
  ds_read_b128 v[32:35], v6 offset:0
  ds_read_b128 v[52:55], v6 offset:5376
  ds_read_b128 v[72:75], v6 offset:10752
  ds_read_b128 v[92:95], v6 offset:16128
  s_waitcnt lgkmcnt(15)
  v_add_f32 v16, v16, v36
  v_add_f32 v56, v56, v76
  v_add_f32 v120, v120, v16
  v_add_f32 v120, v120, v56
  v_add_f32 v17, v17, v37
  v_add_f32 v57, v57, v77
  v_add_f32 v121, v121, v17
  v_add_f32 v121, v121, v57
  v_add_f32 v18, v18, v38
  v_add_f32 v58, v58, v78
  v_add_f32 v122, v122, v18
  v_add_f32 v122, v122, v58
  v_add_f32 v19, v19, v39
  v_add_f32 v59, v59, v79
  v_add_f32 v123, v123, v19
  v_add_f32 v123, v123, v59
  v_cvt_pk_bf16_f32 v100, v120, v121
  v_cvt_pk_bf16_f32 v101, v122, v123
  buffer_store_dwordx2 v[100:101], v253, s[8:11], s31 offen nt
  s_waitcnt lgkmcnt(14)
  v_add_f32 v20, v20, v40
  s_waitcnt lgkmcnt(12)
  v_add_f32 v60, v60, v80
  v_add_f32 v124, v124, v20
  v_add_f32 v124, v124, v60
  v_add_f32 v21, v21, v41
  v_add_f32 v61, v61, v81
  v_add_f32 v125, v125, v21
  v_add_f32 v125, v125, v61
  v_add_f32 v22, v22, v42
  v_add_f32 v62, v62, v82
  v_add_f32 v126, v126, v22
  v_add_f32 v126, v126, v62
  v_add_f32 v23, v23, v43
  v_add_f32 v63, v63, v83
  v_add_f32 v127, v127, v23
  v_add_f32 v127, v127, v63
  v_cvt_pk_bf16_f32 v102, v124, v125
  v_cvt_pk_bf16_f32 v103, v126, v127
  buffer_store_dwordx2 v[102:103], v254, s[8:11], s31 offen nt
  s_waitcnt lgkmcnt(10)
  v_add_f32 v24, v24, v44
  s_waitcnt lgkmcnt(8)
  v_add_f32 v64, v64, v84
  v_add_f32 v128, v128, v24
  v_add_f32 v128, v128, v64
  v_add_f32 v25, v25, v45
  v_add_f32 v65, v65, v85
  v_add_f32 v129, v129, v25
  v_add_f32 v129, v129, v65
  v_add_f32 v26, v26, v46
  v_add_f32 v66, v66, v86
  v_add_f32 v130, v130, v26
  v_add_f32 v130, v130, v66
  v_add_f32 v27, v27, v47
  v_add_f32 v67, v67, v87
  v_add_f32 v131, v131, v27
  v_add_f32 v131, v131, v67
  v_cvt_pk_bf16_f32 v104, v128, v129
  v_cvt_pk_bf16_f32 v105, v130, v131
  buffer_store_dwordx2 v[104:105], v255, s[8:11], s31 offen nt
  s_waitcnt lgkmcnt(6)
  v_add_f32 v28, v28, v48
  s_waitcnt lgkmcnt(4)
  v_add_f32 v68, v68, v88
  v_add_f32 v132, v132, v28
  v_add_f32 v132, v132, v68
  v_add_f32 v29, v29, v49
  v_add_f32 v69, v69, v89
  v_add_f32 v133, v133, v29
  v_add_f32 v133, v133, v69
  v_add_f32 v30, v30, v50
  v_add_f32 v70, v70, v90
  v_add_f32 v134, v134, v30
  v_add_f32 v134, v134, v70
  v_add_f32 v31, v31, v51
  v_add_f32 v71, v71, v91
  v_add_f32 v135, v135, v31
  v_add_f32 v135, v135, v71
  v_cvt_pk_bf16_f32 v106, v132, v133
  v_cvt_pk_bf16_f32 v107, v134, v135
  buffer_store_dwordx2 v[106:107], v12, s[8:11], s31 offen nt
  s_waitcnt lgkmcnt(2)
  v_add_f32 v32, v32, v52
  s_waitcnt lgkmcnt(0)
  v_add_f32 v72, v72, v92
  v_add_f32 v136, v136, v32
  v_add_f32 v136, v136, v72
  v_add_f32 v33, v33, v53
  v_add_f32 v73, v73, v93
  v_add_f32 v137, v137, v33
  v_add_f32 v137, v137, v73
  v_add_f32 v34, v34, v54
  v_add_f32 v74, v74, v94
  v_add_f32 v138, v138, v34
  v_add_f32 v138, v138, v74
  v_add_f32 v35, v35, v55
  v_add_f32 v75, v75, v95
  v_add_f32 v139, v139, v35
  v_add_f32 v139, v139, v75
  v_cvt_pk_bf16_f32 v108, v136, v137
  v_cvt_pk_bf16_f32 v109, v138, v139
  buffer_store_dwordx2 v[108:109], v13, s[8:11], s31 offen nt
  s_endpgm
L_w1:
  s_sub_u32 s3, s3, 18
  s_and_b32 s41, s2, 3
  s_mul_i32 s41, s41, 14
  s_add_u32 s3, s3, s41
  s_lshr_b32 s24, s3, 3
  s_and_b32 s25, s3, 7
  s_mov_b32 s54, s3
  s_and_b32 s43, s24, 1
  s_mul_i32 s43, s43, 1
  s_add_u32 s43, s43, s25
  s_add_u32 s43, s43, 2
  s_mul_i32 s41, s43, 52
  s_lshr_b32 s41, s41, 8
  s_mul_i32 s41, s41, 5
  s_sub_u32 s43, s43, s41
  s_mul_i32 s43, s43, 1
  s_add_u32 s41, s43, 0
  s_sub_u32 s42, s41, 5
  s_cmp_ge_u32 s41, 5
  s_cselect_b32 s41, s42, s41
  s_lshl_b32 s26, s41, 8
  s_mul_i32 s31, s41, 442368
  s_add_u32 s41, s43, 1
  s_sub_u32 s42, s41, 5
  s_cmp_ge_u32 s41, 5
  s_cselect_b32 s41, s42, s41
  s_lshl_b32 s27, s41, 8
  s_mul_i32 s32, s41, 442368
  s_add_u32 s41, s43, 2
  s_sub_u32 s42, s41, 5
  s_cmp_ge_u32 s41, 5
  s_cselect_b32 s41, s42, s41
  s_lshl_b32 s28, s41, 8
  s_mul_i32 s33, s41, 442368
  s_add_u32 s41, s43, 3
  s_sub_u32 s42, s41, 5
  s_cmp_ge_u32 s41, 5
  s_cselect_b32 s41, s42, s41
  s_lshl_b32 s29, s41, 8
  s_mul_i32 s34, s41, 442368
  s_add_u32 s41, s43, 4
  s_sub_u32 s42, s41, 5
  s_cmp_ge_u32 s41, 5
  s_cselect_b32 s41, s42, s41
  s_lshl_b32 s30, s41, 8
  s_mul_i32 s35, s41, 442368
  s_waitcnt lgkmcnt(0)
  s_mov_b32 s4, s60
  s_and_b32 s5, s61, 0xffff
  s_mov_b32 s6, 2621440
  s_mov_b32 s7, 0x20000
  s_mov_b32 s8, s64
  s_and_b32 s9, s65, 0xffff
  s_mov_b32 s10, 2211840
  s_mov_b32 s11, 0x20000
  s_mov_b32 s12, s70
  s_and_b32 s13, s71, 0xffff
  s_mov_b32 s14, 9699328
  s_mov_b32 s15, 0x20000
  s_mov_b32 s16, s66
  s_and_b32 s17, s67, 0xffff
  s_mov_b32 s18, 3456
  s_mov_b32 s19, 0x20000
  s_lshl_b32 s41, s25, 7
  s_lshl_b32 s42, s20, 5
  s_add_u32 s41, s41, s42
  v_bfe_u32 v2, v1, 5, 1
  v_bfe_u32 v3, v1, 3, 2
  v_lshl_add_u32 v2, v3, 1, v2
  v_add_u32 v2, s41, v2
  v_lshlrev_b32 v2, 1, v2
  v_add_u32 v2, s21, v2
  v_mul_u32_u24 v2, 1280, v2
  s_lshl_b32 s40, s20, 12
  v_lshrrev_b32 v3, 4, v1
  v_xor_b32 v3, v3, v1
  v_and_b32 v3, 7, v3
  v_lshlrev_b32 v3, 4, v3
  v_add_u32 v92, v3, v2
  v_xor_b32 v3, 64, v3
  v_add_u32 v93, v3, v2
  v_add_u32 v93, 20480, v93
  s_add_u32 m0, s40, 32768
  s_nop 0
  buffer_load_dwordx4 v92, s[4:7], s26 offen offset:0 lds
  s_add_u32 m0, s40, 33792
  s_nop 0
  buffer_load_dwordx4 v93, s[4:7], s26 offen offset:0 lds
  s_add_u32 m0, s40, 34688
  s_nop 0
  buffer_load_dwordx4 v92, s[4:7], s26 offen offset:128 lds
  s_add_u32 m0, s40, 35712
  s_nop 0
  buffer_load_dwordx4 v93, s[4:7], s26 offen offset:128 lds
  s_add_u32 m0, s40, 49152
  s_nop 0
  buffer_load_dwordx4 v92, s[4:7], s27 offen offset:0 lds
  s_add_u32 m0, s40, 50176
  s_nop 0
  buffer_load_dwordx4 v93, s[4:7], s27 offen offset:0 lds
  s_add_u32 m0, s40, 51072
  s_nop 0
  buffer_load_dwordx4 v92, s[4:7], s27 offen offset:128 lds
  s_add_u32 m0, s40, 52096
  s_nop 0
  buffer_load_dwordx4 v93, s[4:7], s27 offen offset:128 lds
  s_add_u32 m0, s40, 65536
  s_nop 0
  buffer_load_dwordx4 v92, s[4:7], s28 offen offset:0 lds
  s_add_u32 m0, s40, 66560
  s_nop 0
  buffer_load_dwordx4 v93, s[4:7], s28 offen offset:0 lds
  s_add_u32 m0, s40, 67456
  s_nop 0
  buffer_load_dwordx4 v92, s[4:7], s28 offen offset:128 lds
  s_add_u32 m0, s40, 68480
  s_nop 0
  buffer_load_dwordx4 v93, s[4:7], s28 offen offset:128 lds
  s_lshr_b32 s43, s25, 1
  s_mul_i32 s43, s43, 1
  s_lshl_b32 s55, s21, 6
  s_lshl_b32 s41, s25, 3
  s_add_u32 s55, s55, s41
  s_lshl_b32 s41, s20, 1
  s_add_u32 s55, s55, s41
  s_mul_i32 s55, s55, 75776
  s_add_u32 s41, s43, 0
  s_and_b32 s41, s41, 3
  s_lshl_b32 s48, s41, 8
  s_lshl_b32 s42, s24, 2
  s_add_u32 s41, s41, s42
  s_min_u32 s41, s41, 26
  s_lshl_b32 s36, s41, 7
  s_lshl_b32 s41, s41, 11
  s_add_u32 s44, s41, s55
  s_add_u32 s41, s43, 1
  s_and_b32 s41, s41, 3
  s_lshl_b32 s49, s41, 8
  s_lshl_b32 s42, s24, 2
  s_add_u32 s41, s41, s42
  s_min_u32 s41, s41, 26
  s_lshl_b32 s37, s41, 7
  s_lshl_b32 s41, s41, 11
  s_add_u32 s45, s41, s55
  s_add_u32 s41, s43, 2
  s_and_b32 s41, s41, 3
  s_lshl_b32 s50, s41, 8
  s_lshl_b32 s42, s24, 2
  s_add_u32 s41, s41, s42
  s_min_u32 s41, s41, 26
  s_lshl_b32 s38, s41, 7
  s_lshl_b32 s41, s41, 11
  s_add_u32 s46, s41, s55
  s_add_u32 s41, s43, 3
  s_and_b32 s41, s41, 3
  s_lshl_b32 s51, s41, 8
  s_lshl_b32 s42, s24, 2
  s_add_u32 s41, s41, s42
  s_min_u32 s41, s41, 26
  s_lshl_b32 s39, s41, 7
  s_lshl_b32 s41, s41, 11
  s_add_u32 s47, s41, s55
  s_lshl_b32 s41, s24, 2
  s_add_u32 s41, s41, s20
  s_min_u32 s41, s41, 26
  s_lshl_b32 s41, s41, 7
  v_lshlrev_b32 v2, 1, v1
  buffer_load_ushort v94, v2, s[16:19], s41 offen
  v_lshrrev_b32 v2, 3, v1
  s_lshl_b32 s41, s20, 5
  v_add_u32 v2, s41, v2
  v_mul_u32_u24 v2, 3456, v2
  v_and_b32 v3, 7, v1
  v_bfe_u32 v4, v1, 4, 1
  v_lshlrev_b32 v4, 2, v4
  v_xor_b32 v3, v3, v4
  v_lshl_add_u32 v6, v3, 4, v2
  v_add_u32 v7, 26624, v6
  v_add_u32 v8, 26624, v7
  v_add_u32 v9, 26624, v8
  v_lshrrev_b32 v2, 5, v1
  v_lshlrev_b32 v2, 4, v2
  v_bfe_u32 v3, v1, 2, 2
  v_add_u32 v2, v2, v3
  v_lshlrev_b32 v2, 7, v2
  v_bfe_u32 v3, v1, 4, 1
  v_lshlrev_b32 v3, 1, v3
  v_bfe_u32 v4, v1, 1, 1
  v_add_u32 v3, v3, v4
  v_bfe_u32 v4, v1, 3, 1
  v_lshl_add_u32 v3, v4, 2, v3
  v_lshl_add_u32 v2, v3, 4, v2
  v_and_b32 v3, 1, v1
  v_lshl_add_u32 v11, v3, 3, v2
  v_xor_b32 v12, 64, v11
  v_add_u32 v13, 0x10000, v11
  v_add_u32 v14, 0x10000, v12
  v_bfe_u32 v2, v1, 4, 1
  v_mul_u32_u24 v2, 75776, v2
  v_lshrrev_b32 v3, 5, v1
  v_lshl_add_u32 v2, v3, 8, v2
  v_and_b32 v4, 15, v1
  v_lshl_add_u32 v15, v4, 4, v2
  v_lshlrev_b32 v10, 4, v3
  v_add_u32 v10, 114688, v10
  v_mov_b32 v17, 0xbdd2d3e8
  s_and_b32 s41, s2, 7
  s_lshl_b32 s41, s41, 2
  s_lshr_b32 s42, s2, 6
  s_add_u32 s100, s41, s42
  s_bfe_u32 s101, s2, 0x30003
  s_mul_i32 s62, s100, 303104
  s_mul_i32 s63, s101, 378880
  v_mov_b32 v32, 0x3f803f80
  v_mov_b32 v33, v32
  v_mov_b32 v34, v32
  v_mov_b32 v35, v32
  v_and_b32 v44, 15, v1
  v_lshrrev_b32 v45, 4, v1
  v_lshrrev_b32 v46, 2, v44
  v_and_b32 v47, 1, v1
  v_lshlrev_b32 v47, 4, v47
  v_mov_b32 v48, 0x3f80
  v_lshlrev_b32 v48, v47, v48
  v_cmp_eq_u32 vcc, v45, v46
  s_nop 1
  v_cndmask_b32 v48, 0, v48, vcc
  v_and_b32 v47, 2, v1
  v_cmp_eq_u32 vcc, 0, v47
  v_mov_b32 v36, 0
  v_mov_b32 v37, 0
  v_cndmask_b32 v38, 0, v48, vcc
  v_cndmask_b32 v39, v48, 0, vcc
  v_mov_b32 v40, 0
  v_mov_b32 v41, 0
  v_bfe_u32 v42, v1, 1, 3
  v_lshrrev_b32 v43, 4, v1
  v_xor_b32 v42, v42, v43
  v_and_b32 v43, 15, v1
  v_lshlrev_b32 v43, 7, v43
  v_lshl_add_u32 v42, v42, 4, v43
  s_add_u32 s41, s40, 32768
  v_add_u32 v42, s41, v42
  v_xor_b32 v43, 64, v42
  v_add_u32 v88, 49152, v42
  v_add_u32 v89, 49152, v43
  s_add_u32 m0, s40, 81920
  s_nop 0
  buffer_load_dwordx4 v92, s[4:7], s29 offen offset:0 lds
  s_add_u32 m0, s40, 82944
  s_nop 0
  buffer_load_dwordx4 v93, s[4:7], s29 offen offset:0 lds
  s_add_u32 m0, s40, 83840
  s_nop 0
  buffer_load_dwordx4 v92, s[4:7], s29 offen offset:128 lds
  s_add_u32 m0, s40, 84864
  s_nop 0
  buffer_load_dwordx4 v93, s[4:7], s29 offen offset:128 lds
  s_add_u32 m0, s40, 98304
  s_nop 0
  buffer_load_dwordx4 v92, s[4:7], s30 offen offset:0 lds
  s_add_u32 m0, s40, 99328
  s_nop 0
  buffer_load_dwordx4 v93, s[4:7], s30 offen offset:0 lds
  s_add_u32 m0, s40, 100224
  s_nop 0
  buffer_load_dwordx4 v92, s[4:7], s30 offen offset:128 lds
  s_add_u32 m0, s40, 101248
  s_nop 0
  buffer_load_dwordx4 v93, s[4:7], s30 offen offset:128 lds
  s_getpc_b64 s[72:73]
L_pcw:
  s_sub_u32 s72, s72, L_pcw-L_w1
  s_subb_u32 s73, s73, 0
  s_lshl_b32 s74, s20, 11
  s_bfe_u32 s75, s2, 0x20003
  s_lshl_b32 s75, s75, 13
  s_add_u32 s74, s74, s75
  v_lshlrev_b32 v254, 7, v1
  v_add_u32 v254, s74, v254
  v_min_u32 v254, L_end1-L_w1, v254
  v_mov_b32 v255, s73
  v_add_co_u32 v254, vcc, s72, v254
  s_nop 1
  v_addc_co_u32 v255, vcc, 0, v255, vcc
  s_add_u32 s76, s70, 13631488
  s_addc_u32 s77, s71, 0
  s_and_b32 s77, s77, 0xffff
  s_mov_b32 s78, 37888
  s_mov_b32 s79, 0x20000
  s_lshr_b32 s72, s100, 4
  s_and_b32 s73, s100, 15
  s_lshr_b32 s74, s73, 1
  s_lshl_b32 s75, s72, 3
  s_add_u32 s75, s75, s74
  s_mul_i32 s72, s72, 9
  s_add_u32 s72, s72, s74
  s_add_u32 s72, s72, 16
  s_and_b32 s73, s73, 1
  s_add_u32 s73, s73, s72
  v_mov_b32 v96, s73
  v_mov_b32 v97, s72
  v_cmp_gt_u32 vcc, 16, v1
  s_nop 1
  v_cndmask_b32 v96, v96, v97, vcc
  v_mov_b32 v97, s75
  v_cmp_gt_u32 vcc, 8, v1
  s_nop 1
  v_cndmask_b32 v96, v96, v97, vcc
  v_and_b32 v97, 7, v1
  v_lshlrev_b32 v97, 7, v97
  v_lshl_add_u32 v96, v96, 10, v97
  s_lshl_b32 s72, s21, 3
  s_add_u32 s72, s72, s25
  s_lshl_b32 s72, s72, 10
  s_lshl_b32 s73, s24, 7
  s_add_u32 s72, s72, s73
  v_writelane_b32 v96, s72, 24
  s_lshl_b32 s72, s2, 2
  s_add_u32 s72, s72, 36864
  s_cmp_lt_u32 s2, 192
  s_cselect_b32 s72, s72, 0x40000000
  v_writelane_b32 v96, s72, 25
  s_cmp_eq_u32 s20, 0
  s_cselect_b32 s72, 36864, 0x40000000
  v_mul_u32_u24 v97, 12, v1
  v_add_u32 v97, s72, v97
  v_cmp_gt_u32 vcc, 26, v1
  v_mov_b32 v98, 0x40000000
  s_nop 0
  v_cndmask_b32 v96, v98, v96, vcc
  buffer_load_dword a35, v96, s[76:79], 0 offen sc1
  buffer_load_dwordx3 a[32:34], v97, s[76:79], 0 offen sc1
  s_waitcnt vmcnt(21)
  ds_read_b128 v[96:99], v42 offset:0
  ds_read_b128 v[100:103], v43 offset:0
  s_waitcnt vmcnt(19)
  ds_read_b128 v[104:107], v42 offset:2048
  s_waitcnt lgkmcnt(2)
  v_mfma_f32_16x16x32_bf16 v[44:47], v[32:35], v[96:99], 0
  v_mfma_f32_16x16x32_bf16 v[52:55], v[96:99], v[96:99], 0
  ds_read_b128 v[108:111], v43 offset:2048
  s_waitcnt lgkmcnt(2)
  v_mfma_f32_16x16x32_bf16 v[44:47], v[32:35], v[100:103], v[44:47]
  v_mfma_f32_16x16x32_bf16 v[52:55], v[100:103], v[100:103], v[52:55]
  s_add_u32 s42, s26, 40960
  s_add_u32 m0, s40, 32768
  s_nop 0
  buffer_load_dwordx4 v92, s[4:7], s42 offen offset:0 lds
  s_add_u32 m0, s40, 33792
  s_nop 0
  buffer_load_dwordx4 v93, s[4:7], s42 offen offset:0 lds
  s_mov_b32 exec_lo, 0xffff
  s_mov_b32 exec_hi, 0
  global_load_dword a31, v[254:255], off
  s_mov_b64 exec, -1
  s_waitcnt vmcnt(20)
  ds_read_b128 v[112:115], v42 offset:16384
  s_waitcnt lgkmcnt(2)
  v_mfma_f32_16x16x32_bf16 v[44:47], v[32:35], v[104:107], v[44:47]
  v_mfma_f32_16x16x32_bf16 v[52:55], v[104:107], v[104:107], v[52:55]
  ds_read_b128 v[116:119], v43 offset:16384
  s_waitcnt lgkmcnt(2)
  v_mfma_f32_16x16x32_bf16 v[44:47], v[32:35], v[108:111], v[44:47]
  v_mfma_f32_16x16x32_bf16 v[52:55], v[108:111], v[108:111], v[52:55]
  s_add_u32 m0, s40, 34688
  s_nop 0
  buffer_load_dwordx4 v92, s[4:7], s42 offen offset:128 lds
  s_add_u32 m0, s40, 35712
  s_nop 0
  buffer_load_dwordx4 v93, s[4:7], s42 offen offset:128 lds
  s_waitcnt vmcnt(20)
  ds_read_b128 v[120:123], v42 offset:18432
  s_waitcnt lgkmcnt(2)
  v_mfma_f32_16x16x32_bf16 v[44:47], v[32:35], v[112:115], v[44:47]
  v_mfma_f32_16x16x32_bf16 v[52:55], v[112:115], v[112:115], v[52:55]
  ds_read_b128 v[124:127], v43 offset:18432
  s_waitcnt lgkmcnt(2)
  v_mfma_f32_16x16x32_bf16 v[44:47], v[32:35], v[116:119], v[44:47]
  v_mfma_f32_16x16x32_bf16 v[52:55], v[116:119], v[116:119], v[52:55]
  s_add_u32 s42, s27, 40960
  s_add_u32 m0, s40, 49152
  s_nop 0
  buffer_load_dwordx4 v92, s[4:7], s42 offen offset:0 lds
  s_add_u32 m0, s40, 50176
  s_nop 0
  buffer_load_dwordx4 v93, s[4:7], s42 offen offset:0 lds
  s_waitcnt vmcnt(20)
  ds_read_b128 v[128:131], v42 offset:32768
  s_waitcnt lgkmcnt(2)
  v_mfma_f32_16x16x32_bf16 v[44:47], v[32:35], v[120:123], v[44:47]
  v_mfma_f32_16x16x32_bf16 v[52:55], v[120:123], v[120:123], v[52:55]
  ds_read_b128 v[132:135], v43 offset:32768
  s_waitcnt lgkmcnt(2)
  v_mfma_f32_16x16x32_bf16 v[44:47], v[32:35], v[124:127], v[44:47]
  v_mfma_f32_16x16x32_bf16 v[52:55], v[124:127], v[124:127], v[52:55]
  s_add_u32 m0, s40, 51072
  s_nop 0
  buffer_load_dwordx4 v92, s[4:7], s42 offen offset:128 lds
  s_add_u32 m0, s40, 52096
  s_nop 0
  buffer_load_dwordx4 v93, s[4:7], s42 offen offset:128 lds
  s_waitcnt vmcnt(20)
  ds_read_b128 v[136:139], v42 offset:34816
  s_waitcnt lgkmcnt(2)
  v_mfma_f32_16x16x32_bf16 v[44:47], v[32:35], v[128:131], v[44:47]
  v_mfma_f32_16x16x32_bf16 v[52:55], v[128:131], v[128:131], v[52:55]
  ds_read_b128 v[140:143], v43 offset:34816
  s_waitcnt lgkmcnt(2)
  v_mfma_f32_16x16x32_bf16 v[44:47], v[32:35], v[132:135], v[44:47]
  v_mfma_f32_16x16x32_bf16 v[52:55], v[132:135], v[132:135], v[52:55]
  s_add_u32 s42, s28, 40960
  s_add_u32 m0, s40, 65536
  s_nop 0
  buffer_load_dwordx4 v92, s[4:7], s42 offen offset:0 lds
  s_add_u32 m0, s40, 66560
  s_nop 0
  buffer_load_dwordx4 v93, s[4:7], s42 offen offset:0 lds
  s_waitcnt vmcnt(19)
  ds_read_b128 v[144:147], v88 offset:0
  s_waitcnt lgkmcnt(2)
  v_mfma_f32_16x16x32_bf16 v[44:47], v[32:35], v[136:139], v[44:47]
  v_mfma_f32_16x16x32_bf16 v[52:55], v[136:139], v[136:139], v[52:55]
  ds_read_b128 v[148:151], v89 offset:0
  s_waitcnt lgkmcnt(2)
  v_mfma_f32_16x16x32_bf16 v[44:47], v[32:35], v[140:143], v[44:47]
  v_mfma_f32_16x16x32_bf16 v[52:55], v[140:143], v[140:143], v[52:55]
  s_add_u32 m0, s40, 67456
  s_nop 0
  buffer_load_dwordx4 v92, s[4:7], s42 offen offset:128 lds
  s_add_u32 m0, s40, 68480
  s_nop 0
  buffer_load_dwordx4 v93, s[4:7], s42 offen offset:128 lds
  s_waitcnt vmcnt(19)
  ds_read_b128 v[152:155], v88 offset:2048
  s_waitcnt lgkmcnt(2)
  v_mfma_f32_16x16x32_bf16 v[44:47], v[32:35], v[144:147], v[44:47]
  v_mfma_f32_16x16x32_bf16 v[52:55], v[144:147], v[144:147], v[52:55]
  ds_read_b128 v[156:159], v89 offset:2048
  s_waitcnt lgkmcnt(2)
  v_mfma_f32_16x16x32_bf16 v[44:47], v[32:35], v[148:151], v[44:47]
  v_mfma_f32_16x16x32_bf16 v[52:55], v[148:151], v[148:151], v[52:55]
  s_add_u32 s42, s29, 40960
  s_add_u32 m0, s40, 81920
  s_nop 0
  buffer_load_dwordx4 v92, s[4:7], s42 offen offset:0 lds
  s_add_u32 m0, s40, 82944
  s_nop 0
  buffer_load_dwordx4 v93, s[4:7], s42 offen offset:0 lds
  s_waitcnt vmcnt(19)
  ds_read_b128 v[160:163], v88 offset:16384
  s_waitcnt lgkmcnt(2)
  v_mfma_f32_16x16x32_bf16 v[44:47], v[32:35], v[152:155], v[44:47]
  v_mfma_f32_16x16x32_bf16 v[52:55], v[152:155], v[152:155], v[52:55]
  ds_read_b128 v[164:167], v89 offset:16384
  s_waitcnt lgkmcnt(2)
  v_mfma_f32_16x16x32_bf16 v[44:47], v[32:35], v[156:159], v[44:47]
  v_mfma_f32_16x16x32_bf16 v[52:55], v[156:159], v[156:159], v[52:55]
  s_add_u32 m0, s40, 83840
  s_nop 0
  buffer_load_dwordx4 v92, s[4:7], s42 offen offset:128 lds
  s_add_u32 m0, s40, 84864
  s_nop 0
  buffer_load_dwordx4 v93, s[4:7], s42 offen offset:128 lds
  s_waitcnt vmcnt(19)
  ds_read_b128 v[168:171], v88 offset:18432
  s_waitcnt lgkmcnt(2)
  v_mfma_f32_16x16x32_bf16 v[44:47], v[32:35], v[160:163], v[44:47]
  v_mfma_f32_16x16x32_bf16 v[52:55], v[160:163], v[160:163], v[52:55]
  ds_read_b128 v[172:175], v89 offset:18432
  s_waitcnt lgkmcnt(2)
  v_mfma_f32_16x16x32_bf16 v[44:47], v[32:35], v[164:167], v[44:47]
  v_mfma_f32_16x16x32_bf16 v[52:55], v[164:167], v[164:167], v[52:55]
  s_add_u32 s42, s30, 40960
  s_add_u32 m0, s40, 98304
  s_nop 0
  buffer_load_dwordx4 v92, s[4:7], s42 offen offset:0 lds
  s_add_u32 m0, s40, 99328
  s_nop 0
  buffer_load_dwordx4 v93, s[4:7], s42 offen offset:0 lds
  s_waitcnt lgkmcnt(1)
  v_mfma_f32_16x16x32_bf16 v[44:47], v[32:35], v[168:171], v[44:47]
  v_mfma_f32_16x16x32_bf16 v[52:55], v[168:171], v[168:171], v[52:55]
  s_waitcnt lgkmcnt(0)
  v_mfma_f32_16x16x32_bf16 v[44:47], v[32:35], v[172:175], v[44:47]
  v_mfma_f32_16x16x32_bf16 v[52:55], v[172:175], v[172:175], v[52:55]
  s_add_u32 m0, s40, 100224
  s_nop 0
  buffer_load_dwordx4 v92, s[4:7], s42 offen offset:128 lds
  s_add_u32 m0, s40, 101248
  s_nop 0
  buffer_load_dwordx4 v93, s[4:7], s42 offen offset:128 lds
  s_nop 0
  v_mul_f32 v60, 0xbacccccd, v44
  v_mul_f32 v61, 0xbacccccd, v45
  v_mul_f32 v62, 0xbacccccd, v46
  v_mul_f32 v63, 0xbacccccd, v47
  s_nop 1
  v_mfma_f32_16x16x32_bf16 v[68:71], v[38:41], v[96:99], v[60:63]
  v_mfma_f32_16x16x32_bf16 v[72:75], v[36:39], v[96:99], v[60:63]
  s_lshl_b32 s73, s2, 2
  s_add_u32 s73, s73, s20
  s_min_u32 s73, s73, 739
  s_mul_i32 s74, s73, 6554
  s_lshr_b32 s74, s74, 16
  s_mul_i32 s75, s74, 10
  s_sub_u32 s75, s73, s75
  s_mov_b32 s96, s74
  v_mfma_f32_16x16x32_bf16 v[76:79], v[38:41], v[100:103], v[60:63]
  v_mfma_f32_16x16x32_bf16 v[80:83], v[36:39], v[100:103], v[60:63]
  v_cvt_pk_bf16_f32 v96, v68, v69
  v_cvt_pk_bf16_f32 v97, v70, v71
  v_cvt_pk_bf16_f32 v98, v72, v73
  v_cvt_pk_bf16_f32 v99, v74, v75
  s_mov_b32 s97, s75
  s_sub_u32 s76, s74, 54
  s_mul_i32 s77, s76, 52
  s_lshr_b32 s77, s77, 8
  s_mul_i32 s78, s77, 5
  s_sub_u32 s78, s76, s78
  s_mul_i32 s77, s77, 160
  s_lshr_b32 s79, s78, 1
  v_mfma_f32_16x16x32_bf16 v[20:23], v[38:41], v[104:107], v[60:63]
  v_mfma_f32_16x16x32_bf16 v[24:27], v[36:39], v[104:107], v[60:63]
  v_cvt_pk_bf16_f32 v100, v76, v77
  v_cvt_pk_bf16_f32 v101, v78, v79
  v_cvt_pk_bf16_f32 v102, v80, v81
  v_cvt_pk_bf16_f32 v103, v82, v83
  s_mul_i32 s79, s79, 80
  s_and_b32 s76, s78, 1
  s_lshl_b32 s76, s76, 3
  s_add_u32 s79, s79, s76
  s_cmp_eq_u32 s78, 4
  s_cselect_b32 s79, 16, s79
  s_cselect_b32 s76, 80, 40
  s_cselect_b32 s78, 40, 20
  v_mfma_f32_16x16x32_bf16 v[68:71], v[38:41], v[108:111], v[60:63]
  v_mfma_f32_16x16x32_bf16 v[72:75], v[36:39], v[108:111], v[60:63]
  v_cvt_pk_bf16_f32 v104, v20, v21
  v_cvt_pk_bf16_f32 v105, v22, v23
  v_cvt_pk_bf16_f32 v106, v24, v25
  v_cvt_pk_bf16_f32 v107, v26, v27
  s_cselect_b32 s73, 20, 4
  s_add_u32 s77, s77, s79
  s_lshl_b32 s79, s74, 5
  s_cmp_lt_u32 s74, 54
  s_cselect_b32 s77, s79, s77
  s_cselect_b32 s76, 16, s76
  s_cselect_b32 s78, 4, s78
  s_cselect_b32 s73, 8, s73
  v_mfma_f32_16x16x32_bf16 v[76:79], v[38:41], v[112:115], v[60:63]
  v_mfma_f32_16x16x32_bf16 v[80:83], v[36:39], v[112:115], v[60:63]
  v_cvt_pk_bf16_f32 v108, v68, v69
  v_cvt_pk_bf16_f32 v109, v70, v71
  v_cvt_pk_bf16_f32 v110, v72, v73
  v_cvt_pk_bf16_f32 v111, v74, v75
  s_cselect_b32 s16, s56, s58
  s_cselect_b32 s17, s57, s59
  s_cselect_b32 s18, 27, 10
  s_mul_i32 s18, s18, 81920
  s_and_b32 s17, s17, 0xffff
  s_cmp_lt_u32 s2, 192
  s_cselect_b32 s18, s18, 0
  s_mov_b32 s19, 0x20000
  v_mfma_f32_16x16x32_bf16 v[20:23], v[38:41], v[116:119], v[60:63]
  v_mfma_f32_16x16x32_bf16 v[24:27], v[36:39], v[116:119], v[60:63]
  v_cvt_pk_bf16_f32 v112, v76, v77
  v_cvt_pk_bf16_f32 v113, v78, v79
  v_cvt_pk_bf16_f32 v114, v80, v81
  v_cvt_pk_bf16_f32 v115, v82, v83
  v_lshrrev_b32 v90, 5, v1
  v_mul_lo_u32 v90, v90, s73
  v_bfe_u32 v91, v1, 3, 2
  v_add_u32 v90, v90, v91
  v_mul_u32_u24 v90, 1280, v90
  v_and_b32 v91, 7, v1
  v_lshl_add_u32 v90, v91, 4, v90
  s_mul_i32 s77, s77, 1280
  v_mfma_f32_16x16x32_bf16 v[68:71], v[38:41], v[120:123], v[60:63]
  v_mfma_f32_16x16x32_bf16 v[72:75], v[36:39], v[120:123], v[60:63]
  v_cvt_pk_bf16_f32 v116, v20, v21
  v_cvt_pk_bf16_f32 v117, v22, v23
  v_cvt_pk_bf16_f32 v118, v24, v25
  v_cvt_pk_bf16_f32 v119, v26, v27
  s_lshl_b32 s75, s75, 7
  s_add_u32 s77, s77, s75
  s_mul_i32 s76, s76, 1280
  s_mul_i32 s78, s78, 1280
  v_mfma_f32_16x16x32_bf16 v[76:79], v[38:41], v[124:127], v[60:63]
  v_mfma_f32_16x16x32_bf16 v[80:83], v[36:39], v[124:127], v[60:63]
  v_cvt_pk_bf16_f32 v120, v68, v69
  v_cvt_pk_bf16_f32 v121, v70, v71
  v_cvt_pk_bf16_f32 v122, v72, v73
  v_cvt_pk_bf16_f32 v123, v74, v75
  s_waitcnt vmcnt(19)
  ds_read_b128 v[176:179], v42 offset:0
  v_mfma_f32_16x16x32_bf16 v[20:23], v[38:41], v[128:131], v[60:63]
  v_mfma_f32_16x16x32_bf16 v[24:27], v[36:39], v[128:131], v[60:63]
  v_cvt_pk_bf16_f32 v124, v76, v77
  v_cvt_pk_bf16_f32 v125, v78, v79
  v_cvt_pk_bf16_f32 v126, v80, v81
  v_cvt_pk_bf16_f32 v127, v82, v83
  ds_read_b128 v[180:183], v43 offset:0
  v_mfma_f32_16x16x32_bf16 v[68:71], v[38:41], v[132:135], v[60:63]
  v_mfma_f32_16x16x32_bf16 v[72:75], v[36:39], v[132:135], v[60:63]
  v_cvt_pk_bf16_f32 v128, v20, v21
  v_cvt_pk_bf16_f32 v129, v22, v23
  v_cvt_pk_bf16_f32 v130, v24, v25
  v_cvt_pk_bf16_f32 v131, v26, v27
  s_waitcnt vmcnt(16)
  ds_read_b128 v[184:187], v42 offset:2048
  v_mfma_f32_16x16x32_bf16 v[76:79], v[38:41], v[136:139], v[60:63]
  v_mfma_f32_16x16x32_bf16 v[80:83], v[36:39], v[136:139], v[60:63]
  s_waitcnt lgkmcnt(2)
  v_mfma_f32_16x16x32_bf16 v[48:51], v[32:35], v[176:179], 0
  v_mfma_f32_16x16x32_bf16 v[56:59], v[176:179], v[176:179], 0
  v_cvt_pk_bf16_f32 v132, v68, v69
  v_cvt_pk_bf16_f32 v133, v70, v71
  v_cvt_pk_bf16_f32 v134, v72, v73
  v_cvt_pk_bf16_f32 v135, v74, v75
  ds_read_b128 v[188:191], v43 offset:2048
  v_mfma_f32_16x16x32_bf16 v[20:23], v[38:41], v[140:143], v[60:63]
  v_mfma_f32_16x16x32_bf16 v[24:27], v[36:39], v[140:143], v[60:63]
  s_waitcnt lgkmcnt(2)
  v_mfma_f32_16x16x32_bf16 v[48:51], v[32:35], v[180:183], v[48:51]
  v_mfma_f32_16x16x32_bf16 v[56:59], v[180:183], v[180:183], v[56:59]
  v_cvt_pk_bf16_f32 v136, v76, v77
  v_cvt_pk_bf16_f32 v137, v78, v79
  v_cvt_pk_bf16_f32 v138, v80, v81
  v_cvt_pk_bf16_f32 v139, v82, v83
  s_waitcnt vmcnt(14)
  ds_read_b128 v[192:195], v42 offset:16384
  v_mfma_f32_16x16x32_bf16 v[68:71], v[38:41], v[144:147], v[60:63]
  v_mfma_f32_16x16x32_bf16 v[72:75], v[36:39], v[144:147], v[60:63]
  s_waitcnt lgkmcnt(2)
  v_mfma_f32_16x16x32_bf16 v[48:51], v[32:35], v[184:187], v[48:51]
  v_mfma_f32_16x16x32_bf16 v[56:59], v[184:187], v[184:187], v[56:59]
  v_cvt_pk_bf16_f32 v140, v20, v21
  v_cvt_pk_bf16_f32 v141, v22, v23
  v_cvt_pk_bf16_f32 v142, v24, v25
  v_cvt_pk_bf16_f32 v143, v26, v27
  s_add_u32 s41, s31, s36
  s_add_u32 m0, s40, 0
  s_nop 0
  buffer_load_dwordx4 v6, s[8:11], s41 offen offset:0 lds
  ds_read_b128 v[196:199], v43 offset:16384
  v_mfma_f32_16x16x32_bf16 v[76:79], v[38:41], v[148:151], v[60:63]
  v_mfma_f32_16x16x32_bf16 v[80:83], v[36:39], v[148:151], v[60:63]
  s_waitcnt lgkmcnt(2)
  v_mfma_f32_16x16x32_bf16 v[48:51], v[32:35], v[188:191], v[48:51]
  v_mfma_f32_16x16x32_bf16 v[56:59], v[188:191], v[188:191], v[56:59]
  v_cvt_pk_bf16_f32 v144, v68, v69
  v_cvt_pk_bf16_f32 v145, v70, v71
  v_cvt_pk_bf16_f32 v146, v72, v73
  v_cvt_pk_bf16_f32 v147, v74, v75
  s_add_u32 m0, s40, 0
  s_nop 0
  buffer_load_dwordx4 v7, s[8:11], s41 offen offset:1024 lds
  s_waitcnt vmcnt(14)
  ds_read_b128 v[200:203], v42 offset:18432
  v_mfma_f32_16x16x32_bf16 v[20:23], v[38:41], v[152:155], v[60:63]
  v_mfma_f32_16x16x32_bf16 v[24:27], v[36:39], v[152:155], v[60:63]
  s_waitcnt lgkmcnt(2)
  v_mfma_f32_16x16x32_bf16 v[48:51], v[32:35], v[192:195], v[48:51]
  v_mfma_f32_16x16x32_bf16 v[56:59], v[192:195], v[192:195], v[56:59]
  v_cvt_pk_bf16_f32 v148, v76, v77
  v_cvt_pk_bf16_f32 v149, v78, v79
  v_cvt_pk_bf16_f32 v150, v80, v81
  v_cvt_pk_bf16_f32 v151, v82, v83
  s_add_u32 m0, s40, 0
  s_nop 0
  buffer_load_dwordx4 v8, s[8:11], s41 offen offset:2048 lds
  ds_read_b128 v[204:207], v43 offset:18432
  v_mfma_f32_16x16x32_bf16 v[68:71], v[38:41], v[156:159], v[60:63]
  v_mfma_f32_16x16x32_bf16 v[72:75], v[36:39], v[156:159], v[60:63]
  s_waitcnt lgkmcnt(2)
  v_mfma_f32_16x16x32_bf16 v[48:51], v[32:35], v[196:199], v[48:51]
  v_mfma_f32_16x16x32_bf16 v[56:59], v[196:199], v[196:199], v[56:59]
  v_cvt_pk_bf16_f32 v152, v20, v21
  v_cvt_pk_bf16_f32 v153, v22, v23
  v_cvt_pk_bf16_f32 v154, v24, v25
  v_cvt_pk_bf16_f32 v155, v26, v27
  s_add_u32 m0, s40, 0
  s_nop 0
  buffer_load_dwordx4 v9, s[8:11], s41 offen offset:3072 lds
  s_waitcnt vmcnt(14)
  ds_read_b128 v[208:211], v42 offset:32768
  v_mfma_f32_16x16x32_bf16 v[76:79], v[38:41], v[160:163], v[60:63]
  v_mfma_f32_16x16x32_bf16 v[80:83], v[36:39], v[160:163], v[60:63]
  s_waitcnt lgkmcnt(2)
  v_mfma_f32_16x16x32_bf16 v[48:51], v[32:35], v[200:203], v[48:51]
  v_mfma_f32_16x16x32_bf16 v[56:59], v[200:203], v[200:203], v[56:59]
  v_cvt_pk_bf16_f32 v156, v68, v69
  v_cvt_pk_bf16_f32 v157, v70, v71
  v_cvt_pk_bf16_f32 v158, v72, v73
  v_cvt_pk_bf16_f32 v159, v74, v75
  s_add_u32 s41, s32, s36
  s_add_u32 m0, s40, 16384
  s_nop 0
  buffer_load_dwordx4 v6, s[8:11], s41 offen offset:0 lds
  ds_read_b128 v[212:215], v43 offset:32768
  v_mfma_f32_16x16x32_bf16 v[20:23], v[38:41], v[164:167], v[60:63]
  v_mfma_f32_16x16x32_bf16 v[24:27], v[36:39], v[164:167], v[60:63]
  s_waitcnt lgkmcnt(2)
  v_mfma_f32_16x16x32_bf16 v[48:51], v[32:35], v[204:207], v[48:51]
  v_mfma_f32_16x16x32_bf16 v[56:59], v[204:207], v[204:207], v[56:59]
  v_cvt_pk_bf16_f32 v160, v76, v77
  v_cvt_pk_bf16_f32 v161, v78, v79
  v_cvt_pk_bf16_f32 v162, v80, v81
  v_cvt_pk_bf16_f32 v163, v82, v83
  s_add_u32 m0, s40, 16384
  s_nop 0
  buffer_load_dwordx4 v7, s[8:11], s41 offen offset:1024 lds
  s_waitcnt vmcnt(14)
  ds_read_b128 v[216:219], v42 offset:34816
  v_mfma_f32_16x16x32_bf16 v[68:71], v[38:41], v[168:171], v[60:63]
  v_mfma_f32_16x16x32_bf16 v[72:75], v[36:39], v[168:171], v[60:63]
  s_waitcnt lgkmcnt(2)
  v_mfma_f32_16x16x32_bf16 v[48:51], v[32:35], v[208:211], v[48:51]
  v_mfma_f32_16x16x32_bf16 v[56:59], v[208:211], v[208:211], v[56:59]
  v_cvt_pk_bf16_f32 v164, v20, v21
  v_cvt_pk_bf16_f32 v165, v22, v23
  v_cvt_pk_bf16_f32 v166, v24, v25
  v_cvt_pk_bf16_f32 v167, v26, v27
  s_add_u32 m0, s40, 16384
  s_nop 0
  buffer_load_dwordx4 v8, s[8:11], s41 offen offset:2048 lds
  ds_read_b128 v[220:223], v43 offset:34816
  v_mfma_f32_16x16x32_bf16 v[76:79], v[38:41], v[172:175], v[60:63]
  v_mfma_f32_16x16x32_bf16 v[80:83], v[36:39], v[172:175], v[60:63]
  s_waitcnt lgkmcnt(2)
  v_mfma_f32_16x16x32_bf16 v[48:51], v[32:35], v[212:215], v[48:51]
  v_mfma_f32_16x16x32_bf16 v[56:59], v[212:215], v[212:215], v[56:59]
  v_cvt_pk_bf16_f32 v168, v68, v69
  v_cvt_pk_bf16_f32 v169, v70, v71
  v_cvt_pk_bf16_f32 v170, v72, v73
  v_cvt_pk_bf16_f32 v171, v74, v75
  s_add_u32 m0, s40, 16384
  s_nop 0
  buffer_load_dwordx4 v9, s[8:11], s41 offen offset:3072 lds
  s_waitcnt vmcnt(14)
  ds_read_b128 v[224:227], v88 offset:0
  s_waitcnt lgkmcnt(2)
  v_mfma_f32_16x16x32_bf16 v[48:51], v[32:35], v[216:219], v[48:51]
  v_mfma_f32_16x16x32_bf16 v[56:59], v[216:219], v[216:219], v[56:59]
  v_cvt_pk_bf16_f32 v172, v76, v77
  v_cvt_pk_bf16_f32 v173, v78, v79
  v_cvt_pk_bf16_f32 v174, v80, v81
  v_cvt_pk_bf16_f32 v175, v82, v83
  s_add_u32 s41, s33, s36
  s_add_u32 m0, s40, 32768
  s_nop 0
  buffer_load_dwordx4 v6, s[8:11], s41 offen offset:0 lds
  ds_read_b128 v[228:231], v89 offset:0
  s_waitcnt lgkmcnt(2)
  v_mfma_f32_16x16x32_bf16 v[48:51], v[32:35], v[220:223], v[48:51]
  v_mfma_f32_16x16x32_bf16 v[56:59], v[220:223], v[220:223], v[56:59]
  s_add_u32 m0, s40, 32768
  s_nop 0
  buffer_load_dwordx4 v7, s[8:11], s41 offen offset:1024 lds
  s_waitcnt vmcnt(14)
  ds_read_b128 v[232:235], v88 offset:2048
  s_waitcnt lgkmcnt(2)
  v_mfma_f32_16x16x32_bf16 v[48:51], v[32:35], v[224:227], v[48:51]
  v_mfma_f32_16x16x32_bf16 v[56:59], v[224:227], v[224:227], v[56:59]
  s_add_u32 m0, s40, 32768
  s_nop 0
  buffer_load_dwordx4 v8, s[8:11], s41 offen offset:2048 lds
  ds_read_b128 v[236:239], v89 offset:2048
  s_waitcnt lgkmcnt(2)
  v_mfma_f32_16x16x32_bf16 v[48:51], v[32:35], v[228:231], v[48:51]
  v_mfma_f32_16x16x32_bf16 v[56:59], v[228:231], v[228:231], v[56:59]
  s_add_u32 m0, s40, 32768
  s_nop 0
  buffer_load_dwordx4 v9, s[8:11], s41 offen offset:3072 lds
  s_waitcnt vmcnt(14)
  ds_read_b128 v[240:243], v88 offset:16384
  s_waitcnt lgkmcnt(2)
  v_mfma_f32_16x16x32_bf16 v[48:51], v[32:35], v[232:235], v[48:51]
  v_mfma_f32_16x16x32_bf16 v[56:59], v[232:235], v[232:235], v[56:59]
  s_add_u32 s41, s34, s36
  s_add_u32 m0, s40, 49152
  s_nop 0
  buffer_load_dwordx4 v6, s[8:11], s41 offen offset:0 lds
  ds_read_b128 v[244:247], v89 offset:16384
  s_waitcnt lgkmcnt(2)
  v_mfma_f32_16x16x32_bf16 v[48:51], v[32:35], v[236:239], v[48:51]
  v_mfma_f32_16x16x32_bf16 v[56:59], v[236:239], v[236:239], v[56:59]
  s_add_u32 m0, s40, 49152
  s_nop 0
  buffer_load_dwordx4 v7, s[8:11], s41 offen offset:1024 lds
  s_waitcnt vmcnt(14)
  ds_read_b128 v[248:251], v88 offset:18432
  s_waitcnt lgkmcnt(2)
  v_mfma_f32_16x16x32_bf16 v[48:51], v[32:35], v[240:243], v[48:51]
  v_mfma_f32_16x16x32_bf16 v[56:59], v[240:243], v[240:243], v[56:59]
  s_add_u32 m0, s40, 49152
  s_nop 0
  buffer_load_dwordx4 v8, s[8:11], s41 offen offset:2048 lds
  ds_read_b128 v[252:255], v89 offset:18432
  s_waitcnt lgkmcnt(2)
  v_mfma_f32_16x16x32_bf16 v[48:51], v[32:35], v[244:247], v[48:51]
  v_mfma_f32_16x16x32_bf16 v[56:59], v[244:247], v[244:247], v[56:59]
  s_add_u32 m0, s40, 49152
  s_nop 0
  buffer_load_dwordx4 v9, s[8:11], s41 offen offset:3072 lds
  s_waitcnt lgkmcnt(1)
  v_mfma_f32_16x16x32_bf16 v[48:51], v[32:35], v[248:251], v[48:51]
  v_mfma_f32_16x16x32_bf16 v[56:59], v[248:251], v[248:251], v[56:59]
  s_add_u32 s41, s35, s36
  s_add_u32 m0, s40, 65536
  s_nop 0
  buffer_load_dwordx4 v6, s[8:11], s41 offen offset:0 lds
  s_waitcnt lgkmcnt(0)
  v_mfma_f32_16x16x32_bf16 v[48:51], v[32:35], v[252:255], v[48:51]
  v_mfma_f32_16x16x32_bf16 v[56:59], v[252:255], v[252:255], v[56:59]
  s_add_u32 m0, s40, 65536
  s_nop 0
  buffer_load_dwordx4 v7, s[8:11], s41 offen offset:1024 lds
  s_nop 3
  v_mul_f32 v64, 0xbacccccd, v48
  v_mul_f32 v65, 0xbacccccd, v49
  v_mul_f32 v66, 0xbacccccd, v50
  v_mul_f32 v67, 0xbacccccd, v51
  s_nop 1
  v_mfma_f32_16x16x32_bf16 v[68:71], v[38:41], v[176:179], v[64:67]
  v_mfma_f32_16x16x32_bf16 v[72:75], v[36:39], v[176:179], v[64:67]
  s_add_u32 m0, s40, 65536
  s_nop 0
  buffer_load_dwordx4 v8, s[8:11], s41 offen offset:2048 lds
  v_mfma_f32_16x16x32_bf16 v[76:79], v[38:41], v[180:183], v[64:67]
  v_mfma_f32_16x16x32_bf16 v[80:83], v[36:39], v[180:183], v[64:67]
  s_nop 1
  v_cvt_pk_bf16_f32 v176, v68, v69
  v_cvt_pk_bf16_f32 v177, v70, v71
  v_cvt_pk_bf16_f32 v178, v72, v73
  v_cvt_pk_bf16_f32 v179, v74, v75
  v_permlane16_swap_b32 v96, v176
  v_permlane16_swap_b32 v97, v177
  v_permlane16_swap_b32 v98, v178
  v_permlane16_swap_b32 v99, v179
  v_mfma_f32_16x16x32_bf16 v[20:23], v[38:41], v[184:187], v[64:67]
  v_mfma_f32_16x16x32_bf16 v[24:27], v[36:39], v[184:187], v[64:67]
  s_add_u32 m0, s40, 65536
  s_nop 0
  buffer_load_dwordx4 v9, s[8:11], s41 offen offset:3072 lds
  v_cvt_pk_bf16_f32 v180, v76, v77
  v_cvt_pk_bf16_f32 v181, v78, v79
  v_cvt_pk_bf16_f32 v182, v80, v81
  v_cvt_pk_bf16_f32 v183, v82, v83
  v_and_b32 v44, 1, v1
  v_cmp_eq_u32 vcc, 1, v44
  s_nop 1
  v_cndmask_b32 v52, v52, v53, vcc
  v_permlane16_swap_b32 v100, v180
  v_permlane16_swap_b32 v101, v181
  v_permlane16_swap_b32 v102, v182
  v_permlane16_swap_b32 v103, v183
  v_mfma_f32_16x16x32_bf16 v[68:71], v[38:41], v[188:191], v[64:67]
  v_mfma_f32_16x16x32_bf16 v[72:75], v[36:39], v[188:191], v[64:67]
  v_cvt_pk_bf16_f32 v184, v20, v21
  v_cvt_pk_bf16_f32 v185, v22, v23
  v_cvt_pk_bf16_f32 v186, v24, v25
  v_cvt_pk_bf16_f32 v187, v26, v27
  v_cndmask_b32 v54, v54, v55, vcc
  v_and_b32 v44, 2, v1
  v_cmp_eq_u32 vcc, 2, v44
  v_permlane16_swap_b32 v104, v184
  v_permlane16_swap_b32 v105, v185
  v_permlane16_swap_b32 v106, v186
  v_permlane16_swap_b32 v107, v187
  v_mfma_f32_16x16x32_bf16 v[76:79], v[38:41], v[192:195], v[64:67]
  v_mfma_f32_16x16x32_bf16 v[80:83], v[36:39], v[192:195], v[64:67]
  s_add_u32 s41, s31, s37
  s_add_u32 m0, s40, 81920
  s_nop 0
  buffer_load_dwordx4 v6, s[8:11], s41 offen offset:0 lds
  v_cvt_pk_bf16_f32 v188, v68, v69
  v_cvt_pk_bf16_f32 v189, v70, v71
  v_cvt_pk_bf16_f32 v190, v72, v73
  v_cvt_pk_bf16_f32 v191, v74, v75
  v_cndmask_b32 v52, v52, v54, vcc
  v_and_b32 v44, 15, v1
  v_lshrrev_b32 v45, 2, v44
  v_permlane16_swap_b32 v108, v188
  v_permlane16_swap_b32 v109, v189
  v_permlane16_swap_b32 v110, v190
  v_permlane16_swap_b32 v111, v191
  v_mfma_f32_16x16x32_bf16 v[20:23], v[38:41], v[196:199], v[64:67]
  v_mfma_f32_16x16x32_bf16 v[24:27], v[36:39], v[196:199], v[64:67]
  v_cvt_pk_bf16_f32 v192, v76, v77
  v_cvt_pk_bf16_f32 v193, v78, v79
  v_cvt_pk_bf16_f32 v194, v80, v81
  v_cvt_pk_bf16_f32 v195, v82, v83
  v_lshl_add_u32 v44, v45, 4, v44
  v_lshlrev_b32 v44, 2, v44
  ds_bpermute_b32 v53, v44, v52
  v_permlane16_swap_b32 v112, v192
  v_permlane16_swap_b32 v113, v193
  v_permlane16_swap_b32 v114, v194
  v_permlane16_swap_b32 v115, v195
  v_mfma_f32_16x16x32_bf16 v[68:71], v[38:41], v[200:203], v[64:67]
  v_mfma_f32_16x16x32_bf16 v[72:75], v[36:39], v[200:203], v[64:67]
  s_add_u32 m0, s40, 81920
  s_nop 0
  buffer_load_dwordx4 v7, s[8:11], s41 offen offset:1024 lds
  v_cvt_pk_bf16_f32 v196, v20, v21
  v_cvt_pk_bf16_f32 v197, v22, v23
  v_cvt_pk_bf16_f32 v198, v24, v25
  v_cvt_pk_bf16_f32 v199, v26, v27
  v_mul_f32 v45, v60, v60
  v_and_b32 v48, 1, v1
  v_cmp_eq_u32 vcc, 1, v48
  v_permlane16_swap_b32 v116, v196
  v_permlane16_swap_b32 v117, v197
  v_permlane16_swap_b32 v118, v198
  v_permlane16_swap_b32 v119, v199
  v_mfma_f32_16x16x32_bf16 v[76:79], v[38:41], v[204:207], v[64:67]
  v_mfma_f32_16x16x32_bf16 v[80:83], v[36:39], v[204:207], v[64:67]
  v_cvt_pk_bf16_f32 v200, v68, v69
  v_cvt_pk_bf16_f32 v201, v70, v71
  v_cvt_pk_bf16_f32 v202, v72, v73
  v_cvt_pk_bf16_f32 v203, v74, v75
  v_cndmask_b32 v56, v56, v57, vcc
  v_cndmask_b32 v58, v58, v59, vcc
  v_and_b32 v48, 2, v1
  v_permlane16_swap_b32 v120, v200
  v_permlane16_swap_b32 v121, v201
  v_permlane16_swap_b32 v122, v202
  v_permlane16_swap_b32 v123, v203
  v_mfma_f32_16x16x32_bf16 v[20:23], v[38:41], v[208:211], v[64:67]
  v_mfma_f32_16x16x32_bf16 v[24:27], v[36:39], v[208:211], v[64:67]
  s_add_u32 m0, s40, 81920
  s_nop 0
  buffer_load_dwordx4 v8, s[8:11], s41 offen offset:2048 lds
  v_cvt_pk_bf16_f32 v204, v76, v77
  v_cvt_pk_bf16_f32 v205, v78, v79
  v_cvt_pk_bf16_f32 v206, v80, v81
  v_cvt_pk_bf16_f32 v207, v82, v83
  v_cmp_eq_u32 vcc, 2, v48
  s_nop 1
  v_cndmask_b32 v56, v56, v58, vcc
  v_and_b32 v48, 15, v1
  v_permlane16_swap_b32 v124, v204
  v_permlane16_swap_b32 v125, v205
  v_permlane16_swap_b32 v126, v206
  v_permlane16_swap_b32 v127, v207
  v_mfma_f32_16x16x32_bf16 v[68:71], v[38:41], v[212:215], v[64:67]
  v_mfma_f32_16x16x32_bf16 v[72:75], v[36:39], v[212:215], v[64:67]
  v_cvt_pk_bf16_f32 v208, v20, v21
  v_cvt_pk_bf16_f32 v209, v22, v23
  v_cvt_pk_bf16_f32 v210, v24, v25
  v_cvt_pk_bf16_f32 v211, v26, v27
  v_lshrrev_b32 v49, 2, v48
  v_lshl_add_u32 v48, v49, 4, v48
  v_lshlrev_b32 v48, 2, v48
  v_permlane16_swap_b32 v128, v208
  v_permlane16_swap_b32 v129, v209
  v_permlane16_swap_b32 v130, v210
  v_permlane16_swap_b32 v131, v211
  v_mfma_f32_16x16x32_bf16 v[76:79], v[38:41], v[216:219], v[64:67]
  v_mfma_f32_16x16x32_bf16 v[80:83], v[36:39], v[216:219], v[64:67]
  s_add_u32 m0, s40, 81920
  s_nop 0
  buffer_load_dwordx4 v9, s[8:11], s41 offen offset:3072 lds
  v_cvt_pk_bf16_f32 v212, v68, v69
  v_cvt_pk_bf16_f32 v213, v70, v71
  v_cvt_pk_bf16_f32 v214, v72, v73
  v_cvt_pk_bf16_f32 v215, v74, v75
  ds_bpermute_b32 v57, v48, v56
  v_mul_f32 v49, v64, v64
  s_waitcnt lgkmcnt(1)
  v_mul_f32 v53, 0x3acccccd, v53
  v_permlane16_swap_b32 v132, v212
  v_permlane16_swap_b32 v133, v213
  v_permlane16_swap_b32 v134, v214
  v_permlane16_swap_b32 v135, v215
  v_mfma_f32_16x16x32_bf16 v[20:23], v[38:41], v[220:223], v[64:67]
  v_mfma_f32_16x16x32_bf16 v[24:27], v[36:39], v[220:223], v[64:67]
  s_lshl_b32 s73, s20, 12
  s_add_u32 m0, s73, 115712
  s_mov_b32 s79, s77
  buffer_load_dwordx4 v90, s[16:19], s79 offen lds
  v_cvt_pk_bf16_f32 v216, v76, v77
  v_cvt_pk_bf16_f32 v217, v78, v79
  v_cvt_pk_bf16_f32 v218, v80, v81
  v_cvt_pk_bf16_f32 v219, v82, v83
  v_sub_f32 v53, v53, v45
  v_max_f32 v53, 0, v53
  v_add_f32 v44, 0x3727c5ac, v53
  v_permlane16_swap_b32 v136, v216
  v_permlane16_swap_b32 v137, v217
  v_permlane16_swap_b32 v138, v218
  v_permlane16_swap_b32 v139, v219
  v_mfma_f32_16x16x32_bf16 v[68:71], v[38:41], v[224:227], v[64:67]
  v_mfma_f32_16x16x32_bf16 v[72:75], v[36:39], v[224:227], v[64:67]
  v_cvt_pk_bf16_f32 v220, v20, v21
  v_cvt_pk_bf16_f32 v221, v22, v23
  v_cvt_pk_bf16_f32 v222, v24, v25
  v_cvt_pk_bf16_f32 v223, v26, v27
  v_rsq_f32 v16, v44
  s_nop 0
  v_mul_f32 v44, v16, v16
  v_mul_f32 v44, v44, v53
  v_permlane16_swap_b32 v140, v220
  v_permlane16_swap_b32 v141, v221
  v_permlane16_swap_b32 v142, v222
  v_permlane16_swap_b32 v143, v223
  v_mfma_f32_16x16x32_bf16 v[76:79], v[38:41], v[228:231], v[64:67]
  v_mfma_f32_16x16x32_bf16 v[80:83], v[36:39], v[228:231], v[64:67]
  s_lshl_b32 s73, s20, 12
  s_add_u32 m0, s73, 116736
  s_add_u32 s79, s77, s78
  buffer_load_dwordx4 v90, s[16:19], s79 offen lds
  v_cvt_pk_bf16_f32 v224, v68, v69
  v_cvt_pk_bf16_f32 v225, v70, v71
  v_cvt_pk_bf16_f32 v226, v72, v73
  v_cvt_pk_bf16_f32 v227, v74, v75
  v_add_f32 v44, 0x3727c5ac, v44
  v_rsq_f32 v44, v44
  s_nop 0
  v_mul_f32 v16, v16, v44
  v_permlane16_swap_b32 v144, v224
  v_permlane16_swap_b32 v145, v225
  v_permlane16_swap_b32 v146, v226
  v_permlane16_swap_b32 v147, v227
  v_mfma_f32_16x16x32_bf16 v[20:23], v[38:41], v[232:235], v[64:67]
  v_mfma_f32_16x16x32_bf16 v[24:27], v[36:39], v[232:235], v[64:67]
  v_cvt_pk_bf16_f32 v228, v76, v77
  v_cvt_pk_bf16_f32 v229, v78, v79
  v_cvt_pk_bf16_f32 v230, v80, v81
  v_cvt_pk_bf16_f32 v231, v82, v83
  s_waitcnt lgkmcnt(0)
  v_mul_f32 v57, 0x3acccccd, v57
  v_sub_f32 v57, v57, v49
  v_max_f32 v57, 0, v57
  v_permlane16_swap_b32 v148, v228
  v_permlane16_swap_b32 v149, v229
  v_permlane16_swap_b32 v150, v230
  v_permlane16_swap_b32 v151, v231
  v_mfma_f32_16x16x32_bf16 v[68:71], v[38:41], v[236:239], v[64:67]
  v_mfma_f32_16x16x32_bf16 v[72:75], v[36:39], v[236:239], v[64:67]
  s_lshl_b32 s73, s20, 12
  s_add_u32 m0, s73, 117760
  s_add_u32 s79, s77, s76
  buffer_load_dwordx4 v90, s[16:19], s79 offen lds
  v_cvt_pk_bf16_f32 v232, v20, v21
  v_cvt_pk_bf16_f32 v233, v22, v23
  v_cvt_pk_bf16_f32 v234, v24, v25
  v_cvt_pk_bf16_f32 v235, v26, v27
  v_add_f32 v48, 0x3727c5ac, v57
  v_rsq_f32 v5, v48
  s_nop 0
  v_mul_f32 v48, v5, v5
  v_permlane16_swap_b32 v152, v232
  v_permlane16_swap_b32 v153, v233
  v_permlane16_swap_b32 v154, v234
  v_permlane16_swap_b32 v155, v235
  v_mfma_f32_16x16x32_bf16 v[76:79], v[38:41], v[240:243], v[64:67]
  v_mfma_f32_16x16x32_bf16 v[80:83], v[36:39], v[240:243], v[64:67]
  v_cvt_pk_bf16_f32 v236, v68, v69
  v_cvt_pk_bf16_f32 v237, v70, v71
  v_cvt_pk_bf16_f32 v238, v72, v73
  v_cvt_pk_bf16_f32 v239, v74, v75
  v_mul_f32 v48, v48, v57
  v_add_f32 v48, 0x3727c5ac, v48
  v_rsq_f32 v48, v48
  v_permlane16_swap_b32 v156, v236
  v_permlane16_swap_b32 v157, v237
  v_permlane16_swap_b32 v158, v238
  v_permlane16_swap_b32 v159, v239
  v_mfma_f32_16x16x32_bf16 v[20:23], v[38:41], v[244:247], v[64:67]
  v_mfma_f32_16x16x32_bf16 v[24:27], v[36:39], v[244:247], v[64:67]
  s_lshl_b32 s73, s20, 12
  s_add_u32 m0, s73, 118784
  s_add_u32 s79, s79, s78
  buffer_load_dwordx4 v90, s[16:19], s79 offen lds
  s_add_u32 s56, s70, 13631488
  s_addc_u32 s57, s71, 0
  s_and_b32 s57, s57, 0xffff
  s_mov_b32 s58, 37888
  s_mov_b32 s59, 0x20000
  v_cvt_pk_bf16_f32 v240, v76, v77
  v_cvt_pk_bf16_f32 v241, v78, v79
  v_cvt_pk_bf16_f32 v242, v80, v81
  v_cvt_pk_bf16_f32 v243, v82, v83
  v_mul_f32 v5, v5, v48
  v_permlane16_swap_b32 v160, v240
  v_permlane16_swap_b32 v161, v241
  v_permlane16_swap_b32 v162, v242
  v_permlane16_swap_b32 v163, v243
  v_mfma_f32_16x16x32_bf16 v[68:71], v[38:41], v[248:251], v[64:67]
  v_mfma_f32_16x16x32_bf16 v[72:75], v[36:39], v[248:251], v[64:67]
  v_cvt_pk_bf16_f32 v244, v20, v21
  v_cvt_pk_bf16_f32 v245, v22, v23
  v_cvt_pk_bf16_f32 v246, v24, v25
  v_cvt_pk_bf16_f32 v247, v26, v27
  v_permlane16_swap_b32 v164, v244
  v_permlane16_swap_b32 v165, v245
  v_permlane16_swap_b32 v166, v246
  v_permlane16_swap_b32 v167, v247
  v_mfma_f32_16x16x32_bf16 v[76:79], v[38:41], v[252:255], v[64:67]
  v_mfma_f32_16x16x32_bf16 v[80:83], v[36:39], v[252:255], v[64:67]
  v_cvt_pk_bf16_f32 v248, v68, v69
  v_cvt_pk_bf16_f32 v249, v70, v71
  v_cvt_pk_bf16_f32 v250, v72, v73
  v_cvt_pk_bf16_f32 v251, v74, v75
  v_permlane16_swap_b32 v168, v248
  v_permlane16_swap_b32 v169, v249
  v_permlane16_swap_b32 v170, v250
  v_permlane16_swap_b32 v171, v251
  v_cvt_pk_bf16_f32 v252, v76, v77
  v_cvt_pk_bf16_f32 v253, v78, v79
  v_cvt_pk_bf16_f32 v254, v80, v81
  v_cvt_pk_bf16_f32 v255, v82, v83
  v_permlane16_swap_b32 v172, v252
  v_permlane16_swap_b32 v173, v253
  v_permlane16_swap_b32 v174, v254
  v_permlane16_swap_b32 v175, v255
  v_lshlrev_b32 v94, 16, v94
  v_lshlrev_b32 v2, 2, v0
  v_add_u32 v2, 114688, v2
  ds_write_b32 v2, v94
  v_and_b32 v2, 16, v1
  v_cmp_eq_u32 vcc, 0, v2
  s_nop 1
  v_cndmask_b32 v16, v5, v16, vcc
  s_waitcnt vmcnt(24)
  s_waitcnt lgkmcnt(0)
  s_barrier
  ds_read_b64_tr_b16 a[0:1], v11 offset:0
  ds_read_b64_tr_b16 a[2:3], v11 offset:512
  ds_read_b64_tr_b16 a[4:5], v12 offset:0
  ds_read_b64_tr_b16 a[6:7], v12 offset:512
  ds_read_b64_tr_b16 a[8:9], v11 offset:1024
  ds_read_b64_tr_b16 a[10:11], v11 offset:1536
  ds_read_b64_tr_b16 a[12:13], v12 offset:1024
  ds_read_b64_tr_b16 a[14:15], v12 offset:1536
  s_waitcnt lgkmcnt(6)
  v_mfma_f32_32x32x16_bf16 v[32:47], a[0:3], v[96:99], 0
  ds_read_b64_tr_b16 a[16:17], v11 offset:4096
  ds_read_b64_tr_b16 a[18:19], v11 offset:4608
  s_waitcnt lgkmcnt(6)
  v_mfma_f32_32x32x16_bf16 v[48:63], a[4:7], v[96:99], 0
  ds_read_b64_tr_b16 a[20:21], v12 offset:4096
  ds_read_b64_tr_b16 a[22:23], v12 offset:4608
  s_waitcnt lgkmcnt(6)
  v_mfma_f32_32x32x16_bf16 v[32:47], a[8:11], v[176:179], v[32:47]
  ds_read_b64_tr_b16 a[0:1], v11 offset:5120
  ds_read_b64_tr_b16 a[2:3], v11 offset:5632
  s_waitcnt lgkmcnt(6)
  v_mfma_f32_32x32x16_bf16 v[48:63], a[12:15], v[176:179], v[48:63]
  ds_read_b64_tr_b16 a[4:5], v12 offset:5120
  ds_read_b64_tr_b16 a[6:7], v12 offset:5632
  s_waitcnt lgkmcnt(4)
  v_mfma_f32_32x32x16_bf16 v[32:47], a[16:19], v[100:103], v[32:47]
  ds_read_b64_tr_b16 a[8:9], v11 offset:8192
  ds_read_b64_tr_b16 a[10:11], v11 offset:8704
  v_mfma_f32_32x32x16_bf16 v[48:63], a[20:23], v[100:103], v[48:63]
  ds_read_b64_tr_b16 a[12:13], v12 offset:8192
  ds_read_b64_tr_b16 a[14:15], v12 offset:8704
  s_waitcnt lgkmcnt(4)
  v_mfma_f32_32x32x16_bf16 v[32:47], a[0:3], v[180:183], v[32:47]
  ds_read_b64_tr_b16 a[16:17], v11 offset:9216
  ds_read_b64_tr_b16 a[18:19], v11 offset:9728
  v_mfma_f32_32x32x16_bf16 v[48:63], a[4:7], v[180:183], v[48:63]
  ds_read_b64_tr_b16 a[20:21], v12 offset:9216
  ds_read_b64_tr_b16 a[22:23], v12 offset:9728
  s_waitcnt vmcnt(20)
  s_barrier
  s_waitcnt lgkmcnt(4)
  v_mfma_f32_32x32x16_bf16 v[32:47], a[8:11], v[104:107], v[32:47]
  ds_read_b64_tr_b16 a[0:1], v11 offset:12288
  ds_read_b64_tr_b16 a[2:3], v11 offset:12800
  v_mfma_f32_32x32x16_bf16 v[48:63], a[12:15], v[104:107], v[48:63]
  s_add_u32 s41, s32, s37
  s_add_u32 m0, s40, 98304
  s_nop 0
  buffer_load_dwordx4 v6, s[8:11], s41 offen offset:0 lds
  ds_read_b64_tr_b16 a[4:5], v12 offset:12288
  ds_read_b64_tr_b16 a[6:7], v12 offset:12800
  s_waitcnt lgkmcnt(4)
  v_mfma_f32_32x32x16_bf16 v[32:47], a[16:19], v[184:187], v[32:47]
  ds_read_b64_tr_b16 a[8:9], v11 offset:13312
  ds_read_b64_tr_b16 a[10:11], v11 offset:13824
  v_mfma_f32_32x32x16_bf16 v[48:63], a[20:23], v[184:187], v[48:63]
  ds_read_b64_tr_b16 a[12:13], v12 offset:13312
  ds_read_b64_tr_b16 a[14:15], v12 offset:13824
  s_waitcnt lgkmcnt(4)
  v_mfma_f32_32x32x16_bf16 v[32:47], a[0:3], v[108:111], v[32:47]
  s_add_u32 m0, s40, 98304
  s_nop 0
  buffer_load_dwordx4 v7, s[8:11], s41 offen offset:1024 lds
  ds_read_b64_tr_b16 a[16:17], v11 offset:16384
  ds_read_b64_tr_b16 a[18:19], v11 offset:16896
  v_mfma_f32_32x32x16_bf16 v[48:63], a[4:7], v[108:111], v[48:63]
  ds_read_b64_tr_b16 a[20:21], v12 offset:16384
  ds_read_b64_tr_b16 a[22:23], v12 offset:16896
  s_waitcnt lgkmcnt(4)
  v_mfma_f32_32x32x16_bf16 v[32:47], a[8:11], v[188:191], v[32:47]
  ds_read_b64_tr_b16 a[0:1], v11 offset:17408
  ds_read_b64_tr_b16 a[2:3], v11 offset:17920
  v_mfma_f32_32x32x16_bf16 v[48:63], a[12:15], v[188:191], v[48:63]
  s_add_u32 m0, s40, 98304
  s_nop 0
  buffer_load_dwordx4 v8, s[8:11], s41 offen offset:2048 lds
  ds_read_b64_tr_b16 a[4:5], v12 offset:17408
  ds_read_b64_tr_b16 a[6:7], v12 offset:17920
  s_waitcnt lgkmcnt(4)
  v_mfma_f32_32x32x16_bf16 v[32:47], a[16:19], v[112:115], v[32:47]
  ds_read_b64_tr_b16 a[8:9], v11 offset:20480
  ds_read_b64_tr_b16 a[10:11], v11 offset:20992
  v_mfma_f32_32x32x16_bf16 v[48:63], a[20:23], v[112:115], v[48:63]
  ds_read_b64_tr_b16 a[12:13], v12 offset:20480
  ds_read_b64_tr_b16 a[14:15], v12 offset:20992
  s_waitcnt lgkmcnt(4)
  v_mfma_f32_32x32x16_bf16 v[32:47], a[0:3], v[192:195], v[32:47]
  s_add_u32 m0, s40, 98304
  s_nop 0
  buffer_load_dwordx4 v9, s[8:11], s41 offen offset:3072 lds
  ds_read_b64_tr_b16 a[16:17], v11 offset:21504
  ds_read_b64_tr_b16 a[18:19], v11 offset:22016
  v_mfma_f32_32x32x16_bf16 v[48:63], a[4:7], v[192:195], v[48:63]
  ds_read_b64_tr_b16 a[20:21], v12 offset:21504
  ds_read_b64_tr_b16 a[22:23], v12 offset:22016
  s_waitcnt lgkmcnt(4)
  v_mfma_f32_32x32x16_bf16 v[32:47], a[8:11], v[116:119], v[32:47]
  ds_read_b64_tr_b16 a[0:1], v11 offset:24576
  ds_read_b64_tr_b16 a[2:3], v11 offset:25088
  v_mfma_f32_32x32x16_bf16 v[48:63], a[12:15], v[116:119], v[48:63]
  ds_read_b64_tr_b16 a[4:5], v12 offset:24576
  ds_read_b64_tr_b16 a[6:7], v12 offset:25088
  s_waitcnt lgkmcnt(4)
  v_mfma_f32_32x32x16_bf16 v[32:47], a[16:19], v[196:199], v[32:47]
  ds_read_b64_tr_b16 a[8:9], v11 offset:25600
  ds_read_b64_tr_b16 a[10:11], v11 offset:26112
  v_mfma_f32_32x32x16_bf16 v[48:63], a[20:23], v[196:199], v[48:63]
  ds_read_b64_tr_b16 a[12:13], v12 offset:25600
  ds_read_b64_tr_b16 a[14:15], v12 offset:26112
  s_waitcnt vmcnt(20)
  s_barrier
  s_waitcnt lgkmcnt(4)
  v_mfma_f32_32x32x16_bf16 v[32:47], a[0:3], v[120:123], v[32:47]
  s_add_u32 s41, s33, s37
  s_add_u32 m0, s40, 0
  s_nop 0
  buffer_load_dwordx4 v6, s[8:11], s41 offen offset:0 lds
  ds_read_b64_tr_b16 a[16:17], v11 offset:28672
  ds_read_b64_tr_b16 a[18:19], v11 offset:29184
  v_mfma_f32_32x32x16_bf16 v[48:63], a[4:7], v[120:123], v[48:63]
  ds_read_b64_tr_b16 a[20:21], v12 offset:28672
  ds_read_b64_tr_b16 a[22:23], v12 offset:29184
  s_waitcnt lgkmcnt(4)
  v_mfma_f32_32x32x16_bf16 v[32:47], a[8:11], v[200:203], v[32:47]
  ds_read_b64_tr_b16 a[0:1], v11 offset:29696
  ds_read_b64_tr_b16 a[2:3], v11 offset:30208
  v_mfma_f32_32x32x16_bf16 v[48:63], a[12:15], v[200:203], v[48:63]
  s_add_u32 m0, s40, 0
  s_nop 0
  buffer_load_dwordx4 v7, s[8:11], s41 offen offset:1024 lds
  ds_read_b64_tr_b16 a[4:5], v12 offset:29696
  ds_read_b64_tr_b16 a[6:7], v12 offset:30208
  s_waitcnt lgkmcnt(4)
  v_mfma_f32_32x32x16_bf16 v[32:47], a[16:19], v[124:127], v[32:47]
  ds_read_b64_tr_b16 a[8:9], v11 offset:32768
  ds_read_b64_tr_b16 a[10:11], v11 offset:33280
  v_mfma_f32_32x32x16_bf16 v[48:63], a[20:23], v[124:127], v[48:63]
  ds_read_b64_tr_b16 a[12:13], v12 offset:32768
  ds_read_b64_tr_b16 a[14:15], v12 offset:33280
  s_waitcnt lgkmcnt(4)
  v_mfma_f32_32x32x16_bf16 v[32:47], a[0:3], v[204:207], v[32:47]
  s_add_u32 m0, s40, 0
  s_nop 0
  buffer_load_dwordx4 v8, s[8:11], s41 offen offset:2048 lds
  ds_read_b64_tr_b16 a[16:17], v11 offset:33792
  ds_read_b64_tr_b16 a[18:19], v11 offset:34304
  v_mfma_f32_32x32x16_bf16 v[48:63], a[4:7], v[204:207], v[48:63]
  ds_read_b64_tr_b16 a[20:21], v12 offset:33792
  ds_read_b64_tr_b16 a[22:23], v12 offset:34304
  s_waitcnt lgkmcnt(4)
  v_mfma_f32_32x32x16_bf16 v[32:47], a[8:11], v[128:131], v[32:47]
  ds_read_b64_tr_b16 a[0:1], v11 offset:36864
  ds_read_b64_tr_b16 a[2:3], v11 offset:37376
  v_mfma_f32_32x32x16_bf16 v[48:63], a[12:15], v[128:131], v[48:63]
  s_add_u32 m0, s40, 0
  s_nop 0
  buffer_load_dwordx4 v9, s[8:11], s41 offen offset:3072 lds
  ds_read_b64_tr_b16 a[4:5], v12 offset:36864
  ds_read_b64_tr_b16 a[6:7], v12 offset:37376
  s_waitcnt lgkmcnt(4)
  v_mfma_f32_32x32x16_bf16 v[32:47], a[16:19], v[208:211], v[32:47]
  ds_read_b64_tr_b16 a[8:9], v11 offset:37888
  ds_read_b64_tr_b16 a[10:11], v11 offset:38400
  v_mfma_f32_32x32x16_bf16 v[48:63], a[20:23], v[208:211], v[48:63]
  ds_read_b64_tr_b16 a[12:13], v12 offset:37888
  ds_read_b64_tr_b16 a[14:15], v12 offset:38400
  s_waitcnt lgkmcnt(4)
  v_mfma_f32_32x32x16_bf16 v[32:47], a[0:3], v[132:135], v[32:47]
  ds_read_b64_tr_b16 a[16:17], v11 offset:40960
  ds_read_b64_tr_b16 a[18:19], v11 offset:41472
  v_mfma_f32_32x32x16_bf16 v[48:63], a[4:7], v[132:135], v[48:63]
  ds_read_b64_tr_b16 a[20:21], v12 offset:40960
  ds_read_b64_tr_b16 a[22:23], v12 offset:41472
  s_waitcnt lgkmcnt(4)
  v_mfma_f32_32x32x16_bf16 v[32:47], a[8:11], v[212:215], v[32:47]
  ds_read_b64_tr_b16 a[0:1], v11 offset:41984
  ds_read_b64_tr_b16 a[2:3], v11 offset:42496
  v_mfma_f32_32x32x16_bf16 v[48:63], a[12:15], v[212:215], v[48:63]
  ds_read_b64_tr_b16 a[4:5], v12 offset:41984
  ds_read_b64_tr_b16 a[6:7], v12 offset:42496
  s_waitcnt vmcnt(20)
  s_barrier
  s_waitcnt lgkmcnt(4)
  v_mfma_f32_32x32x16_bf16 v[32:47], a[16:19], v[136:139], v[32:47]
  ds_read_b64_tr_b16 a[8:9], v11 offset:45056
  ds_read_b64_tr_b16 a[10:11], v11 offset:45568
  v_mfma_f32_32x32x16_bf16 v[48:63], a[20:23], v[136:139], v[48:63]
  ds_read_b64_tr_b16 a[12:13], v12 offset:45056
  ds_read_b64_tr_b16 a[14:15], v12 offset:45568
  s_waitcnt lgkmcnt(4)
  v_mfma_f32_32x32x16_bf16 v[32:47], a[0:3], v[216:219], v[32:47]
  s_add_u32 s41, s34, s37
  s_add_u32 m0, s40, 16384
  s_nop 0
  buffer_load_dwordx4 v6, s[8:11], s41 offen offset:0 lds
  ds_read_b64_tr_b16 a[16:17], v11 offset:46080
  ds_read_b64_tr_b16 a[18:19], v11 offset:46592
  v_mfma_f32_32x32x16_bf16 v[48:63], a[4:7], v[216:219], v[48:63]
  ds_read_b64_tr_b16 a[20:21], v12 offset:46080
  ds_read_b64_tr_b16 a[22:23], v12 offset:46592
  s_waitcnt lgkmcnt(4)
  v_mfma_f32_32x32x16_bf16 v[32:47], a[8:11], v[140:143], v[32:47]
  ds_read_b64_tr_b16 a[0:1], v11 offset:49152
  ds_read_b64_tr_b16 a[2:3], v11 offset:49664
  v_lshrrev_b32 v2, 4, v1
  v_lshlrev_b32 v2, 3, v2
  v_bfe_u32 v3, v1, 2, 2
  v_mfma_f32_32x32x16_bf16 v[48:63], a[12:15], v[140:143], v[48:63]
  s_add_u32 m0, s40, 16384
  s_nop 0
  buffer_load_dwordx4 v7, s[8:11], s41 offen offset:1024 lds
  ds_read_b64_tr_b16 a[4:5], v12 offset:49152
  ds_read_b64_tr_b16 a[6:7], v12 offset:49664
  v_add_u32 v2, v2, v3
  v_lshlrev_b32 v2, 7, v2
  v_and_b32 v3, 3, v1
  s_waitcnt lgkmcnt(4)
  v_mfma_f32_32x32x16_bf16 v[32:47], a[16:19], v[220:223], v[32:47]
  ds_read_b64_tr_b16 a[8:9], v11 offset:50176
  ds_read_b64_tr_b16 a[10:11], v11 offset:50688
  v_lshl_add_u32 v2, v3, 3, v2
  s_lshl_b32 s73, s20, 12
  s_add_u32 s73, s73, 115712
  v_mfma_f32_32x32x16_bf16 v[48:63], a[20:23], v[220:223], v[48:63]
  ds_read_b64_tr_b16 a[12:13], v12 offset:50176
  ds_read_b64_tr_b16 a[14:15], v12 offset:50688
  v_add_u32 v2, s73, v2
  v_lshlrev_b32 v3, 4, v1
  s_waitcnt vmcnt(10)
  s_waitcnt lgkmcnt(4)
  v_mfma_f32_32x32x16_bf16 v[32:47], a[0:3], v[144:147], v[32:47]
  s_add_u32 m0, s40, 16384
  s_nop 0
  buffer_load_dwordx4 v8, s[8:11], s41 offen offset:2048 lds
  ds_read_b64_tr_b16 a[16:17], v11 offset:53248
  ds_read_b64_tr_b16 a[18:19], v11 offset:53760
  ds_read_b64_tr_b16 a[36:37], v2 offset:0
  ds_read_b64_tr_b16 a[38:39], v2 offset:512
  ds_read_b64_tr_b16 a[40:41], v2 offset:32
  v_mfma_f32_32x32x16_bf16 v[48:63], a[4:7], v[144:147], v[48:63]
  ds_read_b64_tr_b16 a[20:21], v12 offset:53248
  ds_read_b64_tr_b16 a[22:23], v12 offset:53760
  ds_read_b64_tr_b16 a[42:43], v2 offset:544
  ds_read_b64_tr_b16 a[44:45], v2 offset:64
  ds_read_b64_tr_b16 a[46:47], v2 offset:576
  s_waitcnt lgkmcnt(10)
  v_mfma_f32_32x32x16_bf16 v[32:47], a[8:11], v[224:227], v[32:47]
  ds_read_b64_tr_b16 a[0:1], v11 offset:54272
  ds_read_b64_tr_b16 a[2:3], v11 offset:54784
  ds_read_b64_tr_b16 a[48:49], v2 offset:96
  ds_read_b64_tr_b16 a[50:51], v2 offset:608
  s_add_u32 s16, s70, 10485760
  s_addc_u32 s17, s71, 0
  v_mfma_f32_32x32x16_bf16 v[48:63], a[12:15], v[224:227], v[48:63]
  s_add_u32 m0, s40, 16384
  s_nop 0
  buffer_load_dwordx4 v9, s[8:11], s41 offen offset:3072 lds
  ds_read_b64_tr_b16 a[4:5], v12 offset:54272
  ds_read_b64_tr_b16 a[6:7], v12 offset:54784
  s_and_b32 s17, s17, 0xffff
  s_cmp_lt_u32 s2, 192
  s_cselect_b32 s18, 3031040, 0
  s_lshl_b32 s73, s97, 2
  s_waitcnt lgkmcnt(9)
  v_mfma_f32_32x32x16_bf16 v[32:47], a[16:19], v[148:151], v[32:47]
  ds_read_b64_tr_b16 a[8:9], v11 offset:57344
  ds_read_b64_tr_b16 a[10:11], v11 offset:57856
  s_add_u32 s73, s73, 0
  s_mul_i32 s74, s73, 52
  s_lshr_b32 s74, s74, 8
  v_mfma_f32_32x32x16_bf16 v[48:63], a[20:23], v[148:151], v[48:63]
  ds_read_b64_tr_b16 a[12:13], v12 offset:57344
  ds_read_b64_tr_b16 a[14:15], v12 offset:57856
  s_mul_i32 s75, s74, 5
  s_sub_u32 s75, s73, s75
  s_mul_i32 s74, s74, 74
  s_waitcnt lgkmcnt(4)
  v_mfma_f32_32x32x16_bf16 v[32:47], a[0:3], v[228:231], v[32:47]
  ds_read_b64_tr_b16 a[16:17], v11 offset:58368
  ds_read_b64_tr_b16 a[18:19], v11 offset:58880
  s_add_u32 s74, s74, s96
  s_mul_i32 s74, s74, 5
  s_add_u32 s74, s74, s75
  v_mfma_f32_32x32x16_bf16 v[48:63], a[4:7], v[228:231], v[48:63]
  ds_read_b64_tr_b16 a[20:21], v12 offset:58368
  ds_read_b64_tr_b16 a[22:23], v12 offset:58880
  s_lshl_b32 s74, s74, 10
  buffer_store_dwordx4 a[36:39], v3, s[16:19], s74 offen sc1
  s_lshl_b32 s73, s97, 2
  s_barrier
  s_waitcnt lgkmcnt(4)
  v_mfma_f32_32x32x16_bf16 v[32:47], a[8:11], v[152:155], v[32:47]
  ds_read_b64_tr_b16 a[0:1], v11 offset:61440
  ds_read_b64_tr_b16 a[2:3], v11 offset:61952
  s_add_u32 s73, s73, 1
  s_mul_i32 s74, s73, 52
  s_lshr_b32 s74, s74, 8
  v_mfma_f32_32x32x16_bf16 v[48:63], a[12:15], v[152:155], v[48:63]
  s_add_u32 s41, s35, s37
  s_add_u32 m0, s40, 32768
  s_nop 0
  buffer_load_dwordx4 v6, s[8:11], s41 offen offset:0 lds
  ds_read_b64_tr_b16 a[4:5], v12 offset:61440
  ds_read_b64_tr_b16 a[6:7], v12 offset:61952
  s_mul_i32 s75, s74, 5
  s_sub_u32 s75, s73, s75
  s_mul_i32 s74, s74, 74
  s_waitcnt lgkmcnt(4)
  v_mfma_f32_32x32x16_bf16 v[32:47], a[16:19], v[232:235], v[32:47]
  ds_read_b64_tr_b16 a[8:9], v11 offset:62464
  ds_read_b64_tr_b16 a[10:11], v11 offset:62976
  s_add_u32 s74, s74, s96
  s_mul_i32 s74, s74, 5
  s_add_u32 s74, s74, s75
  v_mfma_f32_32x32x16_bf16 v[48:63], a[20:23], v[232:235], v[48:63]
  ds_read_b64_tr_b16 a[12:13], v12 offset:62464
  ds_read_b64_tr_b16 a[14:15], v12 offset:62976
  s_lshl_b32 s74, s74, 10
  buffer_store_dwordx4 a[40:43], v3, s[16:19], s74 offen sc1
  s_lshl_b32 s73, s97, 2
  s_waitcnt lgkmcnt(4)
  v_mfma_f32_32x32x16_bf16 v[32:47], a[0:3], v[156:159], v[32:47]
  s_add_u32 m0, s40, 32768
  s_nop 0
  buffer_load_dwordx4 v7, s[8:11], s41 offen offset:1024 lds
  ds_read_b64_tr_b16 a[16:17], v13 offset:0
  ds_read_b64_tr_b16 a[18:19], v13 offset:512
  s_add_u32 s73, s73, 2
  s_mul_i32 s74, s73, 52
  s_lshr_b32 s74, s74, 8
  v_mfma_f32_32x32x16_bf16 v[48:63], a[4:7], v[156:159], v[48:63]
  ds_read_b64_tr_b16 a[20:21], v14 offset:0
  ds_read_b64_tr_b16 a[22:23], v14 offset:512
  s_mul_i32 s75, s74, 5
  s_sub_u32 s75, s73, s75
  s_mul_i32 s74, s74, 74
  s_waitcnt lgkmcnt(4)
  v_mfma_f32_32x32x16_bf16 v[32:47], a[8:11], v[236:239], v[32:47]
  ds_read_b64_tr_b16 a[0:1], v13 offset:1024
  ds_read_b64_tr_b16 a[2:3], v13 offset:1536
  s_add_u32 s74, s74, s96
  s_mul_i32 s74, s74, 5
  s_add_u32 s74, s74, s75
  v_mfma_f32_32x32x16_bf16 v[48:63], a[12:15], v[236:239], v[48:63]
  s_add_u32 m0, s40, 32768
  s_nop 0
  buffer_load_dwordx4 v8, s[8:11], s41 offen offset:2048 lds
  ds_read_b64_tr_b16 a[4:5], v14 offset:1024
  ds_read_b64_tr_b16 a[6:7], v14 offset:1536
  s_lshl_b32 s74, s74, 10
  buffer_store_dwordx4 a[44:47], v3, s[16:19], s74 offen sc1
  s_lshl_b32 s73, s97, 2
  s_waitcnt lgkmcnt(4)
  v_mfma_f32_32x32x16_bf16 v[32:47], a[16:19], v[160:163], v[32:47]
  ds_read_b64_tr_b16 a[8:9], v13 offset:4096
  ds_read_b64_tr_b16 a[10:11], v13 offset:4608
  s_add_u32 s73, s73, 3
  s_mul_i32 s74, s73, 52
  s_lshr_b32 s74, s74, 8
  v_mfma_f32_32x32x16_bf16 v[48:63], a[20:23], v[160:163], v[48:63]
  ds_read_b64_tr_b16 a[12:13], v14 offset:4096
  ds_read_b64_tr_b16 a[14:15], v14 offset:4608
  s_mul_i32 s75, s74, 5
  s_sub_u32 s75, s73, s75
  s_mul_i32 s74, s74, 74
  s_waitcnt lgkmcnt(4)
  v_mfma_f32_32x32x16_bf16 v[32:47], a[0:3], v[240:243], v[32:47]
  s_add_u32 m0, s40, 32768
  s_nop 0
  buffer_load_dwordx4 v9, s[8:11], s41 offen offset:3072 lds
  ds_read_b64_tr_b16 a[16:17], v13 offset:5120
  ds_read_b64_tr_b16 a[18:19], v13 offset:5632
  s_add_u32 s74, s74, s96
  s_mul_i32 s74, s74, 5
  s_add_u32 s74, s74, s75
  v_mfma_f32_32x32x16_bf16 v[48:63], a[4:7], v[240:243], v[48:63]
  ds_read_b64_tr_b16 a[20:21], v14 offset:5120
  ds_read_b64_tr_b16 a[22:23], v14 offset:5632
  s_lshl_b32 s74, s74, 10
  buffer_store_dwordx4 a[48:51], v3, s[16:19], s74 offen sc1
  s_waitcnt lgkmcnt(4)
  v_mfma_f32_32x32x16_bf16 v[32:47], a[8:11], v[164:167], v[32:47]
  ds_read_b64_tr_b16 a[0:1], v13 offset:8192
  ds_read_b64_tr_b16 a[2:3], v13 offset:8704
  v_mfma_f32_32x32x16_bf16 v[48:63], a[12:15], v[164:167], v[48:63]
  ds_read_b64_tr_b16 a[4:5], v14 offset:8192
  ds_read_b64_tr_b16 a[6:7], v14 offset:8704
  s_waitcnt lgkmcnt(4)
  v_mfma_f32_32x32x16_bf16 v[32:47], a[16:19], v[244:247], v[32:47]
  ds_read_b64_tr_b16 a[8:9], v13 offset:9216
  ds_read_b64_tr_b16 a[10:11], v13 offset:9728
  v_mfma_f32_32x32x16_bf16 v[48:63], a[20:23], v[244:247], v[48:63]
  ds_read_b64_tr_b16 a[12:13], v14 offset:9216
  ds_read_b64_tr_b16 a[14:15], v14 offset:9728
  s_barrier
  s_waitcnt lgkmcnt(4)
  v_mfma_f32_32x32x16_bf16 v[32:47], a[0:3], v[168:171], v[32:47]
  s_add_u32 s41, s31, s38
  s_add_u32 m0, s40, 49152
  s_nop 0
  buffer_load_dwordx4 v6, s[8:11], s41 offen offset:0 lds
  ds_read_b64_tr_b16 a[16:17], v13 offset:12288
  ds_read_b64_tr_b16 a[18:19], v13 offset:12800
  v_mfma_f32_32x32x16_bf16 v[48:63], a[4:7], v[168:171], v[48:63]
  ds_read_b64_tr_b16 a[20:21], v14 offset:12288
  ds_read_b64_tr_b16 a[22:23], v14 offset:12800
  s_waitcnt lgkmcnt(4)
  v_mfma_f32_32x32x16_bf16 v[32:47], a[8:11], v[248:251], v[32:47]
  ds_read_b64_tr_b16 a[0:1], v13 offset:13312
  ds_read_b64_tr_b16 a[2:3], v13 offset:13824
  v_mfma_f32_32x32x16_bf16 v[48:63], a[12:15], v[248:251], v[48:63]
  s_add_u32 m0, s40, 49152
  s_nop 0
  buffer_load_dwordx4 v7, s[8:11], s41 offen offset:1024 lds
  ds_read_b64_tr_b16 a[4:5], v14 offset:13312
  ds_read_b64_tr_b16 a[6:7], v14 offset:13824
  s_waitcnt lgkmcnt(4)
  v_mfma_f32_32x32x16_bf16 v[32:47], a[16:19], v[172:175], v[32:47]
  ds_read_b64_tr_b16 a[8:9], v13 offset:16384
  ds_read_b64_tr_b16 a[10:11], v13 offset:16896
  v_mfma_f32_32x32x16_bf16 v[48:63], a[20:23], v[172:175], v[48:63]
  ds_read_b64_tr_b16 a[12:13], v14 offset:16384
  ds_read_b64_tr_b16 a[14:15], v14 offset:16896
  s_waitcnt lgkmcnt(4)
  v_mfma_f32_32x32x16_bf16 v[32:47], a[0:3], v[252:255], v[32:47]
  s_add_u32 m0, s40, 49152
  s_nop 0
  buffer_load_dwordx4 v8, s[8:11], s41 offen offset:2048 lds
  ds_read_b64_tr_b16 a[16:17], v13 offset:17408
  ds_read_b64_tr_b16 a[18:19], v13 offset:17920
  v_mfma_f32_32x32x16_bf16 v[48:63], a[4:7], v[252:255], v[48:63]
  ds_read_b64_tr_b16 a[20:21], v14 offset:17408
  ds_read_b64_tr_b16 a[22:23], v14 offset:17920
  s_waitcnt lgkmcnt(4)
  v_mfma_f32_32x32x16_bf16 v[64:79], a[8:11], v[96:99], 0
  ds_read_b64_tr_b16 a[0:1], v13 offset:20480
  ds_read_b64_tr_b16 a[2:3], v13 offset:20992
  v_mfma_f32_32x32x16_bf16 v[80:95], a[12:15], v[96:99], 0
  s_add_u32 m0, s40, 49152
  s_nop 0
  buffer_load_dwordx4 v9, s[8:11], s41 offen offset:3072 lds
  ds_read_b64_tr_b16 a[4:5], v14 offset:20480
  ds_read_b64_tr_b16 a[6:7], v14 offset:20992
  v_add_u32 v30, s48, v10
  ds_read_b128 v[18:21], v30 offset:0
  ds_read_b128 v[22:25], v30 offset:32
  s_waitcnt lgkmcnt(1)
  v_fmac_f32 v18, v32, v16
  v_fmac_f32 v19, v33, v16
  v_mfma_f32_32x32x16_bf16 v[64:79], a[16:19], v[176:179], v[64:79]
  ds_read_b64_tr_b16 a[8:9], v13 offset:21504
  ds_read_b64_tr_b16 a[10:11], v13 offset:22016
  v_fmac_f32 v20, v34, v16
  v_fmac_f32 v21, v35, v16
  v_mul_f32 v26, v18, v18
  v_mul_f32 v27, v19, v19
  v_mfma_f32_32x32x16_bf16 v[80:95], a[20:23], v[176:179], v[80:95]
  ds_read_b64_tr_b16 a[12:13], v14 offset:21504
  ds_read_b64_tr_b16 a[14:15], v14 offset:22016
  v_mul_f32 v28, v20, v20
  v_mul_f32 v29, v21, v21
  v_fmaak_f32 v26, v26, v17, 0xc0135761
  v_fmaak_f32 v27, v27, v17, 0xc0135761
  v_mfma_f32_32x32x16_bf16 v[64:79], a[0:3], v[100:103], v[64:79]
  ds_read_b64_tr_b16 a[16:17], v13 offset:24576
  ds_read_b64_tr_b16 a[18:19], v13 offset:25088
  v_fmaak_f32 v28, v28, v17, 0xc0135761
  v_fmaak_f32 v29, v29, v17, 0xc0135761
  v_mul_f32 v26, v18, v26
  v_mul_f32 v27, v19, v27
  v_mfma_f32_32x32x16_bf16 v[80:95], a[4:7], v[100:103], v[80:95]
  ds_read_b64_tr_b16 a[20:21], v14 offset:24576
  ds_read_b64_tr_b16 a[22:23], v14 offset:25088
  v_mul_f32 v28, v20, v28
  v_mul_f32 v29, v21, v29
  v_exp_f32 v26, v26
  s_waitcnt lgkmcnt(4)
  v_mfma_f32_32x32x16_bf16 v[64:79], a[8:11], v[180:183], v[64:79]
  ds_read_b64_tr_b16 a[0:1], v13 offset:25600
  ds_read_b64_tr_b16 a[2:3], v13 offset:26112
  v_exp_f32 v27, v27
  v_exp_f32 v28, v28
  v_mfma_f32_32x32x16_bf16 v[80:95], a[12:15], v[180:183], v[80:95]
  ds_read_b64_tr_b16 a[4:5], v14 offset:25600
  ds_read_b64_tr_b16 a[6:7], v14 offset:26112
  v_exp_f32 v29, v29
  v_add_f32 v26, 1.0, v26
  v_add_f32 v27, 1.0, v27
  v_add_f32 v28, 1.0, v28
  s_waitcnt vmcnt(4)
  s_barrier
  s_lshl_b32 s73, s2, 2
  s_add_u32 s73, s73, 36864
  s_cmp_lt_u32 s2, 192
  s_cselect_b32 s73, s73, 0x40000000
  v_accvgpr_read_b32 v3, a35
  v_mov_b32 v2, 0x40000000
  v_cmp_eq_u32 vcc, 0, v1
  v_readlane_b32 s72, v3, 25
  s_cmp_eq_u32 s20, 0
  s_cselect_b32 s73, s73, 0x40000000
  v_mov_b32 v3, s73
  v_cndmask_b32 v2, v2, v3, vcc
  s_add_u32 s72, s72, 1
  v_mov_b32 v3, s72
  buffer_store_dword v3, v2, s[56:59], 0 offen sc1
  s_waitcnt lgkmcnt(4)
  v_mfma_f32_32x32x16_bf16 v[64:79], a[16:19], v[104:107], v[64:79]
  ds_read_b64_tr_b16 a[8:9], v13 offset:28672
  ds_read_b64_tr_b16 a[10:11], v13 offset:29184
  v_add_f32 v29, 1.0, v29
  v_rcp_f32 v26, v26
  v_rcp_f32 v27, v27
  v_mfma_f32_32x32x16_bf16 v[80:95], a[20:23], v[104:107], v[80:95]
  ds_read_b64_tr_b16 a[12:13], v14 offset:28672
  ds_read_b64_tr_b16 a[14:15], v14 offset:29184
  v_rcp_f32 v28, v28
  v_rcp_f32 v29, v29
  s_waitcnt lgkmcnt(4)
  v_mfma_f32_32x32x16_bf16 v[64:79], a[0:3], v[184:187], v[64:79]
  s_add_u32 s41, s32, s38
  s_add_u32 m0, s40, 65536
  s_nop 0
  buffer_load_dwordx4 v6, s[8:11], s41 offen offset:0 lds
  ds_read_b64_tr_b16 a[16:17], v13 offset:29696
  ds_read_b64_tr_b16 a[18:19], v13 offset:30208
  v_mul_f32 v32, v18, v26
  v_mul_f32 v33, v19, v27
  v_mul_f32 v34, v20, v28
  v_mul_f32 v35, v21, v29
  ds_read_b128 v[18:21], v30 offset:64
  v_mfma_f32_32x32x16_bf16 v[80:95], a[4:7], v[184:187], v[80:95]
  ds_read_b64_tr_b16 a[20:21], v14 offset:29696
  ds_read_b64_tr_b16 a[22:23], v14 offset:30208
  v_cvt_pk_bf16_f32 v32, v32, v33
  v_cvt_pk_bf16_f32 v33, v34, v35
  v_fmac_f32 v22, v36, v16
  v_fmac_f32 v23, v37, v16
  s_waitcnt lgkmcnt(5)
  v_mfma_f32_32x32x16_bf16 v[64:79], a[8:11], v[108:111], v[64:79]
  ds_read_b64_tr_b16 a[0:1], v13 offset:32768
  ds_read_b64_tr_b16 a[2:3], v13 offset:33280
  v_fmac_f32 v24, v38, v16
  v_fmac_f32 v25, v39, v16
  v_mul_f32 v26, v22, v22
  v_mul_f32 v27, v23, v23
  v_mfma_f32_32x32x16_bf16 v[80:95], a[12:15], v[108:111], v[80:95]
  s_add_u32 m0, s40, 65536
  s_nop 0
  buffer_load_dwordx4 v7, s[8:11], s41 offen offset:1024 lds
  ds_read_b64_tr_b16 a[4:5], v14 offset:32768
  ds_read_b64_tr_b16 a[6:7], v14 offset:33280
  v_mul_f32 v28, v24, v24
  v_mul_f32 v29, v25, v25
  v_fmaak_f32 v26, v26, v17, 0xc0135761
  v_fmaak_f32 v27, v27, v17, 0xc0135761
  s_waitcnt lgkmcnt(4)
  v_mfma_f32_32x32x16_bf16 v[64:79], a[16:19], v[188:191], v[64:79]
  ds_read_b64_tr_b16 a[8:9], v13 offset:33792
  ds_read_b64_tr_b16 a[10:11], v13 offset:34304
  v_fmaak_f32 v28, v28, v17, 0xc0135761
  v_fmaak_f32 v29, v29, v17, 0xc0135761
  v_mul_f32 v26, v22, v26
  v_mul_f32 v27, v23, v27
  v_mfma_f32_32x32x16_bf16 v[80:95], a[20:23], v[188:191], v[80:95]
  ds_read_b64_tr_b16 a[12:13], v14 offset:33792
  ds_read_b64_tr_b16 a[14:15], v14 offset:34304
  v_mul_f32 v28, v24, v28
  v_mul_f32 v29, v25, v29
  v_exp_f32 v26, v26
  s_waitcnt lgkmcnt(4)
  v_mfma_f32_32x32x16_bf16 v[64:79], a[0:3], v[112:115], v[64:79]
  s_add_u32 m0, s40, 65536
  s_nop 0
  buffer_load_dwordx4 v8, s[8:11], s41 offen offset:2048 lds
  ds_read_b64_tr_b16 a[16:17], v13 offset:36864
  ds_read_b64_tr_b16 a[18:19], v13 offset:37376
  v_exp_f32 v27, v27
  v_exp_f32 v28, v28
  v_mfma_f32_32x32x16_bf16 v[80:95], a[4:7], v[112:115], v[80:95]
  ds_read_b64_tr_b16 a[20:21], v14 offset:36864
  ds_read_b64_tr_b16 a[22:23], v14 offset:37376
  v_exp_f32 v29, v29
  v_add_f32 v26, 1.0, v26
  v_add_f32 v27, 1.0, v27
  v_add_f32 v28, 1.0, v28
  s_waitcnt lgkmcnt(4)
  v_mfma_f32_32x32x16_bf16 v[64:79], a[8:11], v[192:195], v[64:79]
  ds_read_b64_tr_b16 a[0:1], v13 offset:37888
  ds_read_b64_tr_b16 a[2:3], v13 offset:38400
  v_add_f32 v29, 1.0, v29
  v_rcp_f32 v26, v26
  v_rcp_f32 v27, v27
  v_mfma_f32_32x32x16_bf16 v[80:95], a[12:15], v[192:195], v[80:95]
  s_add_u32 m0, s40, 65536
  s_nop 0
  buffer_load_dwordx4 v9, s[8:11], s41 offen offset:3072 lds
  ds_read_b64_tr_b16 a[4:5], v14 offset:37888
  ds_read_b64_tr_b16 a[6:7], v14 offset:38400
  v_rcp_f32 v28, v28
  v_rcp_f32 v29, v29
  s_waitcnt lgkmcnt(4)
  v_mfma_f32_32x32x16_bf16 v[64:79], a[16:19], v[116:119], v[64:79]
  ds_read_b64_tr_b16 a[8:9], v13 offset:40960
  ds_read_b64_tr_b16 a[10:11], v13 offset:41472
  v_mul_f32 v36, v22, v26
  v_mul_f32 v37, v23, v27
  v_mul_f32 v38, v24, v28
  v_mul_f32 v39, v25, v29
  ds_read_b128 v[22:25], v30 offset:96
  v_mfma_f32_32x32x16_bf16 v[80:95], a[20:23], v[116:119], v[80:95]
  ds_read_b64_tr_b16 a[12:13], v14 offset:40960
  ds_read_b64_tr_b16 a[14:15], v14 offset:41472
  v_cvt_pk_bf16_f32 v34, v36, v37
  v_cvt_pk_bf16_f32 v35, v38, v39
  buffer_store_dwordx4 v[32:35], v15, s[12:15], s44 offen offset:0 sc1
  v_fmac_f32 v18, v40, v16
  v_fmac_f32 v19, v41, v16
  s_waitcnt lgkmcnt(5)
  v_mfma_f32_32x32x16_bf16 v[64:79], a[0:3], v[196:199], v[64:79]
  ds_read_b64_tr_b16 a[16:17], v13 offset:41984
  ds_read_b64_tr_b16 a[18:19], v13 offset:42496
  v_fmac_f32 v20, v42, v16
  v_fmac_f32 v21, v43, v16
  v_mul_f32 v26, v18, v18
  v_mul_f32 v27, v19, v19
  v_mfma_f32_32x32x16_bf16 v[80:95], a[4:7], v[196:199], v[80:95]
  ds_read_b64_tr_b16 a[20:21], v14 offset:41984
  ds_read_b64_tr_b16 a[22:23], v14 offset:42496
  v_mul_f32 v28, v20, v20
  v_mul_f32 v29, v21, v21
  v_fmaak_f32 v26, v26, v17, 0xc0135761
  v_fmaak_f32 v27, v27, v17, 0xc0135761
  s_barrier
  s_waitcnt lgkmcnt(4)
  v_mfma_f32_32x32x16_bf16 v[64:79], a[8:11], v[120:123], v[64:79]
  ds_read_b64_tr_b16 a[0:1], v13 offset:45056
  ds_read_b64_tr_b16 a[2:3], v13 offset:45568
  v_fmaak_f32 v28, v28, v17, 0xc0135761
  v_fmaak_f32 v29, v29, v17, 0xc0135761
  v_mul_f32 v26, v18, v26
  v_mul_f32 v27, v19, v27
  v_mfma_f32_32x32x16_bf16 v[80:95], a[12:15], v[120:123], v[80:95]
  s_add_u32 s41, s33, s38
  s_add_u32 m0, s40, 81920
  s_nop 0
  buffer_load_dwordx4 v6, s[8:11], s41 offen offset:0 lds
  ds_read_b64_tr_b16 a[4:5], v14 offset:45056
  ds_read_b64_tr_b16 a[6:7], v14 offset:45568
  v_mul_f32 v28, v20, v28
  v_mul_f32 v29, v21, v29
  v_exp_f32 v26, v26
  s_waitcnt lgkmcnt(4)
  v_mfma_f32_32x32x16_bf16 v[64:79], a[16:19], v[200:203], v[64:79]
  ds_read_b64_tr_b16 a[8:9], v13 offset:46080
  ds_read_b64_tr_b16 a[10:11], v13 offset:46592
  v_exp_f32 v27, v27
  v_exp_f32 v28, v28
  v_mfma_f32_32x32x16_bf16 v[80:95], a[20:23], v[200:203], v[80:95]
  ds_read_b64_tr_b16 a[12:13], v14 offset:46080
  ds_read_b64_tr_b16 a[14:15], v14 offset:46592
  v_exp_f32 v29, v29
  v_add_f32 v26, 1.0, v26
  v_add_f32 v27, 1.0, v27
  v_add_f32 v28, 1.0, v28
  s_waitcnt lgkmcnt(4)
  v_mfma_f32_32x32x16_bf16 v[64:79], a[0:3], v[124:127], v[64:79]
  s_add_u32 m0, s40, 81920
  s_nop 0
  buffer_load_dwordx4 v7, s[8:11], s41 offen offset:1024 lds
  ds_read_b64_tr_b16 a[16:17], v11 offset:0
  ds_read_b64_tr_b16 a[18:19], v11 offset:512
  v_add_f32 v29, 1.0, v29
  v_rcp_f32 v26, v26
  v_mfma_f32_32x32x16_bf16 v[80:95], a[4:7], v[124:127], v[80:95]
  ds_read_b64_tr_b16 a[20:21], v12 offset:0
  ds_read_b64_tr_b16 a[22:23], v12 offset:512
  v_rcp_f32 v27, v27
  v_rcp_f32 v28, v28
  v_rcp_f32 v29, v29
  s_waitcnt lgkmcnt(4)
  v_mfma_f32_32x32x16_bf16 v[64:79], a[8:11], v[204:207], v[64:79]
  ds_read_b64_tr_b16 a[0:1], v11 offset:1024
  ds_read_b64_tr_b16 a[2:3], v11 offset:1536
  v_mul_f32 v40, v18, v26
  v_mul_f32 v41, v19, v27
  v_mul_f32 v42, v20, v28
  v_mul_f32 v43, v21, v29
  ds_read_b128 v[18:21], v30 offset:128
  v_mfma_f32_32x32x16_bf16 v[80:95], a[12:15], v[204:207], v[80:95]
  s_add_u32 m0, s40, 81920
  s_nop 0
  buffer_load_dwordx4 v8, s[8:11], s41 offen offset:2048 lds
  ds_read_b64_tr_b16 a[4:5], v12 offset:1024
  ds_read_b64_tr_b16 a[6:7], v12 offset:1536
  v_cvt_pk_bf16_f32 v40, v40, v41
  v_cvt_pk_bf16_f32 v41, v42, v43
  v_fmac_f32 v22, v44, v16
  v_fmac_f32 v23, v45, v16
  s_waitcnt lgkmcnt(5)
  v_mfma_f32_32x32x16_bf16 v[64:79], a[16:19], v[128:131], v[64:79]
  ds_read_b64_tr_b16 a[8:9], v11 offset:4096
  ds_read_b64_tr_b16 a[10:11], v11 offset:4608
  v_fmac_f32 v24, v46, v16
  v_fmac_f32 v25, v47, v16
  v_mul_f32 v26, v22, v22
  v_mul_f32 v27, v23, v23
  v_mfma_f32_32x32x16_bf16 v[80:95], a[20:23], v[128:131], v[80:95]
  ds_read_b64_tr_b16 a[12:13], v12 offset:4096
  ds_read_b64_tr_b16 a[14:15], v12 offset:4608
  v_mul_f32 v28, v24, v24
  v_mul_f32 v29, v25, v25
  v_fmaak_f32 v26, v26, v17, 0xc0135761
  v_fmaak_f32 v27, v27, v17, 0xc0135761
  s_waitcnt lgkmcnt(4)
  v_mfma_f32_32x32x16_bf16 v[64:79], a[0:3], v[208:211], v[64:79]
  s_add_u32 m0, s40, 81920
  s_nop 0
  buffer_load_dwordx4 v9, s[8:11], s41 offen offset:3072 lds
  ds_read_b64_tr_b16 a[16:17], v11 offset:5120
  ds_read_b64_tr_b16 a[18:19], v11 offset:5632
  v_fmaak_f32 v28, v28, v17, 0xc0135761
  v_fmaak_f32 v29, v29, v17, 0xc0135761
  v_mul_f32 v26, v22, v26
  v_mul_f32 v27, v23, v27
  v_mfma_f32_32x32x16_bf16 v[80:95], a[4:7], v[208:211], v[80:95]
  ds_read_b64_tr_b16 a[20:21], v12 offset:5120
  ds_read_b64_tr_b16 a[22:23], v12 offset:5632
  v_mul_f32 v28, v24, v28
  v_mul_f32 v29, v25, v29
  v_exp_f32 v26, v26
  s_waitcnt lgkmcnt(4)
  v_mfma_f32_32x32x16_bf16 v[64:79], a[8:11], v[132:135], v[64:79]
  ds_read_b64_tr_b16 a[0:1], v11 offset:8192
  ds_read_b64_tr_b16 a[2:3], v11 offset:8704
  v_exp_f32 v27, v27
  v_exp_f32 v28, v28
  v_mfma_f32_32x32x16_bf16 v[80:95], a[12:15], v[132:135], v[80:95]
  ds_read_b64_tr_b16 a[4:5], v12 offset:8192
  ds_read_b64_tr_b16 a[6:7], v12 offset:8704
  v_exp_f32 v29, v29
  v_add_f32 v26, 1.0, v26
  v_add_f32 v27, 1.0, v27
  v_add_f32 v28, 1.0, v28
  s_waitcnt lgkmcnt(4)
  v_mfma_f32_32x32x16_bf16 v[64:79], a[16:19], v[212:215], v[64:79]
  ds_read_b64_tr_b16 a[8:9], v11 offset:9216
  ds_read_b64_tr_b16 a[10:11], v11 offset:9728
  v_add_f32 v29, 1.0, v29
  v_rcp_f32 v26, v26
  v_mfma_f32_32x32x16_bf16 v[80:95], a[20:23], v[212:215], v[80:95]
  ds_read_b64_tr_b16 a[12:13], v12 offset:9216
  ds_read_b64_tr_b16 a[14:15], v12 offset:9728
  v_rcp_f32 v27, v27
  v_rcp_f32 v28, v28
  v_rcp_f32 v29, v29
  s_barrier
  s_waitcnt lgkmcnt(4)
  v_mfma_f32_32x32x16_bf16 v[64:79], a[0:3], v[136:139], v[64:79]
  s_add_u32 s41, s34, s38
  s_add_u32 m0, s40, 98304
  s_nop 0
  buffer_load_dwordx4 v6, s[8:11], s41 offen offset:0 lds
  ds_read_b64_tr_b16 a[16:17], v11 offset:12288
  ds_read_b64_tr_b16 a[18:19], v11 offset:12800
  v_mul_f32 v44, v22, v26
  v_mul_f32 v45, v23, v27
  v_mul_f32 v46, v24, v28
  v_mul_f32 v47, v25, v29
  ds_read_b128 v[22:25], v30 offset:160
  v_mfma_f32_32x32x16_bf16 v[80:95], a[4:7], v[136:139], v[80:95]
  ds_read_b64_tr_b16 a[20:21], v12 offset:12288
  ds_read_b64_tr_b16 a[22:23], v12 offset:12800
  v_cvt_pk_bf16_f32 v42, v44, v45
  v_cvt_pk_bf16_f32 v43, v46, v47
  buffer_store_dwordx4 v[40:43], v15, s[12:15], s44 offen offset:512 sc1
  v_fmac_f32 v18, v48, v16
  s_waitcnt lgkmcnt(5)
  v_mfma_f32_32x32x16_bf16 v[64:79], a[8:11], v[216:219], v[64:79]
  ds_read_b64_tr_b16 a[0:1], v11 offset:13312
  ds_read_b64_tr_b16 a[2:3], v11 offset:13824
  v_fmac_f32 v19, v49, v16
  v_fmac_f32 v20, v50, v16
  v_fmac_f32 v21, v51, v16
  v_mul_f32 v26, v18, v18
  v_mfma_f32_32x32x16_bf16 v[80:95], a[12:15], v[216:219], v[80:95]
  s_add_u32 m0, s40, 98304
  s_nop 0
  buffer_load_dwordx4 v7, s[8:11], s41 offen offset:1024 lds
  ds_read_b64_tr_b16 a[4:5], v12 offset:13312
  ds_read_b64_tr_b16 a[6:7], v12 offset:13824
  v_mul_f32 v27, v19, v19
  v_mul_f32 v28, v20, v20
  v_mul_f32 v29, v21, v21
  v_fmaak_f32 v26, v26, v17, 0xc0135761
  s_waitcnt lgkmcnt(4)
  v_mfma_f32_32x32x16_bf16 v[64:79], a[16:19], v[140:143], v[64:79]
  ds_read_b64_tr_b16 a[8:9], v11 offset:16384
  ds_read_b64_tr_b16 a[10:11], v11 offset:16896
  v_fmaak_f32 v27, v27, v17, 0xc0135761
  v_fmaak_f32 v28, v28, v17, 0xc0135761
  v_fmaak_f32 v29, v29, v17, 0xc0135761
  v_mul_f32 v26, v18, v26
  v_mfma_f32_32x32x16_bf16 v[80:95], a[20:23], v[140:143], v[80:95]
  ds_read_b64_tr_b16 a[12:13], v12 offset:16384
  ds_read_b64_tr_b16 a[14:15], v12 offset:16896
  v_mul_f32 v27, v19, v27
  v_mul_f32 v28, v20, v28
  v_mul_f32 v29, v21, v29
  v_exp_f32 v26, v26
  s_waitcnt lgkmcnt(4)
  v_mfma_f32_32x32x16_bf16 v[64:79], a[0:3], v[220:223], v[64:79]
  s_add_u32 m0, s40, 98304
  s_nop 0
  buffer_load_dwordx4 v8, s[8:11], s41 offen offset:2048 lds
  ds_read_b64_tr_b16 a[16:17], v11 offset:17408
  ds_read_b64_tr_b16 a[18:19], v11 offset:17920
  v_exp_f32 v27, v27
  v_exp_f32 v28, v28
  v_mfma_f32_32x32x16_bf16 v[80:95], a[4:7], v[220:223], v[80:95]
  ds_read_b64_tr_b16 a[20:21], v12 offset:17408
  ds_read_b64_tr_b16 a[22:23], v12 offset:17920
  v_exp_f32 v29, v29
  v_add_f32 v26, 1.0, v26
  v_add_f32 v27, 1.0, v27
  v_add_f32 v28, 1.0, v28
  s_waitcnt lgkmcnt(4)
  v_mfma_f32_32x32x16_bf16 v[64:79], a[8:11], v[144:147], v[64:79]
  ds_read_b64_tr_b16 a[0:1], v11 offset:20480
  ds_read_b64_tr_b16 a[2:3], v11 offset:20992
  v_add_f32 v29, 1.0, v29
  v_rcp_f32 v26, v26
  v_mfma_f32_32x32x16_bf16 v[80:95], a[12:15], v[144:147], v[80:95]
  s_add_u32 m0, s40, 98304
  s_nop 0
  buffer_load_dwordx4 v9, s[8:11], s41 offen offset:3072 lds
  ds_read_b64_tr_b16 a[4:5], v12 offset:20480
  ds_read_b64_tr_b16 a[6:7], v12 offset:20992
  v_rcp_f32 v27, v27
  v_rcp_f32 v28, v28
  s_waitcnt lgkmcnt(4)
  v_mfma_f32_32x32x16_bf16 v[64:79], a[16:19], v[224:227], v[64:79]
  ds_read_b64_tr_b16 a[8:9], v11 offset:21504
  ds_read_b64_tr_b16 a[10:11], v11 offset:22016
  v_rcp_f32 v29, v29
  v_mul_f32 v48, v18, v26
  v_mul_f32 v49, v19, v27
  v_mul_f32 v50, v20, v28
  v_mul_f32 v51, v21, v29
  v_mfma_f32_32x32x16_bf16 v[80:95], a[20:23], v[224:227], v[80:95]
  ds_read_b64_tr_b16 a[12:13], v12 offset:21504
  ds_read_b64_tr_b16 a[14:15], v12 offset:22016
  ds_read_b128 v[18:21], v30 offset:192
  v_cvt_pk_bf16_f32 v48, v48, v49
  v_cvt_pk_bf16_f32 v49, v50, v51
  v_fmac_f32 v22, v52, v16
  s_waitcnt lgkmcnt(5)
  v_mfma_f32_32x32x16_bf16 v[64:79], a[0:3], v[148:151], v[64:79]
  ds_read_b64_tr_b16 a[16:17], v11 offset:24576
  ds_read_b64_tr_b16 a[18:19], v11 offset:25088
  v_fmac_f32 v23, v53, v16
  v_fmac_f32 v24, v54, v16
  v_fmac_f32 v25, v55, v16
  v_mul_f32 v26, v22, v22
  v_mfma_f32_32x32x16_bf16 v[80:95], a[4:7], v[148:151], v[80:95]
  ds_read_b64_tr_b16 a[20:21], v12 offset:24576
  ds_read_b64_tr_b16 a[22:23], v12 offset:25088
  v_mul_f32 v27, v23, v23
  v_mul_f32 v28, v24, v24
  v_mul_f32 v29, v25, v25
  v_fmaak_f32 v26, v26, v17, 0xc0135761
  s_waitcnt lgkmcnt(5)
  v_mfma_f32_32x32x16_bf16 v[64:79], a[8:11], v[228:231], v[64:79]
  ds_read_b64_tr_b16 a[0:1], v11 offset:25600
  ds_read_b64_tr_b16 a[2:3], v11 offset:26112
  v_fmaak_f32 v27, v27, v17, 0xc0135761
  v_fmaak_f32 v28, v28, v17, 0xc0135761
  v_fmaak_f32 v29, v29, v17, 0xc0135761
  v_mul_f32 v26, v22, v26
  v_mfma_f32_32x32x16_bf16 v[80:95], a[12:15], v[228:231], v[80:95]
  ds_read_b64_tr_b16 a[4:5], v12 offset:25600
  ds_read_b64_tr_b16 a[6:7], v12 offset:26112
  v_mul_f32 v27, v23, v27
  v_mul_f32 v28, v24, v28
  v_mul_f32 v29, v25, v29
  v_exp_f32 v26, v26
  s_barrier
  s_waitcnt lgkmcnt(4)
  v_mfma_f32_32x32x16_bf16 v[64:79], a[16:19], v[152:155], v[64:79]
  ds_read_b64_tr_b16 a[8:9], v11 offset:28672
  ds_read_b64_tr_b16 a[10:11], v11 offset:29184
  v_exp_f32 v27, v27
  v_exp_f32 v28, v28
  v_mfma_f32_32x32x16_bf16 v[80:95], a[20:23], v[152:155], v[80:95]
  ds_read_b64_tr_b16 a[12:13], v12 offset:28672
  ds_read_b64_tr_b16 a[14:15], v12 offset:29184
  v_exp_f32 v29, v29
  v_add_f32 v26, 1.0, v26
  v_add_f32 v27, 1.0, v27
  v_add_f32 v28, 1.0, v28
  s_waitcnt lgkmcnt(4)
  v_mfma_f32_32x32x16_bf16 v[64:79], a[0:3], v[232:235], v[64:79]
  s_add_u32 s41, s35, s38
  s_add_u32 m0, s40, 0
  s_nop 0
  buffer_load_dwordx4 v6, s[8:11], s41 offen offset:0 lds
  ds_read_b64_tr_b16 a[16:17], v11 offset:29696
  ds_read_b64_tr_b16 a[18:19], v11 offset:30208
  v_add_f32 v29, 1.0, v29
  v_rcp_f32 v26, v26
  v_mfma_f32_32x32x16_bf16 v[80:95], a[4:7], v[232:235], v[80:95]
  ds_read_b64_tr_b16 a[20:21], v12 offset:29696
  ds_read_b64_tr_b16 a[22:23], v12 offset:30208
  v_rcp_f32 v27, v27
  v_rcp_f32 v28, v28
  s_waitcnt lgkmcnt(4)
  v_mfma_f32_32x32x16_bf16 v[64:79], a[8:11], v[156:159], v[64:79]
  ds_read_b64_tr_b16 a[0:1], v11 offset:32768
  ds_read_b64_tr_b16 a[2:3], v11 offset:33280
  v_rcp_f32 v29, v29
  v_mul_f32 v52, v22, v26
  v_mul_f32 v53, v23, v27
  v_mul_f32 v54, v24, v28
  v_mul_f32 v55, v25, v29
  ds_read_b128 v[22:25], v30 offset:224
  v_mfma_f32_32x32x16_bf16 v[80:95], a[12:15], v[156:159], v[80:95]
  s_add_u32 m0, s40, 0
  s_nop 0
  buffer_load_dwordx4 v7, s[8:11], s41 offen offset:1024 lds
  ds_read_b64_tr_b16 a[4:5], v12 offset:32768
  ds_read_b64_tr_b16 a[6:7], v12 offset:33280
  v_cvt_pk_bf16_f32 v50, v52, v53
  v_cvt_pk_bf16_f32 v51, v54, v55
  buffer_store_dwordx4 v[48:51], v15, s[12:15], s44 offen offset:1024 sc1
  v_fmac_f32 v18, v56, v16
  s_waitcnt lgkmcnt(5)
  v_mfma_f32_32x32x16_bf16 v[64:79], a[16:19], v[236:239], v[64:79]
  ds_read_b64_tr_b16 a[8:9], v11 offset:33792
  ds_read_b64_tr_b16 a[10:11], v11 offset:34304
  v_fmac_f32 v19, v57, v16
  v_fmac_f32 v20, v58, v16
  v_fmac_f32 v21, v59, v16
  v_mul_f32 v26, v18, v18
  v_mfma_f32_32x32x16_bf16 v[80:95], a[20:23], v[236:239], v[80:95]
  ds_read_b64_tr_b16 a[12:13], v12 offset:33792
  ds_read_b64_tr_b16 a[14:15], v12 offset:34304
  v_mul_f32 v27, v19, v19
  v_mul_f32 v28, v20, v20
  v_mul_f32 v29, v21, v21
  v_fmaak_f32 v26, v26, v17, 0xc0135761
  s_waitcnt lgkmcnt(4)
  v_mfma_f32_32x32x16_bf16 v[64:79], a[0:3], v[160:163], v[64:79]
  s_add_u32 m0, s40, 0
  s_nop 0
  buffer_load_dwordx4 v8, s[8:11], s41 offen offset:2048 lds
  ds_read_b64_tr_b16 a[16:17], v11 offset:36864
  ds_read_b64_tr_b16 a[18:19], v11 offset:37376
  v_fmaak_f32 v27, v27, v17, 0xc0135761
  v_fmaak_f32 v28, v28, v17, 0xc0135761
  v_fmaak_f32 v29, v29, v17, 0xc0135761
  v_mul_f32 v26, v18, v26
  v_mfma_f32_32x32x16_bf16 v[80:95], a[4:7], v[160:163], v[80:95]
  ds_read_b64_tr_b16 a[20:21], v12 offset:36864
  ds_read_b64_tr_b16 a[22:23], v12 offset:37376
  v_mul_f32 v27, v19, v27
  v_mul_f32 v28, v20, v28
  v_mul_f32 v29, v21, v29
  s_waitcnt lgkmcnt(4)
  v_mfma_f32_32x32x16_bf16 v[64:79], a[8:11], v[240:243], v[64:79]
  ds_read_b64_tr_b16 a[0:1], v11 offset:37888
  ds_read_b64_tr_b16 a[2:3], v11 offset:38400
  v_exp_f32 v26, v26
  v_exp_f32 v27, v27
  v_exp_f32 v28, v28
  v_mfma_f32_32x32x16_bf16 v[80:95], a[12:15], v[240:243], v[80:95]
  s_add_u32 m0, s40, 0
  s_nop 0
  buffer_load_dwordx4 v9, s[8:11], s41 offen offset:3072 lds
  ds_read_b64_tr_b16 a[4:5], v12 offset:37888
  ds_read_b64_tr_b16 a[6:7], v12 offset:38400
  v_exp_f32 v29, v29
  v_add_f32 v26, 1.0, v26
  v_add_f32 v27, 1.0, v27
  s_waitcnt lgkmcnt(4)
  v_mfma_f32_32x32x16_bf16 v[64:79], a[16:19], v[164:167], v[64:79]
  ds_read_b64_tr_b16 a[8:9], v11 offset:40960
  ds_read_b64_tr_b16 a[10:11], v11 offset:41472
  v_add_f32 v28, 1.0, v28
  v_add_f32 v29, 1.0, v29
  v_rcp_f32 v26, v26
  v_mfma_f32_32x32x16_bf16 v[80:95], a[20:23], v[164:167], v[80:95]
  ds_read_b64_tr_b16 a[12:13], v12 offset:40960
  ds_read_b64_tr_b16 a[14:15], v12 offset:41472
  v_rcp_f32 v27, v27
  v_rcp_f32 v28, v28
  s_waitcnt lgkmcnt(4)
  v_mfma_f32_32x32x16_bf16 v[64:79], a[0:3], v[244:247], v[64:79]
  ds_read_b64_tr_b16 a[16:17], v11 offset:41984
  ds_read_b64_tr_b16 a[18:19], v11 offset:42496
  v_rcp_f32 v29, v29
  v_mul_f32 v56, v18, v26
  v_mul_f32 v57, v19, v27
  v_mul_f32 v58, v20, v28
  v_mfma_f32_32x32x16_bf16 v[80:95], a[4:7], v[244:247], v[80:95]
  ds_read_b64_tr_b16 a[20:21], v12 offset:41984
  ds_read_b64_tr_b16 a[22:23], v12 offset:42496
  v_mul_f32 v59, v21, v29
  v_cvt_pk_bf16_f32 v56, v56, v57
  v_cvt_pk_bf16_f32 v57, v58, v59
  v_fmac_f32 v22, v60, v16
  s_waitcnt vmcnt(20)
  s_barrier
  s_waitcnt lgkmcnt(4)
  v_mfma_f32_32x32x16_bf16 v[64:79], a[8:11], v[168:171], v[64:79]
  ds_read_b64_tr_b16 a[0:1], v11 offset:45056
  ds_read_b64_tr_b16 a[2:3], v11 offset:45568
  v_fmac_f32 v23, v61, v16
  v_fmac_f32 v24, v62, v16
  v_fmac_f32 v25, v63, v16
  v_mul_f32 v26, v22, v22
  v_mfma_f32_32x32x16_bf16 v[80:95], a[12:15], v[168:171], v[80:95]
  s_add_u32 s41, s31, s39
  s_add_u32 m0, s40, 16384
  s_nop 0
  buffer_load_dwordx4 v6, s[8:11], s41 offen offset:0 lds
  ds_read_b64_tr_b16 a[4:5], v12 offset:45056
  ds_read_b64_tr_b16 a[6:7], v12 offset:45568
  v_mul_f32 v27, v23, v23
  v_mul_f32 v28, v24, v24
  v_mul_f32 v29, v25, v25
  v_fmaak_f32 v26, v26, v17, 0xc0135761
  s_waitcnt lgkmcnt(4)
  v_mfma_f32_32x32x16_bf16 v[64:79], a[16:19], v[248:251], v[64:79]
  ds_read_b64_tr_b16 a[8:9], v11 offset:46080
  ds_read_b64_tr_b16 a[10:11], v11 offset:46592
  v_fmaak_f32 v27, v27, v17, 0xc0135761
  v_fmaak_f32 v28, v28, v17, 0xc0135761
  v_fmaak_f32 v29, v29, v17, 0xc0135761
  v_mul_f32 v26, v22, v26
  v_mfma_f32_32x32x16_bf16 v[80:95], a[20:23], v[248:251], v[80:95]
  ds_read_b64_tr_b16 a[12:13], v12 offset:46080
  ds_read_b64_tr_b16 a[14:15], v12 offset:46592
  v_mul_f32 v27, v23, v27
  v_mul_f32 v28, v24, v28
  v_mul_f32 v29, v25, v29
  v_exp_f32 v26, v26
  s_waitcnt lgkmcnt(4)
  v_mfma_f32_32x32x16_bf16 v[64:79], a[0:3], v[172:175], v[64:79]
  s_add_u32 m0, s40, 16384
  s_nop 0
  buffer_load_dwordx4 v7, s[8:11], s41 offen offset:1024 lds
  ds_read_b64_tr_b16 a[16:17], v11 offset:49152
  ds_read_b64_tr_b16 a[18:19], v11 offset:49664
  v_exp_f32 v27, v27
  v_exp_f32 v28, v28
  v_mfma_f32_32x32x16_bf16 v[80:95], a[4:7], v[172:175], v[80:95]
  ds_read_b64_tr_b16 a[20:21], v12 offset:49152
  ds_read_b64_tr_b16 a[22:23], v12 offset:49664
  v_exp_f32 v29, v29
  v_add_f32 v26, 1.0, v26
  v_add_f32 v27, 1.0, v27
  v_add_f32 v28, 1.0, v28
  s_waitcnt lgkmcnt(4)
  v_mfma_f32_32x32x16_bf16 v[64:79], a[8:11], v[252:255], v[64:79]
  ds_read_b64_tr_b16 a[0:1], v11 offset:50176
  ds_read_b64_tr_b16 a[2:3], v11 offset:50688
  v_add_f32 v29, 1.0, v29
  v_rcp_f32 v26, v26
  v_mfma_f32_32x32x16_bf16 v[80:95], a[12:15], v[252:255], v[80:95]
  s_add_u32 m0, s40, 16384
  s_nop 0
  buffer_load_dwordx4 v8, s[8:11], s41 offen offset:2048 lds
  ds_read_b64_tr_b16 a[4:5], v12 offset:50176
  ds_read_b64_tr_b16 a[6:7], v12 offset:50688
  v_rcp_f32 v27, v27
  v_rcp_f32 v28, v28
  v_rcp_f32 v29, v29
  v_mul_f32 v60, v22, v26
  v_mul_f32 v61, v23, v27
  v_mul_f32 v62, v24, v28
  v_mul_f32 v63, v25, v29
  v_cvt_pk_bf16_f32 v58, v60, v61
  v_cvt_pk_bf16_f32 v59, v62, v63
  buffer_store_dwordx4 v[56:59], v15, s[12:15], s44 offen offset:1536 sc1
  s_waitcnt lgkmcnt(4)
  v_mfma_f32_32x32x16_bf16 v[32:47], a[16:19], v[96:99], 0
  ds_read_b64_tr_b16 a[8:9], v11 offset:53248
  ds_read_b64_tr_b16 a[10:11], v11 offset:53760
  v_mfma_f32_32x32x16_bf16 v[48:63], a[20:23], v[96:99], 0
  ds_read_b64_tr_b16 a[12:13], v12 offset:53248
  ds_read_b64_tr_b16 a[14:15], v12 offset:53760
  v_add_u32 v30, s49, v10
  ds_read_b128 v[18:21], v30 offset:0
  ds_read_b128 v[22:25], v30 offset:32
  s_waitcnt lgkmcnt(1)
  v_fmac_f32 v18, v64, v16
  v_fmac_f32 v19, v65, v16
  v_mfma_f32_32x32x16_bf16 v[32:47], a[0:3], v[176:179], v[32:47]
  s_add_u32 m0, s40, 16384
  s_nop 0
  buffer_load_dwordx4 v9, s[8:11], s41 offen offset:3072 lds
  ds_read_b64_tr_b16 a[16:17], v11 offset:54272
  ds_read_b64_tr_b16 a[18:19], v11 offset:54784
  v_fmac_f32 v20, v66, v16
  v_fmac_f32 v21, v67, v16
  v_mul_f32 v26, v18, v18
  v_mul_f32 v27, v19, v19
  v_mfma_f32_32x32x16_bf16 v[48:63], a[4:7], v[176:179], v[48:63]
  ds_read_b64_tr_b16 a[20:21], v12 offset:54272
  ds_read_b64_tr_b16 a[22:23], v12 offset:54784
  v_mul_f32 v28, v20, v20
  v_mul_f32 v29, v21, v21
  v_fmaak_f32 v26, v26, v17, 0xc0135761
  v_fmaak_f32 v27, v27, v17, 0xc0135761
  v_mfma_f32_32x32x16_bf16 v[32:47], a[8:11], v[100:103], v[32:47]
  ds_read_b64_tr_b16 a[0:1], v11 offset:57344
  ds_read_b64_tr_b16 a[2:3], v11 offset:57856
  v_fmaak_f32 v28, v28, v17, 0xc0135761
  v_fmaak_f32 v29, v29, v17, 0xc0135761
  v_mul_f32 v26, v18, v26
  v_mul_f32 v27, v19, v27
  v_mfma_f32_32x32x16_bf16 v[48:63], a[12:15], v[100:103], v[48:63]
  ds_read_b64_tr_b16 a[4:5], v12 offset:57344
  ds_read_b64_tr_b16 a[6:7], v12 offset:57856
  v_mul_f32 v28, v20, v28
  v_mul_f32 v29, v21, v29
  v_exp_f32 v26, v26
  s_waitcnt lgkmcnt(4)
  v_mfma_f32_32x32x16_bf16 v[32:47], a[16:19], v[180:183], v[32:47]
  ds_read_b64_tr_b16 a[8:9], v11 offset:58368
  ds_read_b64_tr_b16 a[10:11], v11 offset:58880
  v_exp_f32 v27, v27
  v_exp_f32 v28, v28
  v_mfma_f32_32x32x16_bf16 v[48:63], a[20:23], v[180:183], v[48:63]
  ds_read_b64_tr_b16 a[12:13], v12 offset:58368
  ds_read_b64_tr_b16 a[14:15], v12 offset:58880
  v_exp_f32 v29, v29
  v_add_f32 v26, 1.0, v26
  v_add_f32 v27, 1.0, v27
  v_add_f32 v28, 1.0, v28
  s_waitcnt vmcnt(20)
  s_barrier
  s_waitcnt lgkmcnt(4)
  v_mfma_f32_32x32x16_bf16 v[32:47], a[0:3], v[104:107], v[32:47]
  s_add_u32 s41, s32, s39
  s_add_u32 m0, s40, 32768
  s_nop 0
  buffer_load_dwordx4 v6, s[8:11], s41 offen offset:0 lds
  ds_read_b64_tr_b16 a[16:17], v11 offset:61440
  ds_read_b64_tr_b16 a[18:19], v11 offset:61952
  v_add_f32 v29, 1.0, v29
  v_rcp_f32 v26, v26
  v_rcp_f32 v27, v27
  v_mfma_f32_32x32x16_bf16 v[48:63], a[4:7], v[104:107], v[48:63]
  ds_read_b64_tr_b16 a[20:21], v12 offset:61440
  ds_read_b64_tr_b16 a[22:23], v12 offset:61952
  v_rcp_f32 v28, v28
  v_rcp_f32 v29, v29
  s_waitcnt lgkmcnt(4)
  v_mfma_f32_32x32x16_bf16 v[32:47], a[8:11], v[184:187], v[32:47]
  ds_read_b64_tr_b16 a[0:1], v11 offset:62464
  ds_read_b64_tr_b16 a[2:3], v11 offset:62976
  v_mul_f32 v64, v18, v26
  v_mul_f32 v65, v19, v27
  v_mul_f32 v66, v20, v28
  v_mul_f32 v67, v21, v29
  ds_read_b128 v[18:21], v30 offset:64
  v_mfma_f32_32x32x16_bf16 v[48:63], a[12:15], v[184:187], v[48:63]
  s_add_u32 m0, s40, 32768
  s_nop 0
  buffer_load_dwordx4 v7, s[8:11], s41 offen offset:1024 lds
  ds_read_b64_tr_b16 a[4:5], v12 offset:62464
  ds_read_b64_tr_b16 a[6:7], v12 offset:62976
  v_cvt_pk_bf16_f32 v64, v64, v65
  v_cvt_pk_bf16_f32 v65, v66, v67
  v_fmac_f32 v22, v68, v16
  v_fmac_f32 v23, v69, v16
  s_waitcnt lgkmcnt(5)
  v_mfma_f32_32x32x16_bf16 v[32:47], a[16:19], v[108:111], v[32:47]
  ds_read_b64_tr_b16 a[8:9], v13 offset:0
  ds_read_b64_tr_b16 a[10:11], v13 offset:512
  v_fmac_f32 v24, v70, v16
  v_fmac_f32 v25, v71, v16
  v_mul_f32 v26, v22, v22
  v_mul_f32 v27, v23, v23
  v_mfma_f32_32x32x16_bf16 v[48:63], a[20:23], v[108:111], v[48:63]
  ds_read_b64_tr_b16 a[12:13], v14 offset:0
  ds_read_b64_tr_b16 a[14:15], v14 offset:512
  v_mul_f32 v28, v24, v24
  v_mul_f32 v29, v25, v25
  v_fmaak_f32 v26, v26, v17, 0xc0135761
  v_fmaak_f32 v27, v27, v17, 0xc0135761
  s_waitcnt lgkmcnt(4)
  v_mfma_f32_32x32x16_bf16 v[32:47], a[0:3], v[188:191], v[32:47]
  s_add_u32 m0, s40, 32768
  s_nop 0
  buffer_load_dwordx4 v8, s[8:11], s41 offen offset:2048 lds
  ds_read_b64_tr_b16 a[16:17], v13 offset:1024
  ds_read_b64_tr_b16 a[18:19], v13 offset:1536
  v_fmaak_f32 v28, v28, v17, 0xc0135761
  v_fmaak_f32 v29, v29, v17, 0xc0135761
  v_mul_f32 v26, v22, v26
  v_mul_f32 v27, v23, v27
  v_mfma_f32_32x32x16_bf16 v[48:63], a[4:7], v[188:191], v[48:63]
  ds_read_b64_tr_b16 a[20:21], v14 offset:1024
  ds_read_b64_tr_b16 a[22:23], v14 offset:1536
  v_mul_f32 v28, v24, v28
  v_mul_f32 v29, v25, v29
  v_exp_f32 v26, v26
  s_waitcnt lgkmcnt(4)
  v_mfma_f32_32x32x16_bf16 v[32:47], a[8:11], v[112:115], v[32:47]
  ds_read_b64_tr_b16 a[0:1], v13 offset:4096
  ds_read_b64_tr_b16 a[2:3], v13 offset:4608
  v_exp_f32 v27, v27
  v_exp_f32 v28, v28
  v_mfma_f32_32x32x16_bf16 v[48:63], a[12:15], v[112:115], v[48:63]
  s_add_u32 m0, s40, 32768
  s_nop 0
  buffer_load_dwordx4 v9, s[8:11], s41 offen offset:3072 lds
  ds_read_b64_tr_b16 a[4:5], v14 offset:4096
  ds_read_b64_tr_b16 a[6:7], v14 offset:4608
  v_exp_f32 v29, v29
  v_add_f32 v26, 1.0, v26
  v_add_f32 v27, 1.0, v27
  v_add_f32 v28, 1.0, v28
  s_waitcnt lgkmcnt(4)
  v_mfma_f32_32x32x16_bf16 v[32:47], a[16:19], v[192:195], v[32:47]
  ds_read_b64_tr_b16 a[8:9], v13 offset:5120
  ds_read_b64_tr_b16 a[10:11], v13 offset:5632
  v_add_f32 v29, 1.0, v29
  v_rcp_f32 v26, v26
  v_rcp_f32 v27, v27
  v_mfma_f32_32x32x16_bf16 v[48:63], a[20:23], v[192:195], v[48:63]
  ds_read_b64_tr_b16 a[12:13], v14 offset:5120
  ds_read_b64_tr_b16 a[14:15], v14 offset:5632
  v_rcp_f32 v28, v28
  v_rcp_f32 v29, v29
  s_waitcnt lgkmcnt(4)
  v_mfma_f32_32x32x16_bf16 v[32:47], a[0:3], v[116:119], v[32:47]
  ds_read_b64_tr_b16 a[16:17], v13 offset:8192
  ds_read_b64_tr_b16 a[18:19], v13 offset:8704
  v_mul_f32 v68, v22, v26
  v_mul_f32 v69, v23, v27
  v_mul_f32 v70, v24, v28
  v_mul_f32 v71, v25, v29
  ds_read_b128 v[22:25], v30 offset:96
  v_mfma_f32_32x32x16_bf16 v[48:63], a[4:7], v[116:119], v[48:63]
  ds_read_b64_tr_b16 a[20:21], v14 offset:8192
  ds_read_b64_tr_b16 a[22:23], v14 offset:8704
  v_cvt_pk_bf16_f32 v66, v68, v69
  v_cvt_pk_bf16_f32 v67, v70, v71
  buffer_store_dwordx4 v[64:67], v15, s[12:15], s45 offen offset:0 sc1
  v_fmac_f32 v18, v72, v16
  v_fmac_f32 v19, v73, v16
  s_waitcnt lgkmcnt(5)
  v_mfma_f32_32x32x16_bf16 v[32:47], a[8:11], v[196:199], v[32:47]
  ds_read_b64_tr_b16 a[0:1], v13 offset:9216
  ds_read_b64_tr_b16 a[2:3], v13 offset:9728
  v_fmac_f32 v20, v74, v16
  v_fmac_f32 v21, v75, v16
  v_mul_f32 v26, v18, v18
  v_mul_f32 v27, v19, v19
  v_mfma_f32_32x32x16_bf16 v[48:63], a[12:15], v[196:199], v[48:63]
  ds_read_b64_tr_b16 a[4:5], v14 offset:9216
  ds_read_b64_tr_b16 a[6:7], v14 offset:9728
  v_mul_f32 v28, v20, v20
  v_mul_f32 v29, v21, v21
  v_fmaak_f32 v26, v26, v17, 0xc0135761
  v_fmaak_f32 v27, v27, v17, 0xc0135761
  s_waitcnt vmcnt(20)
  s_barrier
  s_cmp_eq_u32 s20, 0
  s_cselect_b32 s72, 36864, 0x40000000
  v_mul_u32_u24 v31, 12, v1
  v_add_u32 v31, s72, v31
  buffer_load_dwordx3 a[24:26], v31, s[56:59], 0 offen sc1
  s_waitcnt lgkmcnt(4)
  v_mfma_f32_32x32x16_bf16 v[32:47], a[16:19], v[120:123], v[32:47]
  ds_read_b64_tr_b16 a[8:9], v13 offset:12288
  ds_read_b64_tr_b16 a[10:11], v13 offset:12800
  v_fmaak_f32 v28, v28, v17, 0xc0135761
  v_fmaak_f32 v29, v29, v17, 0xc0135761
  v_mul_f32 v26, v18, v26
  v_mul_f32 v27, v19, v27
  v_mfma_f32_32x32x16_bf16 v[48:63], a[20:23], v[120:123], v[48:63]
  ds_read_b64_tr_b16 a[12:13], v14 offset:12288
  ds_read_b64_tr_b16 a[14:15], v14 offset:12800
  v_mul_f32 v28, v20, v28
  v_mul_f32 v29, v21, v29
  v_exp_f32 v26, v26
  s_waitcnt lgkmcnt(4)
  v_mfma_f32_32x32x16_bf16 v[32:47], a[0:3], v[200:203], v[32:47]
  s_add_u32 s41, s33, s39
  s_add_u32 m0, s40, 49152
  s_nop 0
  buffer_load_dwordx4 v6, s[8:11], s41 offen offset:0 lds
  ds_read_b64_tr_b16 a[16:17], v13 offset:13312
  ds_read_b64_tr_b16 a[18:19], v13 offset:13824
  v_exp_f32 v27, v27
  v_exp_f32 v28, v28
  v_mfma_f32_32x32x16_bf16 v[48:63], a[4:7], v[200:203], v[48:63]
  ds_read_b64_tr_b16 a[20:21], v14 offset:13312
  ds_read_b64_tr_b16 a[22:23], v14 offset:13824
  v_exp_f32 v29, v29
  v_add_f32 v26, 1.0, v26
  v_add_f32 v27, 1.0, v27
  v_add_f32 v28, 1.0, v28
  s_waitcnt lgkmcnt(4)
  v_mfma_f32_32x32x16_bf16 v[32:47], a[8:11], v[124:127], v[32:47]
  ds_read_b64_tr_b16 a[0:1], v13 offset:16384
  ds_read_b64_tr_b16 a[2:3], v13 offset:16896
  v_add_f32 v29, 1.0, v29
  v_rcp_f32 v26, v26
  v_mfma_f32_32x32x16_bf16 v[48:63], a[12:15], v[124:127], v[48:63]
  s_add_u32 m0, s40, 49152
  s_nop 0
  buffer_load_dwordx4 v7, s[8:11], s41 offen offset:1024 lds
  ds_read_b64_tr_b16 a[4:5], v14 offset:16384
  ds_read_b64_tr_b16 a[6:7], v14 offset:16896
  v_rcp_f32 v27, v27
  v_rcp_f32 v28, v28
  v_rcp_f32 v29, v29
  s_waitcnt lgkmcnt(4)
  v_mfma_f32_32x32x16_bf16 v[32:47], a[16:19], v[204:207], v[32:47]
  ds_read_b64_tr_b16 a[8:9], v13 offset:17408
  ds_read_b64_tr_b16 a[10:11], v13 offset:17920
  v_mul_f32 v72, v18, v26
  v_mul_f32 v73, v19, v27
  v_mul_f32 v74, v20, v28
  v_mul_f32 v75, v21, v29
  ds_read_b128 v[18:21], v30 offset:128
  v_mfma_f32_32x32x16_bf16 v[48:63], a[20:23], v[204:207], v[48:63]
  ds_read_b64_tr_b16 a[12:13], v14 offset:17408
  ds_read_b64_tr_b16 a[14:15], v14 offset:17920
  v_cvt_pk_bf16_f32 v72, v72, v73
  v_cvt_pk_bf16_f32 v73, v74, v75
  v_fmac_f32 v22, v76, v16
  v_fmac_f32 v23, v77, v16
  s_waitcnt lgkmcnt(5)
  v_mfma_f32_32x32x16_bf16 v[32:47], a[0:3], v[128:131], v[32:47]
  s_add_u32 m0, s40, 49152
  s_nop 0
  buffer_load_dwordx4 v8, s[8:11], s41 offen offset:2048 lds
  ds_read_b64_tr_b16 a[16:17], v13 offset:20480
  ds_read_b64_tr_b16 a[18:19], v13 offset:20992
  v_fmac_f32 v24, v78, v16
  v_fmac_f32 v25, v79, v16
  v_mul_f32 v26, v22, v22
  v_mul_f32 v27, v23, v23
  v_mfma_f32_32x32x16_bf16 v[48:63], a[4:7], v[128:131], v[48:63]
  ds_read_b64_tr_b16 a[20:21], v14 offset:20480
  ds_read_b64_tr_b16 a[22:23], v14 offset:20992
  v_mul_f32 v28, v24, v24
  v_mul_f32 v29, v25, v25
  v_fmaak_f32 v26, v26, v17, 0xc0135761
  v_fmaak_f32 v27, v27, v17, 0xc0135761
  s_waitcnt lgkmcnt(4)
  v_mfma_f32_32x32x16_bf16 v[32:47], a[8:11], v[208:211], v[32:47]
  ds_read_b64_tr_b16 a[0:1], v13 offset:21504
  ds_read_b64_tr_b16 a[2:3], v13 offset:22016
  v_fmaak_f32 v28, v28, v17, 0xc0135761
  v_fmaak_f32 v29, v29, v17, 0xc0135761
  v_mul_f32 v26, v22, v26
  v_mul_f32 v27, v23, v27
  v_mfma_f32_32x32x16_bf16 v[48:63], a[12:15], v[208:211], v[48:63]
  s_add_u32 m0, s40, 49152
  s_nop 0
  buffer_load_dwordx4 v9, s[8:11], s41 offen offset:3072 lds
  ds_read_b64_tr_b16 a[4:5], v14 offset:21504
  ds_read_b64_tr_b16 a[6:7], v14 offset:22016
  v_mul_f32 v28, v24, v28
  v_mul_f32 v29, v25, v29
  v_exp_f32 v26, v26
  s_waitcnt lgkmcnt(4)
  v_mfma_f32_32x32x16_bf16 v[32:47], a[16:19], v[132:135], v[32:47]
  ds_read_b64_tr_b16 a[8:9], v13 offset:24576
  ds_read_b64_tr_b16 a[10:11], v13 offset:25088
  v_exp_f32 v27, v27
  v_exp_f32 v28, v28
  v_mfma_f32_32x32x16_bf16 v[48:63], a[20:23], v[132:135], v[48:63]
  ds_read_b64_tr_b16 a[12:13], v14 offset:24576
  ds_read_b64_tr_b16 a[14:15], v14 offset:25088
  v_exp_f32 v29, v29
  v_add_f32 v26, 1.0, v26
  v_add_f32 v27, 1.0, v27
  v_add_f32 v28, 1.0, v28
  s_waitcnt lgkmcnt(4)
  v_mfma_f32_32x32x16_bf16 v[32:47], a[0:3], v[212:215], v[32:47]
  ds_read_b64_tr_b16 a[16:17], v13 offset:25600
  ds_read_b64_tr_b16 a[18:19], v13 offset:26112
  v_add_f32 v29, 1.0, v29
  v_rcp_f32 v26, v26
  v_mfma_f32_32x32x16_bf16 v[48:63], a[4:7], v[212:215], v[48:63]
  ds_read_b64_tr_b16 a[20:21], v14 offset:25600
  ds_read_b64_tr_b16 a[22:23], v14 offset:26112
  v_rcp_f32 v27, v27
  v_rcp_f32 v28, v28
  v_rcp_f32 v29, v29
  s_waitcnt vmcnt(4)
  s_cmp_lg_u32 s20, 0
  s_cbranch_scc1 L_ppw_ok
  s_mov_b32 s76, 0
L_ppw:
  v_accvgpr_read_b32 v2, a24
  v_accvgpr_read_b32 v3, a32
  v_cmp_eq_u32 s[72:73], v2, v3
  v_accvgpr_read_b32 v2, a25
  v_accvgpr_read_b32 v3, a33
  v_cmp_eq_u32 s[74:75], v2, v3
  v_accvgpr_read_b32 v2, a26
  v_accvgpr_read_b32 v3, a34
  v_cmp_eq_u32 vcc, v2, v3
  s_or_b64 s[72:73], s[72:73], s[74:75]
  s_nop 1
  s_or_b64 s[72:73], s[72:73], vcc
  s_cbranch_scc0 L_ppw_ok
  s_add_u32 s76, s76, 1
  s_cmp_ge_u32 s76, 0x1000
  s_cbranch_scc1 L_ppw_ok
  s_sleep 16
  buffer_load_dwordx3 a[24:26], v31, s[56:59], 0 offen sc1
  s_waitcnt vmcnt(0)
  s_branch L_ppw
L_ppw_ok:
  s_barrier
  v_mov_b32 v2, v1
  s_lshr_b32 s72, s100, 2
  s_mul_i32 s72, s72, 1
  v_subrev_u32 v4, 5, v2
  v_cmp_gt_u32 vcc, 10, v2
  s_nop 1
  v_cndmask_b32 v4, v4, v2, vcc
  v_lshlrev_b32 v4, 2, v4
  v_add_u32 v4, s20, v4
  v_mul_u32_u24 v5, 147, v4
  v_lshrrev_b32 v5, 11, v5
  v_mul_u32_u24 v31, 14, v5
  v_sub_u32 v4, v4, v31
  v_add_u32 v5, s72, v5
  v_and_b32 v5, 3, v5
  v_lshrrev_b32 v31, 1, v4
  v_lshl_add_u32 v5, v31, 2, v5
  v_and_b32 v4, 1, v4
  v_cmp_eq_u32 vcc, 27, v5
  v_min_u32 v5, 26, v5
  v_lshl_add_u32 v5, v5, 1, v4
  v_lshlrev_b32 v5, 10, v5
  v_cndmask_b32 v4, 0, 1, vcc
  v_or_b32 v5, v5, v4
  s_mul_i32 s72, s20, 5
  s_add_u32 s72, s72, 44
  v_add_u32 v4, s72, v2
  v_lshlrev_b32 v4, 10, v4
  v_subrev_u32 v31, 10, v2
  v_cmp_gt_u32 vcc, 5, v31
  s_nop 1
  v_cndmask_b32 v31, v5, v4, vcc
  v_lshlrev_b32 v4, 4, v1
  v_add_u32 v5, 4096, v4
  s_waitcnt lgkmcnt(4)
  v_mfma_f32_32x32x16_bf16 v[32:47], a[8:11], v[136:139], v[32:47]
  ds_read_b64_tr_b16 a[0:1], v13 offset:28672
  ds_read_b64_tr_b16 a[2:3], v13 offset:29184
  v_mul_f32 v76, v22, v26
  v_mul_f32 v77, v23, v27
  v_mul_f32 v78, v24, v28
  v_mul_f32 v79, v25, v29
  ds_read_b128 v[22:25], v30 offset:160
  v_mfma_f32_32x32x16_bf16 v[48:63], a[12:15], v[136:139], v[48:63]
  s_add_u32 s41, s34, s39
  s_add_u32 m0, s40, 65536
  s_nop 0
  buffer_load_dwordx4 v6, s[8:11], s41 offen offset:0 lds
  ds_read_b64_tr_b16 a[4:5], v14 offset:28672
  ds_read_b64_tr_b16 a[6:7], v14 offset:29184
  v_cvt_pk_bf16_f32 v74, v76, v77
  v_cvt_pk_bf16_f32 v75, v78, v79
  buffer_store_dwordx4 v[72:75], v15, s[12:15], s45 offen offset:512 sc1
  v_fmac_f32 v18, v80, v16
  s_waitcnt lgkmcnt(5)
  v_mfma_f32_32x32x16_bf16 v[32:47], a[16:19], v[216:219], v[32:47]
  s_mov_b32 s18, 3031040
  v_readlane_b32 s43, v31, 0
  s_nop 0
  s_mul_i32 s43, s43, 5
  s_add_u32 s43, s43, s63
  s_nop 1
  buffer_load_dwordx4 a[36:39], v4, s[16:19], s43 offen offset:0 sc1
  ds_read_b64_tr_b16 a[8:9], v13 offset:29696
  ds_read_b64_tr_b16 a[10:11], v13 offset:30208
  v_fmac_f32 v19, v81, v16
  v_fmac_f32 v20, v82, v16
  v_fmac_f32 v21, v83, v16
  v_mul_f32 v26, v18, v18
  v_mfma_f32_32x32x16_bf16 v[48:63], a[20:23], v[216:219], v[48:63]
  ds_read_b64_tr_b16 a[12:13], v14 offset:29696
  ds_read_b64_tr_b16 a[14:15], v14 offset:30208
  v_mul_f32 v27, v19, v19
  v_mul_f32 v28, v20, v20
  v_mul_f32 v29, v21, v21
  v_fmaak_f32 v26, v26, v17, 0xc0135761
  s_waitcnt lgkmcnt(4)
  v_mfma_f32_32x32x16_bf16 v[32:47], a[0:3], v[140:143], v[32:47]
  s_add_u32 m0, s40, 65536
  s_nop 0
  buffer_load_dwordx4 v7, s[8:11], s41 offen offset:1024 lds
  ds_read_b64_tr_b16 a[16:17], v13 offset:32768
  ds_read_b64_tr_b16 a[18:19], v13 offset:33280
  v_fmaak_f32 v27, v27, v17, 0xc0135761
  v_fmaak_f32 v28, v28, v17, 0xc0135761
  v_fmaak_f32 v29, v29, v17, 0xc0135761
  v_mul_f32 v26, v18, v26
  v_mfma_f32_32x32x16_bf16 v[48:63], a[4:7], v[140:143], v[48:63]
  buffer_load_dwordx4 a[40:43], v4, s[16:19], s43 offen offset:1024 sc1
  ds_read_b64_tr_b16 a[20:21], v14 offset:32768
  ds_read_b64_tr_b16 a[22:23], v14 offset:33280
  v_mul_f32 v27, v19, v27
  v_mul_f32 v28, v20, v28
  v_mul_f32 v29, v21, v29
  v_exp_f32 v26, v26
  s_waitcnt lgkmcnt(4)
  v_mfma_f32_32x32x16_bf16 v[32:47], a[8:11], v[220:223], v[32:47]
  ds_read_b64_tr_b16 a[0:1], v13 offset:33792
  ds_read_b64_tr_b16 a[2:3], v13 offset:34304
  v_exp_f32 v27, v27
  v_exp_f32 v28, v28
  v_mfma_f32_32x32x16_bf16 v[48:63], a[12:15], v[220:223], v[48:63]
  s_add_u32 m0, s40, 65536
  s_nop 0
  buffer_load_dwordx4 v8, s[8:11], s41 offen offset:2048 lds
  ds_read_b64_tr_b16 a[4:5], v14 offset:33792
  ds_read_b64_tr_b16 a[6:7], v14 offset:34304
  v_exp_f32 v29, v29
  v_add_f32 v26, 1.0, v26
  v_add_f32 v27, 1.0, v27
  v_add_f32 v28, 1.0, v28
  s_waitcnt lgkmcnt(4)
  v_mfma_f32_32x32x16_bf16 v[32:47], a[16:19], v[144:147], v[32:47]
  buffer_load_dwordx4 a[44:47], v4, s[16:19], s43 offen offset:2048 sc1
  ds_read_b64_tr_b16 a[8:9], v13 offset:36864
  ds_read_b64_tr_b16 a[10:11], v13 offset:37376
  v_add_f32 v29, 1.0, v29
  v_rcp_f32 v26, v26
  v_mfma_f32_32x32x16_bf16 v[48:63], a[20:23], v[144:147], v[48:63]
  ds_read_b64_tr_b16 a[12:13], v14 offset:36864
  ds_read_b64_tr_b16 a[14:15], v14 offset:37376
  v_rcp_f32 v27, v27
  v_rcp_f32 v28, v28
  s_waitcnt lgkmcnt(4)
  v_mfma_f32_32x32x16_bf16 v[32:47], a[0:3], v[224:227], v[32:47]
  s_add_u32 m0, s40, 65536
  s_nop 0
  buffer_load_dwordx4 v9, s[8:11], s41 offen offset:3072 lds
  ds_read_b64_tr_b16 a[16:17], v13 offset:37888
  ds_read_b64_tr_b16 a[18:19], v13 offset:38400
  v_rcp_f32 v29, v29
  v_mul_f32 v80, v18, v26
  v_mul_f32 v81, v19, v27
  v_mul_f32 v82, v20, v28
  v_mul_f32 v83, v21, v29
  v_mfma_f32_32x32x16_bf16 v[48:63], a[4:7], v[224:227], v[48:63]
  buffer_load_dwordx4 a[48:51], v4, s[16:19], s43 offen offset:3072 sc1
  ds_read_b64_tr_b16 a[20:21], v14 offset:37888
  ds_read_b64_tr_b16 a[22:23], v14 offset:38400
  ds_read_b128 v[18:21], v30 offset:192
  v_cvt_pk_bf16_f32 v80, v80, v81
  v_cvt_pk_bf16_f32 v81, v82, v83
  v_fmac_f32 v22, v84, v16
  s_waitcnt lgkmcnt(5)
  v_mfma_f32_32x32x16_bf16 v[32:47], a[8:11], v[148:151], v[32:47]
  ds_read_b64_tr_b16 a[0:1], v13 offset:40960
  ds_read_b64_tr_b16 a[2:3], v13 offset:41472
  v_fmac_f32 v23, v85, v16
  v_fmac_f32 v24, v86, v16
  v_fmac_f32 v25, v87, v16
  v_mul_f32 v26, v22, v22
  v_mfma_f32_32x32x16_bf16 v[48:63], a[12:15], v[148:151], v[48:63]
  ds_read_b64_tr_b16 a[4:5], v14 offset:40960
  ds_read_b64_tr_b16 a[6:7], v14 offset:41472
  v_mul_f32 v27, v23, v23
  v_mul_f32 v28, v24, v24
  v_mul_f32 v29, v25, v25
  v_fmaak_f32 v26, v26, v17, 0xc0135761
  s_waitcnt lgkmcnt(5)
  v_mfma_f32_32x32x16_bf16 v[32:47], a[16:19], v[228:231], v[32:47]
  buffer_load_dwordx4 a[52:55], v5, s[16:19], s43 offen offset:0 sc1
  ds_read_b64_tr_b16 a[8:9], v13 offset:41984
  ds_read_b64_tr_b16 a[10:11], v13 offset:42496
  v_fmaak_f32 v27, v27, v17, 0xc0135761
  v_fmaak_f32 v28, v28, v17, 0xc0135761
  v_fmaak_f32 v29, v29, v17, 0xc0135761
  v_mul_f32 v26, v22, v26
  v_mfma_f32_32x32x16_bf16 v[48:63], a[20:23], v[228:231], v[48:63]
  ds_read_b64_tr_b16 a[12:13], v14 offset:41984
  ds_read_b64_tr_b16 a[14:15], v14 offset:42496
  v_mul_f32 v27, v23, v27
  v_mul_f32 v28, v24, v28
  v_mul_f32 v29, v25, v29
  v_exp_f32 v26, v26
  s_barrier
  s_waitcnt lgkmcnt(4)
  v_mfma_f32_32x32x16_bf16 v[32:47], a[0:3], v[152:155], v[32:47]
  s_add_u32 s41, s35, s39
  s_add_u32 m0, s40, 81920
  s_nop 0
  buffer_load_dwordx4 v6, s[8:11], s41 offen offset:0 lds
  ds_read_b64_tr_b16 a[16:17], v13 offset:45056
  ds_read_b64_tr_b16 a[18:19], v13 offset:45568
  v_exp_f32 v27, v27
  v_exp_f32 v28, v28
  v_mfma_f32_32x32x16_bf16 v[48:63], a[4:7], v[152:155], v[48:63]
  v_readlane_b32 s43, v31, 1
  s_nop 0
  s_mul_i32 s43, s43, 5
  s_add_u32 s43, s43, s63
  s_nop 1
  buffer_load_dwordx4 a[56:59], v4, s[16:19], s43 offen offset:0 sc1
  ds_read_b64_tr_b16 a[20:21], v14 offset:45056
  ds_read_b64_tr_b16 a[22:23], v14 offset:45568
  v_exp_f32 v29, v29
  v_add_f32 v26, 1.0, v26
  v_add_f32 v27, 1.0, v27
  v_add_f32 v28, 1.0, v28
  s_waitcnt lgkmcnt(4)
  v_mfma_f32_32x32x16_bf16 v[32:47], a[8:11], v[232:235], v[32:47]
  ds_read_b64_tr_b16 a[0:1], v13 offset:46080
  ds_read_b64_tr_b16 a[2:3], v13 offset:46592
  v_add_f32 v29, 1.0, v29
  v_rcp_f32 v26, v26
  v_mfma_f32_32x32x16_bf16 v[48:63], a[12:15], v[232:235], v[48:63]
  s_add_u32 m0, s40, 81920
  s_nop 0
  buffer_load_dwordx4 v7, s[8:11], s41 offen offset:1024 lds
  ds_read_b64_tr_b16 a[4:5], v14 offset:46080
  ds_read_b64_tr_b16 a[6:7], v14 offset:46592
  v_rcp_f32 v27, v27
  v_rcp_f32 v28, v28
  s_waitcnt lgkmcnt(4)
  v_mfma_f32_32x32x16_bf16 v[32:47], a[16:19], v[156:159], v[32:47]
  buffer_load_dwordx4 a[60:63], v4, s[16:19], s43 offen offset:1024 sc1
  ds_read_b64_tr_b16 a[8:9], v11 offset:0
  ds_read_b64_tr_b16 a[10:11], v11 offset:512
  v_rcp_f32 v29, v29
  v_mul_f32 v84, v22, v26
  v_mul_f32 v85, v23, v27
  v_mul_f32 v86, v24, v28
  v_mul_f32 v87, v25, v29
  ds_read_b128 v[22:25], v30 offset:224
  v_mfma_f32_32x32x16_bf16 v[48:63], a[20:23], v[156:159], v[48:63]
  ds_read_b64_tr_b16 a[12:13], v12 offset:0
  ds_read_b64_tr_b16 a[14:15], v12 offset:512
  v_cvt_pk_bf16_f32 v82, v84, v85
  v_cvt_pk_bf16_f32 v83, v86, v87
  buffer_store_dwordx4 v[80:83], v15, s[12:15], s45 offen offset:1024 sc1
  v_fmac_f32 v18, v88, v16
  s_waitcnt lgkmcnt(5)
  v_mfma_f32_32x32x16_bf16 v[32:47], a[0:3], v[236:239], v[32:47]
  s_add_u32 m0, s40, 81920
  s_nop 0
  buffer_load_dwordx4 v8, s[8:11], s41 offen offset:2048 lds
  ds_read_b64_tr_b16 a[16:17], v11 offset:1024
  ds_read_b64_tr_b16 a[18:19], v11 offset:1536
  v_fmac_f32 v19, v89, v16
  v_fmac_f32 v20, v90, v16
  v_fmac_f32 v21, v91, v16
  v_mul_f32 v26, v18, v18
  v_mfma_f32_32x32x16_bf16 v[48:63], a[4:7], v[236:239], v[48:63]
  buffer_load_dwordx4 a[64:67], v4, s[16:19], s43 offen offset:2048 sc1
  ds_read_b64_tr_b16 a[20:21], v12 offset:1024
  ds_read_b64_tr_b16 a[22:23], v12 offset:1536
  v_mul_f32 v27, v19, v19
  v_mul_f32 v28, v20, v20
  v_mul_f32 v29, v21, v21
  v_fmaak_f32 v26, v26, v17, 0xc0135761
  s_waitcnt lgkmcnt(4)
  v_mfma_f32_32x32x16_bf16 v[32:47], a[8:11], v[160:163], v[32:47]
  ds_read_b64_tr_b16 a[0:1], v11 offset:4096
  ds_read_b64_tr_b16 a[2:3], v11 offset:4608
  v_fmaak_f32 v27, v27, v17, 0xc0135761
  v_fmaak_f32 v28, v28, v17, 0xc0135761
  v_fmaak_f32 v29, v29, v17, 0xc0135761
  v_mul_f32 v26, v18, v26
  v_mfma_f32_32x32x16_bf16 v[48:63], a[12:15], v[160:163], v[48:63]
  s_add_u32 m0, s40, 81920
  s_nop 0
  buffer_load_dwordx4 v9, s[8:11], s41 offen offset:3072 lds
  ds_read_b64_tr_b16 a[4:5], v12 offset:4096
  ds_read_b64_tr_b16 a[6:7], v12 offset:4608
  v_mul_f32 v27, v19, v27
  v_mul_f32 v28, v20, v28
  v_mul_f32 v29, v21, v29
  s_waitcnt lgkmcnt(4)
  v_mfma_f32_32x32x16_bf16 v[32:47], a[16:19], v[240:243], v[32:47]
  buffer_load_dwordx4 a[68:71], v4, s[16:19], s43 offen offset:3072 sc1
  ds_read_b64_tr_b16 a[8:9], v11 offset:5120
  ds_read_b64_tr_b16 a[10:11], v11 offset:5632
  v_exp_f32 v26, v26
  v_exp_f32 v27, v27
  v_exp_f32 v28, v28
  v_mfma_f32_32x32x16_bf16 v[48:63], a[20:23], v[240:243], v[48:63]
  ds_read_b64_tr_b16 a[12:13], v12 offset:5120
  ds_read_b64_tr_b16 a[14:15], v12 offset:5632
  v_exp_f32 v29, v29
  v_add_f32 v26, 1.0, v26
  v_add_f32 v27, 1.0, v27
  s_waitcnt lgkmcnt(4)
  v_mfma_f32_32x32x16_bf16 v[32:47], a[0:3], v[164:167], v[32:47]
  buffer_load_dwordx4 a[72:75], v5, s[16:19], s43 offen offset:0 sc1
  ds_read_b64_tr_b16 a[16:17], v11 offset:8192
  ds_read_b64_tr_b16 a[18:19], v11 offset:8704
  v_add_f32 v28, 1.0, v28
  v_add_f32 v29, 1.0, v29
  v_rcp_f32 v26, v26
  v_mfma_f32_32x32x16_bf16 v[48:63], a[4:7], v[164:167], v[48:63]
  v_readlane_b32 s43, v31, 2
  s_nop 0
  s_mul_i32 s43, s43, 5
  s_add_u32 s43, s43, s63
  s_nop 1
  buffer_load_dwordx4 a[76:79], v4, s[16:19], s43 offen offset:0 sc1
  ds_read_b64_tr_b16 a[20:21], v12 offset:8192
  ds_read_b64_tr_b16 a[22:23], v12 offset:8704
  v_rcp_f32 v27, v27
  v_rcp_f32 v28, v28
  s_waitcnt lgkmcnt(4)
  v_mfma_f32_32x32x16_bf16 v[32:47], a[8:11], v[244:247], v[32:47]
  ds_read_b64_tr_b16 a[0:1], v11 offset:9216
  ds_read_b64_tr_b16 a[2:3], v11 offset:9728
  v_rcp_f32 v29, v29
  v_mul_f32 v88, v18, v26
  v_mul_f32 v89, v19, v27
  v_mul_f32 v90, v20, v28
  v_mfma_f32_32x32x16_bf16 v[48:63], a[12:15], v[244:247], v[48:63]
  buffer_load_dwordx4 a[80:83], v4, s[16:19], s43 offen offset:1024 sc1
  ds_read_b64_tr_b16 a[4:5], v12 offset:9216
  ds_read_b64_tr_b16 a[6:7], v12 offset:9728
  v_mul_f32 v91, v21, v29
  v_cvt_pk_bf16_f32 v88, v88, v89
  v_cvt_pk_bf16_f32 v89, v90, v91
  v_fmac_f32 v22, v92, v16
  s_barrier
  s_waitcnt lgkmcnt(4)
  v_mfma_f32_32x32x16_bf16 v[32:47], a[16:19], v[168:171], v[32:47]
  buffer_load_dwordx4 a[84:87], v4, s[16:19], s43 offen offset:2048 sc1
  ds_read_b64_tr_b16 a[8:9], v11 offset:12288
  ds_read_b64_tr_b16 a[10:11], v11 offset:12800
  v_fmac_f32 v23, v93, v16
  v_fmac_f32 v24, v94, v16
  v_fmac_f32 v25, v95, v16
  v_mul_f32 v26, v22, v22
  v_mfma_f32_32x32x16_bf16 v[48:63], a[20:23], v[168:171], v[48:63]
  ds_read_b64_tr_b16 a[12:13], v12 offset:12288
  ds_read_b64_tr_b16 a[14:15], v12 offset:12800
  v_mul_f32 v27, v23, v23
  v_mul_f32 v28, v24, v24
  v_mul_f32 v29, v25, v25
  v_fmaak_f32 v26, v26, v17, 0xc0135761
  s_waitcnt lgkmcnt(4)
  v_mfma_f32_32x32x16_bf16 v[32:47], a[0:3], v[248:251], v[32:47]
  buffer_load_dwordx4 a[88:91], v4, s[16:19], s43 offen offset:3072 sc1
  ds_read_b64_tr_b16 a[16:17], v11 offset:13312
  ds_read_b64_tr_b16 a[18:19], v11 offset:13824
  v_fmaak_f32 v27, v27, v17, 0xc0135761
  v_fmaak_f32 v28, v28, v17, 0xc0135761
  v_fmaak_f32 v29, v29, v17, 0xc0135761
  v_mul_f32 v26, v22, v26
  v_mfma_f32_32x32x16_bf16 v[48:63], a[4:7], v[248:251], v[48:63]
  buffer_load_dwordx4 a[92:95], v5, s[16:19], s43 offen offset:0 sc1
  ds_read_b64_tr_b16 a[20:21], v12 offset:13312
  ds_read_b64_tr_b16 a[22:23], v12 offset:13824
  v_mul_f32 v27, v23, v27
  v_mul_f32 v28, v24, v28
  v_mul_f32 v29, v25, v29
  v_exp_f32 v26, v26
  s_waitcnt lgkmcnt(4)
  v_mfma_f32_32x32x16_bf16 v[32:47], a[8:11], v[172:175], v[32:47]
  ds_read_b64_tr_b16 a[0:1], v11 offset:16384
  ds_read_b64_tr_b16 a[2:3], v11 offset:16896
  v_exp_f32 v27, v27
  v_exp_f32 v28, v28
  v_mfma_f32_32x32x16_bf16 v[48:63], a[12:15], v[172:175], v[48:63]
  v_readlane_b32 s43, v31, 3
  s_nop 0
  s_and_b32 s43, s43, -2
  s_mul_i32 s43, s43, 5
  s_add_u32 s43, s43, s63
  s_nop 0
  buffer_load_dwordx4 a[96:99], v4, s[16:19], s43 offen offset:0 sc1
  ds_read_b64_tr_b16 a[4:5], v12 offset:16384
  ds_read_b64_tr_b16 a[6:7], v12 offset:16896
  v_exp_f32 v29, v29
  v_add_f32 v26, 1.0, v26
  v_add_f32 v27, 1.0, v27
  v_add_f32 v28, 1.0, v28
  s_waitcnt lgkmcnt(4)
  v_mfma_f32_32x32x16_bf16 v[32:47], a[16:19], v[252:255], v[32:47]
  buffer_load_dwordx4 a[100:103], v4, s[16:19], s43 offen offset:1024 sc1
  ds_read_b64_tr_b16 a[8:9], v11 offset:17408
  ds_read_b64_tr_b16 a[10:11], v11 offset:17920
  v_add_f32 v29, 1.0, v29
  v_rcp_f32 v26, v26
  v_mfma_f32_32x32x16_bf16 v[48:63], a[20:23], v[252:255], v[48:63]
  ds_read_b64_tr_b16 a[12:13], v12 offset:17408
  ds_read_b64_tr_b16 a[14:15], v12 offset:17920
  v_rcp_f32 v27, v27
  v_rcp_f32 v28, v28
  v_rcp_f32 v29, v29
  v_mul_f32 v92, v22, v26
  v_mul_f32 v93, v23, v27
  v_mul_f32 v94, v24, v28
  v_mul_f32 v95, v25, v29
  v_cvt_pk_bf16_f32 v90, v92, v93
  v_cvt_pk_bf16_f32 v91, v94, v95
  buffer_store_dwordx4 v[88:91], v15, s[12:15], s45 offen offset:1536 sc1
  s_waitcnt lgkmcnt(4)
  v_mfma_f32_32x32x16_bf16 v[64:79], a[0:3], v[96:99], 0
  buffer_load_dwordx4 a[104:107], v4, s[16:19], s43 offen offset:2048 sc1
  ds_read_b64_tr_b16 a[16:17], v11 offset:20480
  ds_read_b64_tr_b16 a[18:19], v11 offset:20992
  v_mfma_f32_32x32x16_bf16 v[80:95], a[4:7], v[96:99], 0
  buffer_load_dwordx4 a[108:111], v4, s[16:19], s43 offen offset:3072 sc1
  ds_read_b64_tr_b16 a[20:21], v12 offset:20480
  ds_read_b64_tr_b16 a[22:23], v12 offset:20992
  v_add_u32 v30, s50, v10
  ds_read_b128 v[18:21], v30 offset:0
  ds_read_b128 v[22:25], v30 offset:32
  s_waitcnt lgkmcnt(1)
  v_fmac_f32 v18, v32, v16
  v_fmac_f32 v19, v33, v16
  v_mfma_f32_32x32x16_bf16 v[64:79], a[8:11], v[176:179], v[64:79]
  ds_read_b64_tr_b16 a[0:1], v11 offset:21504
  ds_read_b64_tr_b16 a[2:3], v11 offset:22016
  v_fmac_f32 v20, v34, v16
  v_fmac_f32 v21, v35, v16
  v_mul_f32 v26, v18, v18
  v_mul_f32 v27, v19, v19
  v_mfma_f32_32x32x16_bf16 v[80:95], a[12:15], v[176:179], v[80:95]
  buffer_load_dwordx4 a[112:115], v5, s[16:19], s43 offen offset:0 sc1
  ds_read_b64_tr_b16 a[4:5], v12 offset:21504
  ds_read_b64_tr_b16 a[6:7], v12 offset:22016
  v_mul_f32 v28, v20, v20
  v_mul_f32 v29, v21, v21
  v_fmaak_f32 v26, v26, v17, 0xc0135761
  v_fmaak_f32 v27, v27, v17, 0xc0135761
  v_mfma_f32_32x32x16_bf16 v[64:79], a[16:19], v[100:103], v[64:79]
  v_readlane_b32 s43, v31, 4
  s_nop 0
  s_mul_i32 s43, s43, 5
  s_add_u32 s43, s43, s63
  s_nop 1
  buffer_load_dwordx4 a[116:119], v4, s[16:19], s43 offen offset:0 sc1
  ds_read_b64_tr_b16 a[8:9], v11 offset:24576
  ds_read_b64_tr_b16 a[10:11], v11 offset:25088
  v_fmaak_f32 v28, v28, v17, 0xc0135761
  v_fmaak_f32 v29, v29, v17, 0xc0135761
  v_mul_f32 v26, v18, v26
  v_mul_f32 v27, v19, v27
  v_mfma_f32_32x32x16_bf16 v[80:95], a[20:23], v[100:103], v[80:95]
  ds_read_b64_tr_b16 a[12:13], v12 offset:24576
  ds_read_b64_tr_b16 a[14:15], v12 offset:25088
  v_mul_f32 v28, v20, v28
  v_mul_f32 v29, v21, v29
  v_exp_f32 v26, v26
  s_waitcnt lgkmcnt(4)
  v_mfma_f32_32x32x16_bf16 v[64:79], a[0:3], v[180:183], v[64:79]
  buffer_load_dwordx4 a[120:123], v4, s[16:19], s43 offen offset:1024 sc1
  ds_read_b64_tr_b16 a[16:17], v11 offset:25600
  ds_read_b64_tr_b16 a[18:19], v11 offset:26112
  v_exp_f32 v27, v27
  v_exp_f32 v28, v28
  v_mfma_f32_32x32x16_bf16 v[80:95], a[4:7], v[180:183], v[80:95]
  buffer_load_dwordx4 a[124:127], v4, s[16:19], s43 offen offset:2048 sc1
  ds_read_b64_tr_b16 a[20:21], v12 offset:25600
  ds_read_b64_tr_b16 a[22:23], v12 offset:26112
  v_exp_f32 v29, v29
  v_add_f32 v26, 1.0, v26
  v_add_f32 v27, 1.0, v27
  v_add_f32 v28, 1.0, v28
  s_barrier
  s_waitcnt lgkmcnt(4)
  v_mfma_f32_32x32x16_bf16 v[64:79], a[8:11], v[104:107], v[64:79]
  ds_read_b64_tr_b16 a[0:1], v11 offset:28672
  ds_read_b64_tr_b16 a[2:3], v11 offset:29184
  v_add_f32 v29, 1.0, v29
  v_rcp_f32 v26, v26
  v_rcp_f32 v27, v27
  v_mfma_f32_32x32x16_bf16 v[80:95], a[12:15], v[104:107], v[80:95]
  buffer_load_dwordx4 a[128:131], v4, s[16:19], s43 offen offset:3072 sc1
  ds_read_b64_tr_b16 a[4:5], v12 offset:28672
  ds_read_b64_tr_b16 a[6:7], v12 offset:29184
  v_rcp_f32 v28, v28
  v_rcp_f32 v29, v29
  s_waitcnt lgkmcnt(4)
  v_mfma_f32_32x32x16_bf16 v[64:79], a[16:19], v[184:187], v[64:79]
  buffer_load_dwordx4 a[132:135], v5, s[16:19], s43 offen offset:0 sc1
  ds_read_b64_tr_b16 a[8:9], v11 offset:29696
  ds_read_b64_tr_b16 a[10:11], v11 offset:30208
  v_mul_f32 v32, v18, v26
  v_mul_f32 v33, v19, v27
  v_mul_f32 v34, v20, v28
  v_mul_f32 v35, v21, v29
  ds_read_b128 v[18:21], v30 offset:64
  v_mfma_f32_32x32x16_bf16 v[80:95], a[20:23], v[184:187], v[80:95]
  ds_read_b64_tr_b16 a[12:13], v12 offset:29696
  ds_read_b64_tr_b16 a[14:15], v12 offset:30208
  v_cvt_pk_bf16_f32 v32, v32, v33
  v_cvt_pk_bf16_f32 v33, v34, v35
  v_fmac_f32 v22, v36, v16
  v_fmac_f32 v23, v37, v16
  s_waitcnt lgkmcnt(5)
  v_mfma_f32_32x32x16_bf16 v[64:79], a[0:3], v[108:111], v[64:79]
  v_readlane_b32 s43, v31, 5
  s_nop 0
  s_mul_i32 s43, s43, 5
  s_add_u32 s43, s43, s63
  s_nop 1
  buffer_load_dwordx4 a[136:139], v4, s[16:19], s43 offen offset:0 sc1
  ds_read_b64_tr_b16 a[16:17], v11 offset:32768
  ds_read_b64_tr_b16 a[18:19], v11 offset:33280
  v_fmac_f32 v24, v38, v16
  v_fmac_f32 v25, v39, v16
  v_mul_f32 v26, v22, v22
  v_mul_f32 v27, v23, v23
  v_mfma_f32_32x32x16_bf16 v[80:95], a[4:7], v[108:111], v[80:95]
  buffer_load_dwordx4 a[140:143], v4, s[16:19], s43 offen offset:1024 sc1
  ds_read_b64_tr_b16 a[20:21], v12 offset:32768
  ds_read_b64_tr_b16 a[22:23], v12 offset:33280
  v_mul_f32 v28, v24, v24
  v_mul_f32 v29, v25, v25
  v_fmaak_f32 v26, v26, v17, 0xc0135761
  v_fmaak_f32 v27, v27, v17, 0xc0135761
  s_waitcnt lgkmcnt(4)
  v_mfma_f32_32x32x16_bf16 v[64:79], a[8:11], v[188:191], v[64:79]
  ds_read_b64_tr_b16 a[0:1], v11 offset:33792
  ds_read_b64_tr_b16 a[2:3], v11 offset:34304
  v_fmaak_f32 v28, v28, v17, 0xc0135761
  v_fmaak_f32 v29, v29, v17, 0xc0135761
  v_mul_f32 v26, v22, v26
  v_mul_f32 v27, v23, v27
  v_mfma_f32_32x32x16_bf16 v[80:95], a[12:15], v[188:191], v[80:95]
  buffer_load_dwordx4 a[144:147], v4, s[16:19], s43 offen offset:2048 sc1
  ds_read_b64_tr_b16 a[4:5], v12 offset:33792
  ds_read_b64_tr_b16 a[6:7], v12 offset:34304
  v_mul_f32 v28, v24, v28
  v_mul_f32 v29, v25, v29
  v_exp_f32 v26, v26
  s_waitcnt lgkmcnt(4)
  v_mfma_f32_32x32x16_bf16 v[64:79], a[16:19], v[112:115], v[64:79]
  buffer_load_dwordx4 a[148:151], v4, s[16:19], s43 offen offset:3072 sc1
  ds_read_b64_tr_b16 a[8:9], v11 offset:36864
  ds_read_b64_tr_b16 a[10:11], v11 offset:37376
  v_exp_f32 v27, v27
  v_exp_f32 v28, v28
  v_mfma_f32_32x32x16_bf16 v[80:95], a[20:23], v[112:115], v[80:95]
  ds_read_b64_tr_b16 a[12:13], v12 offset:36864
  ds_read_b64_tr_b16 a[14:15], v12 offset:37376
  v_exp_f32 v29, v29
  v_add_f32 v26, 1.0, v26
  v_add_f32 v27, 1.0, v27
  v_add_f32 v28, 1.0, v28
  s_waitcnt lgkmcnt(4)
  v_mfma_f32_32x32x16_bf16 v[64:79], a[0:3], v[192:195], v[64:79]
  buffer_load_dwordx4 a[152:155], v5, s[16:19], s43 offen offset:0 sc1
  ds_read_b64_tr_b16 a[16:17], v11 offset:37888
  ds_read_b64_tr_b16 a[18:19], v11 offset:38400
  v_add_f32 v29, 1.0, v29
  v_rcp_f32 v26, v26
  v_rcp_f32 v27, v27
  v_mfma_f32_32x32x16_bf16 v[80:95], a[4:7], v[192:195], v[80:95]
  v_readlane_b32 s43, v31, 6
  s_nop 0
  s_and_b32 s43, s43, -2
  s_mul_i32 s43, s43, 5
  s_add_u32 s43, s43, s63
  s_nop 0
  buffer_load_dwordx4 a[156:159], v4, s[16:19], s43 offen offset:0 sc1
  ds_read_b64_tr_b16 a[20:21], v12 offset:37888
  ds_read_b64_tr_b16 a[22:23], v12 offset:38400
  v_rcp_f32 v28, v28
  v_rcp_f32 v29, v29
  s_waitcnt lgkmcnt(4)
  v_mfma_f32_32x32x16_bf16 v[64:79], a[8:11], v[116:119], v[64:79]
  ds_read_b64_tr_b16 a[0:1], v11 offset:40960
  ds_read_b64_tr_b16 a[2:3], v11 offset:41472
  v_mul_f32 v36, v22, v26
  v_mul_f32 v37, v23, v27
  v_mul_f32 v38, v24, v28
  v_mul_f32 v39, v25, v29
  ds_read_b128 v[22:25], v30 offset:96
  v_mfma_f32_32x32x16_bf16 v[80:95], a[12:15], v[116:119], v[80:95]
  buffer_load_dwordx4 a[160:163], v4, s[16:19], s43 offen offset:1024 sc1
  ds_read_b64_tr_b16 a[4:5], v12 offset:40960
  ds_read_b64_tr_b16 a[6:7], v12 offset:41472
  v_cvt_pk_bf16_f32 v34, v36, v37
  v_cvt_pk_bf16_f32 v35, v38, v39
  buffer_store_dwordx4 v[32:35], v15, s[12:15], s46 offen offset:0 sc1
  v_fmac_f32 v18, v40, v16
  v_fmac_f32 v19, v41, v16
  s_waitcnt lgkmcnt(5)
  v_mfma_f32_32x32x16_bf16 v[64:79], a[16:19], v[196:199], v[64:79]
  buffer_load_dwordx4 a[164:167], v4, s[16:19], s43 offen offset:2048 sc1
  ds_read_b64_tr_b16 a[8:9], v11 offset:41984
  ds_read_b64_tr_b16 a[10:11], v11 offset:42496
  v_fmac_f32 v20, v42, v16
  v_fmac_f32 v21, v43, v16
  v_mul_f32 v26, v18, v18
  v_mul_f32 v27, v19, v19
  v_mfma_f32_32x32x16_bf16 v[80:95], a[20:23], v[196:199], v[80:95]
  ds_read_b64_tr_b16 a[12:13], v12 offset:41984
  ds_read_b64_tr_b16 a[14:15], v12 offset:42496
  v_mul_f32 v28, v20, v20
  v_mul_f32 v29, v21, v21
  v_fmaak_f32 v26, v26, v17, 0xc0135761
  v_fmaak_f32 v27, v27, v17, 0xc0135761
  s_waitcnt vmcnt(17)
  s_barrier
  s_lshl_b32 s73, s21, 3
  s_add_u32 s73, s73, s25
  s_lshl_b32 s73, s73, 10
  s_lshl_b32 s74, s24, 7
  s_add_u32 s73, s73, s74
  v_accvgpr_read_b32 v3, a35
  v_mov_b32 v2, 0x40000000
  v_cmp_eq_u32 vcc, 0, v1
  v_readlane_b32 s72, v3, 24
  s_cmp_eq_u32 s20, 0
  s_cselect_b32 s73, s73, 0x40000000
  v_mov_b32 v3, s73
  v_cndmask_b32 v2, v2, v3, vcc
  s_add_u32 s72, s72, 1
  v_mov_b32 v3, s72
  buffer_store_dword v3, v2, s[56:59], 0 offen sc1
  s_waitcnt lgkmcnt(4)
  v_mfma_f32_32x32x16_bf16 v[64:79], a[0:3], v[120:123], v[64:79]
  buffer_load_dwordx4 a[168:171], v4, s[16:19], s43 offen offset:3072 sc1
  ds_read_b64_tr_b16 a[16:17], v11 offset:45056
  ds_read_b64_tr_b16 a[18:19], v11 offset:45568
  v_fmaak_f32 v28, v28, v17, 0xc0135761
  v_fmaak_f32 v29, v29, v17, 0xc0135761
  v_mul_f32 v26, v18, v26
  v_mul_f32 v27, v19, v27
  v_mfma_f32_32x32x16_bf16 v[80:95], a[4:7], v[120:123], v[80:95]
  buffer_load_dwordx4 a[172:175], v5, s[16:19], s43 offen offset:0 sc1
  ds_read_b64_tr_b16 a[20:21], v12 offset:45056
  ds_read_b64_tr_b16 a[22:23], v12 offset:45568
  v_mul_f32 v28, v20, v28
  v_mul_f32 v29, v21, v29
  v_exp_f32 v26, v26
  s_waitcnt lgkmcnt(4)
  v_mfma_f32_32x32x16_bf16 v[64:79], a[8:11], v[200:203], v[64:79]
  ds_read_b64_tr_b16 a[0:1], v11 offset:46080
  ds_read_b64_tr_b16 a[2:3], v11 offset:46592
  v_exp_f32 v27, v27
  v_exp_f32 v28, v28
  v_mfma_f32_32x32x16_bf16 v[80:95], a[12:15], v[200:203], v[80:95]
  v_readlane_b32 s43, v31, 7
  s_nop 0
  s_mul_i32 s43, s43, 5
  s_add_u32 s43, s43, s63
  s_nop 1
  buffer_load_dwordx4 a[176:179], v4, s[16:19], s43 offen offset:0 sc1
  ds_read_b64_tr_b16 a[4:5], v12 offset:46080
  ds_read_b64_tr_b16 a[6:7], v12 offset:46592
  v_exp_f32 v29, v29
  v_add_f32 v26, 1.0, v26
  v_add_f32 v27, 1.0, v27
  v_add_f32 v28, 1.0, v28
  s_waitcnt lgkmcnt(4)
  v_mfma_f32_32x32x16_bf16 v[64:79], a[16:19], v[124:127], v[64:79]
  buffer_load_dwordx4 a[180:183], v4, s[16:19], s43 offen offset:1024 sc1
  ds_read_b64_tr_b16 a[8:9], v11 offset:49152
  ds_read_b64_tr_b16 a[10:11], v11 offset:49664
  v_add_f32 v29, 1.0, v29
  v_rcp_f32 v26, v26
  v_mfma_f32_32x32x16_bf16 v[80:95], a[20:23], v[124:127], v[80:95]
  ds_read_b64_tr_b16 a[12:13], v12 offset:49152
  ds_read_b64_tr_b16 a[14:15], v12 offset:49664
  v_rcp_f32 v27, v27
  v_rcp_f32 v28, v28
  v_rcp_f32 v29, v29
  s_waitcnt lgkmcnt(4)
  v_mfma_f32_32x32x16_bf16 v[64:79], a[0:3], v[204:207], v[64:79]
  buffer_load_dwordx4 a[184:187], v4, s[16:19], s43 offen offset:2048 sc1
  ds_read_b64_tr_b16 a[16:17], v11 offset:50176
  ds_read_b64_tr_b16 a[18:19], v11 offset:50688
  v_mul_f32 v40, v18, v26
  v_mul_f32 v41, v19, v27
  v_mul_f32 v42, v20, v28
  v_mul_f32 v43, v21, v29
  ds_read_b128 v[18:21], v30 offset:128
  v_mfma_f32_32x32x16_bf16 v[80:95], a[4:7], v[204:207], v[80:95]
  buffer_load_dwordx4 a[188:191], v4, s[16:19], s43 offen offset:3072 sc1
  ds_read_b64_tr_b16 a[20:21], v12 offset:50176
  ds_read_b64_tr_b16 a[22:23], v12 offset:50688
  v_cvt_pk_bf16_f32 v40, v40, v41
  v_cvt_pk_bf16_f32 v41, v42, v43
  v_fmac_f32 v22, v44, v16
  v_fmac_f32 v23, v45, v16
  s_waitcnt lgkmcnt(5)
  v_mfma_f32_32x32x16_bf16 v[64:79], a[8:11], v[128:131], v[64:79]
  ds_read_b64_tr_b16 a[0:1], v11 offset:53248
  ds_read_b64_tr_b16 a[2:3], v11 offset:53760
  v_fmac_f32 v24, v46, v16
  v_fmac_f32 v25, v47, v16
  v_mul_f32 v26, v22, v22
  v_mul_f32 v27, v23, v23
  v_mfma_f32_32x32x16_bf16 v[80:95], a[12:15], v[128:131], v[80:95]
  buffer_load_dwordx4 a[192:195], v5, s[16:19], s43 offen offset:0 sc1
  ds_read_b64_tr_b16 a[4:5], v12 offset:53248
  ds_read_b64_tr_b16 a[6:7], v12 offset:53760
  v_mul_f32 v28, v24, v24
  v_mul_f32 v29, v25, v25
  v_fmaak_f32 v26, v26, v17, 0xc0135761
  v_fmaak_f32 v27, v27, v17, 0xc0135761
  s_waitcnt lgkmcnt(4)
  v_mfma_f32_32x32x16_bf16 v[64:79], a[16:19], v[208:211], v[64:79]
  v_readlane_b32 s43, v31, 8
  s_nop 0
  s_mul_i32 s43, s43, 5
  s_add_u32 s43, s43, s63
  s_nop 1
  buffer_load_dwordx4 a[196:199], v4, s[16:19], s43 offen offset:0 sc1
  ds_read_b64_tr_b16 a[8:9], v11 offset:54272
  ds_read_b64_tr_b16 a[10:11], v11 offset:54784
  v_fmaak_f32 v28, v28, v17, 0xc0135761
  v_fmaak_f32 v29, v29, v17, 0xc0135761
  v_mul_f32 v26, v22, v26
  v_mul_f32 v27, v23, v27
  v_mfma_f32_32x32x16_bf16 v[80:95], a[20:23], v[208:211], v[80:95]
  ds_read_b64_tr_b16 a[12:13], v12 offset:54272
  ds_read_b64_tr_b16 a[14:15], v12 offset:54784
  v_mul_f32 v28, v24, v28
  v_mul_f32 v29, v25, v29
  v_exp_f32 v26, v26
  s_waitcnt lgkmcnt(4)
  v_mfma_f32_32x32x16_bf16 v[64:79], a[0:3], v[132:135], v[64:79]
  buffer_load_dwordx4 a[200:203], v4, s[16:19], s43 offen offset:1024 sc1
  ds_read_b64_tr_b16 a[16:17], v11 offset:57344
  ds_read_b64_tr_b16 a[18:19], v11 offset:57856
  v_exp_f32 v27, v27
  v_exp_f32 v28, v28
  v_mfma_f32_32x32x16_bf16 v[80:95], a[4:7], v[132:135], v[80:95]
  buffer_load_dwordx4 a[204:207], v4, s[16:19], s43 offen offset:2048 sc1
  ds_read_b64_tr_b16 a[20:21], v12 offset:57344
  ds_read_b64_tr_b16 a[22:23], v12 offset:57856
  v_exp_f32 v29, v29
  v_add_f32 v26, 1.0, v26
  v_add_f32 v27, 1.0, v27
  v_add_f32 v28, 1.0, v28
  s_waitcnt lgkmcnt(4)
  v_mfma_f32_32x32x16_bf16 v[64:79], a[8:11], v[212:215], v[64:79]
  ds_read_b64_tr_b16 a[0:1], v11 offset:58368
  ds_read_b64_tr_b16 a[2:3], v11 offset:58880
  v_add_f32 v29, 1.0, v29
  v_rcp_f32 v26, v26
  v_mfma_f32_32x32x16_bf16 v[80:95], a[12:15], v[212:215], v[80:95]
  buffer_load_dwordx4 a[208:211], v4, s[16:19], s43 offen offset:3072 sc1
  ds_read_b64_tr_b16 a[4:5], v12 offset:58368
  ds_read_b64_tr_b16 a[6:7], v12 offset:58880
  v_rcp_f32 v27, v27
  v_rcp_f32 v28, v28
  v_rcp_f32 v29, v29
  s_barrier
  s_waitcnt lgkmcnt(4)
  v_mfma_f32_32x32x16_bf16 v[64:79], a[16:19], v[136:139], v[64:79]
  buffer_load_dwordx4 a[212:215], v5, s[16:19], s43 offen offset:0 sc1
  ds_read_b64_tr_b16 a[8:9], v11 offset:61440
  ds_read_b64_tr_b16 a[10:11], v11 offset:61952
  v_mul_f32 v44, v22, v26
  v_mul_f32 v45, v23, v27
  v_mul_f32 v46, v24, v28
  v_mul_f32 v47, v25, v29
  ds_read_b128 v[22:25], v30 offset:160
  v_mfma_f32_32x32x16_bf16 v[80:95], a[20:23], v[136:139], v[80:95]
  ds_read_b64_tr_b16 a[12:13], v12 offset:61440
  ds_read_b64_tr_b16 a[14:15], v12 offset:61952
  v_cvt_pk_bf16_f32 v42, v44, v45
  v_cvt_pk_bf16_f32 v43, v46, v47
  buffer_store_dwordx4 v[40:43], v15, s[12:15], s46 offen offset:512 sc1
  v_fmac_f32 v18, v48, v16
  s_waitcnt lgkmcnt(5)
  v_mfma_f32_32x32x16_bf16 v[64:79], a[0:3], v[216:219], v[64:79]
  v_readlane_b32 s43, v31, 9
  s_nop 0
  s_mul_i32 s43, s43, 5
  s_add_u32 s43, s43, s63
  s_nop 1
  buffer_load_dwordx4 a[216:219], v4, s[16:19], s43 offen offset:0 sc1
  ds_read_b64_tr_b16 a[16:17], v11 offset:62464
  ds_read_b64_tr_b16 a[18:19], v11 offset:62976
  v_fmac_f32 v19, v49, v16
  v_fmac_f32 v20, v50, v16
  v_fmac_f32 v21, v51, v16
  v_mul_f32 v26, v18, v18
  v_mfma_f32_32x32x16_bf16 v[80:95], a[4:7], v[216:219], v[80:95]
  buffer_load_dwordx4 a[220:223], v4, s[16:19], s43 offen offset:1024 sc1
  ds_read_b64_tr_b16 a[20:21], v12 offset:62464
  ds_read_b64_tr_b16 a[22:23], v12 offset:62976
  v_mul_f32 v27, v19, v19
  v_mul_f32 v28, v20, v20
  v_mul_f32 v29, v21, v21
  v_fmaak_f32 v26, v26, v17, 0xc0135761
  s_waitcnt lgkmcnt(4)
  v_mfma_f32_32x32x16_bf16 v[64:79], a[8:11], v[140:143], v[64:79]
  ds_read_b64_tr_b16 a[0:1], v13 offset:0
  ds_read_b64_tr_b16 a[2:3], v13 offset:512
  v_fmaak_f32 v27, v27, v17, 0xc0135761
  v_fmaak_f32 v28, v28, v17, 0xc0135761
  v_fmaak_f32 v29, v29, v17, 0xc0135761
  v_mul_f32 v26, v18, v26
  v_mfma_f32_32x32x16_bf16 v[80:95], a[12:15], v[140:143], v[80:95]
  buffer_load_dwordx4 a[224:227], v4, s[16:19], s43 offen offset:2048 sc1
  ds_read_b64_tr_b16 a[4:5], v14 offset:0
  ds_read_b64_tr_b16 a[6:7], v14 offset:512
  v_mul_f32 v27, v19, v27
  v_mul_f32 v28, v20, v28
  v_mul_f32 v29, v21, v29
  v_exp_f32 v26, v26
  s_waitcnt lgkmcnt(4)
  v_mfma_f32_32x32x16_bf16 v[64:79], a[16:19], v[220:223], v[64:79]
  buffer_load_dwordx4 a[228:231], v4, s[16:19], s43 offen offset:3072 sc1
  ds_read_b64_tr_b16 a[8:9], v13 offset:1024
  ds_read_b64_tr_b16 a[10:11], v13 offset:1536
  v_exp_f32 v27, v27
  v_exp_f32 v28, v28
  v_mfma_f32_32x32x16_bf16 v[80:95], a[20:23], v[220:223], v[80:95]
  ds_read_b64_tr_b16 a[12:13], v14 offset:1024
  ds_read_b64_tr_b16 a[14:15], v14 offset:1536
  v_exp_f32 v29, v29
  v_add_f32 v26, 1.0, v26
  v_add_f32 v27, 1.0, v27
  v_add_f32 v28, 1.0, v28
  s_waitcnt lgkmcnt(4)
  v_mfma_f32_32x32x16_bf16 v[64:79], a[0:3], v[144:147], v[64:79]
  buffer_load_dwordx4 a[232:235], v5, s[16:19], s43 offen offset:0 sc1
  ds_read_b64_tr_b16 a[16:17], v13 offset:4096
  ds_read_b64_tr_b16 a[18:19], v13 offset:4608
  v_add_f32 v29, 1.0, v29
  v_rcp_f32 v26, v26
  v_mfma_f32_32x32x16_bf16 v[80:95], a[4:7], v[144:147], v[80:95]
  v_readlane_b32 s43, v31, 10
  s_nop 0
  s_mul_i32 s43, s43, 5
  s_add_u32 s43, s43, s63
  s_nop 1
  buffer_load_dwordx4 a[236:239], v4, s[16:19], s43 offen offset:0 sc1
  ds_read_b64_tr_b16 a[20:21], v14 offset:4096
  ds_read_b64_tr_b16 a[22:23], v14 offset:4608
  v_rcp_f32 v27, v27
  v_rcp_f32 v28, v28
  s_waitcnt lgkmcnt(4)
  v_mfma_f32_32x32x16_bf16 v[64:79], a[8:11], v[224:227], v[64:79]
  ds_read_b64_tr_b16 a[0:1], v13 offset:5120
  ds_read_b64_tr_b16 a[2:3], v13 offset:5632
  v_rcp_f32 v29, v29
  v_mul_f32 v48, v18, v26
  v_mul_f32 v49, v19, v27
  v_mul_f32 v50, v20, v28
  v_mul_f32 v51, v21, v29
  v_mfma_f32_32x32x16_bf16 v[80:95], a[12:15], v[224:227], v[80:95]
  buffer_load_dwordx4 a[240:243], v4, s[16:19], s43 offen offset:1024 sc1
  ds_read_b64_tr_b16 a[4:5], v14 offset:5120
  ds_read_b64_tr_b16 a[6:7], v14 offset:5632
  ds_read_b128 v[18:21], v30 offset:192
  v_cvt_pk_bf16_f32 v48, v48, v49
  v_cvt_pk_bf16_f32 v49, v50, v51
  v_fmac_f32 v22, v52, v16
  s_waitcnt lgkmcnt(5)
  v_mfma_f32_32x32x16_bf16 v[64:79], a[16:19], v[148:151], v[64:79]
  buffer_load_dwordx4 a[244:247], v4, s[16:19], s43 offen offset:2048 sc1
  ds_read_b64_tr_b16 a[8:9], v13 offset:8192
  ds_read_b64_tr_b16 a[10:11], v13 offset:8704
  v_fmac_f32 v23, v53, v16
  v_fmac_f32 v24, v54, v16
  v_fmac_f32 v25, v55, v16
  v_mul_f32 v26, v22, v22
  v_mfma_f32_32x32x16_bf16 v[80:95], a[20:23], v[148:151], v[80:95]
  ds_read_b64_tr_b16 a[12:13], v14 offset:8192
  ds_read_b64_tr_b16 a[14:15], v14 offset:8704
  v_mul_f32 v27, v23, v23
  v_mul_f32 v28, v24, v24
  v_mul_f32 v29, v25, v25
  v_fmaak_f32 v26, v26, v17, 0xc0135761
  s_waitcnt lgkmcnt(5)
  v_mfma_f32_32x32x16_bf16 v[64:79], a[0:3], v[228:231], v[64:79]
  buffer_load_dwordx4 a[248:251], v4, s[16:19], s43 offen offset:3072 sc1
  ds_read_b64_tr_b16 a[16:17], v13 offset:9216
  ds_read_b64_tr_b16 a[18:19], v13 offset:9728
  v_fmaak_f32 v27, v27, v17, 0xc0135761
  v_fmaak_f32 v28, v28, v17, 0xc0135761
  v_fmaak_f32 v29, v29, v17, 0xc0135761
  v_mul_f32 v26, v22, v26
  v_mfma_f32_32x32x16_bf16 v[80:95], a[4:7], v[228:231], v[80:95]
  buffer_load_dwordx4 a[252:255], v5, s[16:19], s43 offen offset:0 sc1
  ds_read_b64_tr_b16 a[20:21], v14 offset:9216
  ds_read_b64_tr_b16 a[22:23], v14 offset:9728
  v_mul_f32 v27, v23, v27
  v_mul_f32 v28, v24, v28
  v_mul_f32 v29, v25, v29
  v_exp_f32 v26, v26
  s_barrier
  s_waitcnt lgkmcnt(4)
  v_mfma_f32_32x32x16_bf16 v[64:79], a[8:11], v[152:155], v[64:79]
  ds_read_b64_tr_b16 a[0:1], v13 offset:12288
  ds_read_b64_tr_b16 a[2:3], v13 offset:12800
  v_exp_f32 v27, v27
  v_exp_f32 v28, v28
  v_mfma_f32_32x32x16_bf16 v[80:95], a[12:15], v[152:155], v[80:95]
  ds_read_b64_tr_b16 a[4:5], v14 offset:12288
  ds_read_b64_tr_b16 a[6:7], v14 offset:12800
  v_exp_f32 v29, v29
  v_add_f32 v26, 1.0, v26
  v_add_f32 v27, 1.0, v27
  v_add_f32 v28, 1.0, v28
  s_waitcnt lgkmcnt(4)
  v_mfma_f32_32x32x16_bf16 v[64:79], a[16:19], v[232:235], v[64:79]
  ds_read_b64_tr_b16 a[8:9], v13 offset:13312
  ds_read_b64_tr_b16 a[10:11], v13 offset:13824
  v_add_f32 v29, 1.0, v29
  v_rcp_f32 v26, v26
  v_mfma_f32_32x32x16_bf16 v[80:95], a[20:23], v[232:235], v[80:95]
  ds_read_b64_tr_b16 a[12:13], v14 offset:13312
  ds_read_b64_tr_b16 a[14:15], v14 offset:13824
  v_rcp_f32 v27, v27
  v_rcp_f32 v28, v28
  s_waitcnt lgkmcnt(4)
  v_mfma_f32_32x32x16_bf16 v[64:79], a[0:3], v[156:159], v[64:79]
  ds_read_b64_tr_b16 a[16:17], v13 offset:16384
  ds_read_b64_tr_b16 a[18:19], v13 offset:16896
  v_rcp_f32 v29, v29
  v_mul_f32 v52, v22, v26
  v_mul_f32 v53, v23, v27
  v_mul_f32 v54, v24, v28
  v_mul_f32 v55, v25, v29
  ds_read_b128 v[22:25], v30 offset:224
  v_mfma_f32_32x32x16_bf16 v[80:95], a[4:7], v[156:159], v[80:95]
  ds_read_b64_tr_b16 a[20:21], v14 offset:16384
  ds_read_b64_tr_b16 a[22:23], v14 offset:16896
  v_cvt_pk_bf16_f32 v50, v52, v53
  v_cvt_pk_bf16_f32 v51, v54, v55
  buffer_store_dwordx4 v[48:51], v15, s[12:15], s46 offen offset:1024 sc1
  v_fmac_f32 v18, v56, v16
  s_waitcnt lgkmcnt(5)
  v_mfma_f32_32x32x16_bf16 v[64:79], a[8:11], v[236:239], v[64:79]
  ds_read_b64_tr_b16 a[0:1], v13 offset:17408
  ds_read_b64_tr_b16 a[2:3], v13 offset:17920
  v_fmac_f32 v19, v57, v16
  v_fmac_f32 v20, v58, v16
  v_fmac_f32 v21, v59, v16
  v_mul_f32 v26, v18, v18
  v_mfma_f32_32x32x16_bf16 v[80:95], a[12:15], v[236:239], v[80:95]
  ds_read_b64_tr_b16 a[4:5], v14 offset:17408
  ds_read_b64_tr_b16 a[6:7], v14 offset:17920
  v_mul_f32 v27, v19, v19
  v_mul_f32 v28, v20, v20
  v_mul_f32 v29, v21, v21
  v_fmaak_f32 v26, v26, v17, 0xc0135761
  s_waitcnt lgkmcnt(4)
  v_mfma_f32_32x32x16_bf16 v[64:79], a[16:19], v[160:163], v[64:79]
  ds_read_b64_tr_b16 a[8:9], v13 offset:20480
  ds_read_b64_tr_b16 a[10:11], v13 offset:20992
  v_fmaak_f32 v27, v27, v17, 0xc0135761
  v_fmaak_f32 v28, v28, v17, 0xc0135761
  v_fmaak_f32 v29, v29, v17, 0xc0135761
  v_mul_f32 v26, v18, v26
  v_mfma_f32_32x32x16_bf16 v[80:95], a[20:23], v[160:163], v[80:95]
  ds_read_b64_tr_b16 a[12:13], v14 offset:20480
  ds_read_b64_tr_b16 a[14:15], v14 offset:20992
  v_mul_f32 v27, v19, v27
  v_mul_f32 v28, v20, v28
  v_mul_f32 v29, v21, v29
  s_waitcnt lgkmcnt(4)
  v_mfma_f32_32x32x16_bf16 v[64:79], a[0:3], v[240:243], v[64:79]
  ds_read_b64_tr_b16 a[16:17], v13 offset:21504
  ds_read_b64_tr_b16 a[18:19], v13 offset:22016
  v_exp_f32 v26, v26
  v_exp_f32 v27, v27
  v_exp_f32 v28, v28
  v_mfma_f32_32x32x16_bf16 v[80:95], a[4:7], v[240:243], v[80:95]
  ds_read_b64_tr_b16 a[20:21], v14 offset:21504
  ds_read_b64_tr_b16 a[22:23], v14 offset:22016
  v_exp_f32 v29, v29
  v_add_f32 v26, 1.0, v26
  v_add_f32 v27, 1.0, v27
  s_waitcnt lgkmcnt(4)
  v_mfma_f32_32x32x16_bf16 v[64:79], a[8:11], v[164:167], v[64:79]
  ds_read_b64_tr_b16 a[0:1], v13 offset:24576
  ds_read_b64_tr_b16 a[2:3], v13 offset:25088
  v_add_f32 v28, 1.0, v28
  v_add_f32 v29, 1.0, v29
  v_rcp_f32 v26, v26
  v_mfma_f32_32x32x16_bf16 v[80:95], a[12:15], v[164:167], v[80:95]
  ds_read_b64_tr_b16 a[4:5], v14 offset:24576
  ds_read_b64_tr_b16 a[6:7], v14 offset:25088
  v_rcp_f32 v27, v27
  v_rcp_f32 v28, v28
  s_waitcnt lgkmcnt(4)
  v_mfma_f32_32x32x16_bf16 v[64:79], a[16:19], v[244:247], v[64:79]
  ds_read_b64_tr_b16 a[8:9], v13 offset:25600
  ds_read_b64_tr_b16 a[10:11], v13 offset:26112
  v_rcp_f32 v29, v29
  v_mul_f32 v56, v18, v26
  v_mul_f32 v57, v19, v27
  v_mul_f32 v58, v20, v28
  v_mfma_f32_32x32x16_bf16 v[80:95], a[20:23], v[244:247], v[80:95]
  ds_read_b64_tr_b16 a[12:13], v14 offset:25600
  ds_read_b64_tr_b16 a[14:15], v14 offset:26112
  v_mul_f32 v59, v21, v29
  v_cvt_pk_bf16_f32 v56, v56, v57
  v_cvt_pk_bf16_f32 v57, v58, v59
  v_fmac_f32 v22, v60, v16
  s_waitcnt lgkmcnt(4)
  v_mfma_f32_32x32x16_bf16 v[64:79], a[0:3], v[168:171], v[64:79]
  ds_read_b64_tr_b16 a[16:17], v13 offset:28672
  ds_read_b64_tr_b16 a[18:19], v13 offset:29184
  v_fmac_f32 v23, v61, v16
  v_fmac_f32 v24, v62, v16
  v_fmac_f32 v25, v63, v16
  v_mul_f32 v26, v22, v22
  v_mfma_f32_32x32x16_bf16 v[80:95], a[4:7], v[168:171], v[80:95]
  ds_read_b64_tr_b16 a[20:21], v14 offset:28672
  ds_read_b64_tr_b16 a[22:23], v14 offset:29184
  v_mul_f32 v27, v23, v23
  v_mul_f32 v28, v24, v24
  v_mul_f32 v29, v25, v25
  v_fmaak_f32 v26, v26, v17, 0xc0135761
  s_waitcnt lgkmcnt(4)
  v_mfma_f32_32x32x16_bf16 v[64:79], a[8:11], v[248:251], v[64:79]
  ds_read_b64_tr_b16 a[0:1], v13 offset:29696
  ds_read_b64_tr_b16 a[2:3], v13 offset:30208
  v_fmaak_f32 v27, v27, v17, 0xc0135761
  v_fmaak_f32 v28, v28, v17, 0xc0135761
  v_fmaak_f32 v29, v29, v17, 0xc0135761
  v_mul_f32 v26, v22, v26
  v_mfma_f32_32x32x16_bf16 v[80:95], a[12:15], v[248:251], v[80:95]
  ds_read_b64_tr_b16 a[4:5], v14 offset:29696
  ds_read_b64_tr_b16 a[6:7], v14 offset:30208
  v_mul_f32 v27, v23, v27
  v_mul_f32 v28, v24, v28
  v_mul_f32 v29, v25, v29
  v_exp_f32 v26, v26
  s_waitcnt lgkmcnt(4)
  v_mfma_f32_32x32x16_bf16 v[64:79], a[16:19], v[172:175], v[64:79]
  v_exp_f32 v27, v27
  v_exp_f32 v28, v28
  v_mfma_f32_32x32x16_bf16 v[80:95], a[20:23], v[172:175], v[80:95]
  v_exp_f32 v29, v29
  v_add_f32 v26, 1.0, v26
  v_add_f32 v27, 1.0, v27
  v_add_f32 v28, 1.0, v28
  s_waitcnt lgkmcnt(0)
  v_mfma_f32_32x32x16_bf16 v[64:79], a[0:3], v[252:255], v[64:79]
  v_add_f32 v29, 1.0, v29
  v_rcp_f32 v26, v26
  v_mfma_f32_32x32x16_bf16 v[80:95], a[4:7], v[252:255], v[80:95]
  v_rcp_f32 v27, v27
  v_rcp_f32 v28, v28
  v_rcp_f32 v29, v29
  v_mul_f32 v60, v22, v26
  v_mul_f32 v61, v23, v27
  v_mul_f32 v62, v24, v28
  v_mul_f32 v63, v25, v29
  v_cvt_pk_bf16_f32 v58, v60, v61
  v_cvt_pk_bf16_f32 v59, v62, v63
  buffer_store_dwordx4 v[56:59], v15, s[12:15], s46 offen offset:1536 sc1
  v_add_u32 v30, s51, v10
  ds_read_b128 v[18:21], v30 offset:0
  ds_read_b128 v[22:25], v30 offset:32
  s_waitcnt lgkmcnt(1)
  v_fmac_f32 v18, v64, v16
  v_fmac_f32 v19, v65, v16
  v_fmac_f32 v20, v66, v16
  v_fmac_f32 v21, v67, v16
  v_mul_f32 v26, v18, v18
  v_mul_f32 v27, v19, v19
  v_readlane_b32 s43, v31, 11
  s_nop 0
  s_mul_i32 s43, s43, 5
  s_add_u32 s43, s43, s63
  s_nop 1
  buffer_load_dwordx4 v[96:99], v4, s[16:19], s43 offen offset:0 sc1
  v_mul_f32 v28, v20, v20
  v_mul_f32 v29, v21, v21
  v_fmaak_f32 v26, v26, v17, 0xc0135761
  v_fmaak_f32 v27, v27, v17, 0xc0135761
  v_fmaak_f32 v28, v28, v17, 0xc0135761
  v_fmaak_f32 v29, v29, v17, 0xc0135761
  v_mul_f32 v26, v18, v26
  v_mul_f32 v27, v19, v27
  v_mul_f32 v28, v20, v28
  buffer_load_dwordx4 v[100:103], v4, s[16:19], s43 offen offset:1024 sc1
  v_mul_f32 v29, v21, v29
  v_exp_f32 v26, v26
  v_exp_f32 v27, v27
  v_exp_f32 v28, v28
  v_exp_f32 v29, v29
  v_add_f32 v26, 1.0, v26
  v_add_f32 v27, 1.0, v27
  v_add_f32 v28, 1.0, v28
  v_add_f32 v29, 1.0, v29
  buffer_load_dwordx4 v[104:107], v4, s[16:19], s43 offen offset:2048 sc1
  v_rcp_f32 v26, v26
  v_rcp_f32 v27, v27
  v_rcp_f32 v28, v28
  v_rcp_f32 v29, v29
  v_mul_f32 v64, v18, v26
  v_mul_f32 v65, v19, v27
  v_mul_f32 v66, v20, v28
  v_mul_f32 v67, v21, v29
  ds_read_b128 v[18:21], v30 offset:64
  buffer_load_dwordx4 v[108:111], v4, s[16:19], s43 offen offset:3072 sc1
  v_cvt_pk_bf16_f32 v64, v64, v65
  v_cvt_pk_bf16_f32 v65, v66, v67
  s_waitcnt lgkmcnt(1)
  v_fmac_f32 v22, v68, v16
  v_fmac_f32 v23, v69, v16
  v_fmac_f32 v24, v70, v16
  v_fmac_f32 v25, v71, v16
  v_mul_f32 v26, v22, v22
  v_mul_f32 v27, v23, v23
  v_mul_f32 v28, v24, v24
  buffer_load_dwordx4 v[112:115], v5, s[16:19], s43 offen offset:0 sc1
  v_mul_f32 v29, v25, v25
  v_fmaak_f32 v26, v26, v17, 0xc0135761
  v_fmaak_f32 v27, v27, v17, 0xc0135761
  v_fmaak_f32 v28, v28, v17, 0xc0135761
  v_fmaak_f32 v29, v29, v17, 0xc0135761
  v_mul_f32 v26, v22, v26
  v_mul_f32 v27, v23, v27
  v_mul_f32 v28, v24, v28
  v_mul_f32 v29, v25, v29
  v_readlane_b32 s43, v31, 12
  s_nop 0
  s_mul_i32 s43, s43, 5
  s_add_u32 s43, s43, s63
  s_nop 1
  buffer_load_dwordx4 v[116:119], v4, s[16:19], s43 offen offset:0 sc1
  v_exp_f32 v26, v26
  v_exp_f32 v27, v27
  v_exp_f32 v28, v28
  v_exp_f32 v29, v29
  v_add_f32 v26, 1.0, v26
  v_add_f32 v27, 1.0, v27
  v_add_f32 v28, 1.0, v28
  v_add_f32 v29, 1.0, v29
  v_rcp_f32 v26, v26
  buffer_load_dwordx4 v[120:123], v4, s[16:19], s43 offen offset:1024 sc1
  v_rcp_f32 v27, v27
  v_rcp_f32 v28, v28
  v_rcp_f32 v29, v29
  v_mul_f32 v68, v22, v26
  v_mul_f32 v69, v23, v27
  v_mul_f32 v70, v24, v28
  v_mul_f32 v71, v25, v29
  ds_read_b128 v[22:25], v30 offset:96
  v_cvt_pk_bf16_f32 v66, v68, v69
  buffer_load_dwordx4 v[124:127], v4, s[16:19], s43 offen offset:2048 sc1
  v_cvt_pk_bf16_f32 v67, v70, v71
  buffer_store_dwordx4 v[64:67], v15, s[12:15], s47 offen offset:0 sc1
  s_waitcnt lgkmcnt(1)
  v_fmac_f32 v18, v72, v16
  v_fmac_f32 v19, v73, v16
  v_fmac_f32 v20, v74, v16
  v_fmac_f32 v21, v75, v16
  v_mul_f32 v26, v18, v18
  v_mul_f32 v27, v19, v19
  v_mul_f32 v28, v20, v20
  buffer_load_dwordx4 v[128:131], v4, s[16:19], s43 offen offset:3072 sc1
  v_mul_f32 v29, v21, v21
  v_fmaak_f32 v26, v26, v17, 0xc0135761
  v_fmaak_f32 v27, v27, v17, 0xc0135761
  v_fmaak_f32 v28, v28, v17, 0xc0135761
  v_fmaak_f32 v29, v29, v17, 0xc0135761
  v_mul_f32 v26, v18, v26
  v_mul_f32 v27, v19, v27
  v_mul_f32 v28, v20, v28
  v_mul_f32 v29, v21, v29
  buffer_load_dwordx4 v[132:135], v5, s[16:19], s43 offen offset:0 sc1
  v_exp_f32 v26, v26
  v_exp_f32 v27, v27
  v_exp_f32 v28, v28
  v_exp_f32 v29, v29
  v_add_f32 v26, 1.0, v26
  v_add_f32 v27, 1.0, v27
  v_add_f32 v28, 1.0, v28
  v_add_f32 v29, 1.0, v29
  v_rcp_f32 v26, v26
  v_readlane_b32 s43, v31, 13
  s_nop 0
  s_mul_i32 s43, s43, 5
  s_add_u32 s43, s43, s63
  s_nop 1
  buffer_load_dwordx4 v[136:139], v4, s[16:19], s43 offen offset:0 sc1
  v_rcp_f32 v27, v27
  s_waitcnt vmcnt(12)
  s_barrier
  s_lshl_b32 s73, s21, 3
  s_add_u32 s73, s73, s25
  s_lshl_b32 s73, s73, 10
  s_lshl_b32 s74, s24, 7
  s_add_u32 s73, s73, s74
  v_accvgpr_read_b32 v3, a35
  v_mov_b32 v2, 0x40000000
  v_cmp_eq_u32 vcc, 0, v1
  v_readlane_b32 s72, v3, 24
  s_cmp_eq_u32 s20, 0
  s_cselect_b32 s73, s73, 0x40000000
  v_mov_b32 v3, s73
  v_cndmask_b32 v2, v2, v3, vcc
  s_add_u32 s72, s72, 2
  v_mov_b32 v3, s72
  buffer_store_dword v3, v2, s[56:59], 0 offen sc1
  v_rcp_f32 v28, v28
  v_rcp_f32 v29, v29
  v_mul_f32 v72, v18, v26
  v_mul_f32 v73, v19, v27
  v_mul_f32 v74, v20, v28
  v_mul_f32 v75, v21, v29
  ds_read_b128 v[18:21], v30 offset:128
  v_cvt_pk_bf16_f32 v72, v72, v73
  buffer_load_dwordx4 v[140:143], v4, s[16:19], s43 offen offset:1024 sc1
  v_cvt_pk_bf16_f32 v73, v74, v75
  s_waitcnt lgkmcnt(1)
  v_fmac_f32 v22, v76, v16
  v_fmac_f32 v23, v77, v16
  v_fmac_f32 v24, v78, v16
  v_fmac_f32 v25, v79, v16
  v_mul_f32 v26, v22, v22
  v_mul_f32 v27, v23, v23
  v_mul_f32 v28, v24, v24
  v_mul_f32 v29, v25, v25
  buffer_load_dwordx4 v[144:147], v4, s[16:19], s43 offen offset:2048 sc1
  v_fmaak_f32 v26, v26, v17, 0xc0135761
  v_fmaak_f32 v27, v27, v17, 0xc0135761
  v_fmaak_f32 v28, v28, v17, 0xc0135761
  v_fmaak_f32 v29, v29, v17, 0xc0135761
  v_mul_f32 v26, v22, v26
  v_mul_f32 v27, v23, v27
  v_mul_f32 v28, v24, v28
  v_mul_f32 v29, v25, v29
  v_exp_f32 v26, v26
  buffer_load_dwordx4 v[148:151], v4, s[16:19], s43 offen offset:3072 sc1
  v_exp_f32 v27, v27
  v_exp_f32 v28, v28
  v_exp_f32 v29, v29
  v_add_f32 v26, 1.0, v26
  v_add_f32 v27, 1.0, v27
  v_add_f32 v28, 1.0, v28
  v_add_f32 v29, 1.0, v29
  v_rcp_f32 v26, v26
  v_rcp_f32 v27, v27
  buffer_load_dwordx4 v[152:155], v5, s[16:19], s43 offen offset:0 sc1
  v_rcp_f32 v28, v28
  v_rcp_f32 v29, v29
  v_mul_f32 v76, v22, v26
  v_mul_f32 v77, v23, v27
  v_mul_f32 v78, v24, v28
  v_mul_f32 v79, v25, v29
  ds_read_b128 v[22:25], v30 offset:160
  v_cvt_pk_bf16_f32 v74, v76, v77
  v_cvt_pk_bf16_f32 v75, v78, v79
  v_readlane_b32 s43, v31, 14
  s_nop 0
  s_mul_i32 s43, s43, 5
  s_add_u32 s43, s43, s63
  s_nop 1
  buffer_load_dwordx4 v[156:159], v4, s[16:19], s43 offen offset:0 sc1
  buffer_store_dwordx4 v[72:75], v15, s[12:15], s47 offen offset:512 sc1
  s_waitcnt lgkmcnt(1)
  v_fmac_f32 v18, v80, v16
  v_fmac_f32 v19, v81, v16
  v_fmac_f32 v20, v82, v16
  v_fmac_f32 v21, v83, v16
  v_mul_f32 v26, v18, v18
  v_mul_f32 v27, v19, v19
  v_mul_f32 v28, v20, v20
  v_mul_f32 v29, v21, v21
  buffer_load_dwordx4 v[160:163], v4, s[16:19], s43 offen offset:1024 sc1
  v_fmaak_f32 v26, v26, v17, 0xc0135761
  v_fmaak_f32 v27, v27, v17, 0xc0135761
  v_fmaak_f32 v28, v28, v17, 0xc0135761
  v_fmaak_f32 v29, v29, v17, 0xc0135761
  v_mul_f32 v26, v18, v26
  v_mul_f32 v27, v19, v27
  v_mul_f32 v28, v20, v28
  v_mul_f32 v29, v21, v29
  v_exp_f32 v26, v26
  buffer_load_dwordx4 v[164:167], v4, s[16:19], s43 offen offset:2048 sc1
  v_exp_f32 v27, v27
  v_exp_f32 v28, v28
  v_exp_f32 v29, v29
  v_add_f32 v26, 1.0, v26
  v_add_f32 v27, 1.0, v27
  v_add_f32 v28, 1.0, v28
  v_add_f32 v29, 1.0, v29
  v_rcp_f32 v26, v26
  v_rcp_f32 v27, v27
  buffer_load_dwordx4 v[168:171], v4, s[16:19], s43 offen offset:3072 sc1
  v_rcp_f32 v28, v28
  v_rcp_f32 v29, v29
  v_mul_f32 v80, v18, v26
  v_mul_f32 v81, v19, v27
  v_mul_f32 v82, v20, v28
  v_mul_f32 v83, v21, v29
  ds_read_b128 v[18:21], v30 offset:192
  v_cvt_pk_bf16_f32 v80, v80, v81
  v_cvt_pk_bf16_f32 v81, v82, v83
  buffer_load_dwordx4 v[172:175], v5, s[16:19], s43 offen offset:0 sc1
  s_lshr_b32 s72, s100, 4
  s_and_b32 s73, s100, 15
  s_lshr_b32 s74, s73, 1
  s_lshl_b32 s75, s72, 3
  s_add_u32 s75, s75, s74
  s_mul_i32 s72, s72, 9
  s_add_u32 s72, s72, s74
  s_add_u32 s72, s72, 16
  s_and_b32 s73, s73, 1
  s_add_u32 s73, s73, s72
  v_mov_b32 v6, s73
  v_mov_b32 v7, s72
  v_cmp_gt_u32 vcc, 16, v1
  s_nop 1
  v_cndmask_b32 v6, v6, v7, vcc
  v_mov_b32 v7, s75
  v_cmp_gt_u32 vcc, 8, v1
  s_nop 1
  v_cndmask_b32 v6, v6, v7, vcc
  v_and_b32 v7, 7, v1
  v_lshlrev_b32 v7, 7, v7
  v_lshl_add_u32 v6, v6, 10, v7
  s_mov_b64 exec, 0x7f
  buffer_load_dword v8, v6, s[56:59], 0 offen sc1
  s_mov_b64 exec, -1
  s_waitcnt lgkmcnt(1)
  v_fmac_f32 v22, v84, v16
  v_fmac_f32 v23, v85, v16
  v_fmac_f32 v24, v86, v16
  v_fmac_f32 v25, v87, v16
  v_mul_f32 v26, v22, v22
  v_mul_f32 v27, v23, v23
  v_mul_f32 v28, v24, v24
  v_mul_f32 v29, v25, v25
  v_fmaak_f32 v26, v26, v17, 0xc0135761
  v_readlane_b32 s43, v31, 15
  s_nop 0
  s_and_b32 s43, s43, -2
  s_mul_i32 s43, s43, 5
  s_add_u32 s43, s43, s63
  s_nop 0
  buffer_load_dwordx4 v[176:179], v4, s[16:19], s43 offen offset:0 sc1
  v_fmaak_f32 v27, v27, v17, 0xc0135761
  v_fmaak_f32 v28, v28, v17, 0xc0135761
  v_fmaak_f32 v29, v29, v17, 0xc0135761
  v_mul_f32 v26, v22, v26
  v_mul_f32 v27, v23, v27
  v_mul_f32 v28, v24, v28
  v_mul_f32 v29, v25, v29
  v_exp_f32 v26, v26
  v_exp_f32 v27, v27
  buffer_load_dwordx4 v[180:183], v4, s[16:19], s43 offen offset:1024 sc1
  v_exp_f32 v28, v28
  v_exp_f32 v29, v29
  v_add_f32 v26, 1.0, v26
  v_add_f32 v27, 1.0, v27
  v_add_f32 v28, 1.0, v28
  v_add_f32 v29, 1.0, v29
  v_rcp_f32 v26, v26
  v_rcp_f32 v27, v27
  v_rcp_f32 v28, v28
  buffer_load_dwordx4 v[184:187], v4, s[16:19], s43 offen offset:2048 sc1
  v_rcp_f32 v29, v29
  v_mul_f32 v84, v22, v26
  v_mul_f32 v85, v23, v27
  v_mul_f32 v86, v24, v28
  v_mul_f32 v87, v25, v29
  ds_read_b128 v[22:25], v30 offset:224
  v_cvt_pk_bf16_f32 v82, v84, v85
  v_cvt_pk_bf16_f32 v83, v86, v87
  buffer_store_dwordx4 v[80:83], v15, s[12:15], s47 offen offset:1024 sc1
  buffer_load_dwordx4 v[188:191], v4, s[16:19], s43 offen offset:3072 sc1
  s_waitcnt lgkmcnt(1)
  v_fmac_f32 v18, v88, v16
  v_fmac_f32 v19, v89, v16
  v_fmac_f32 v20, v90, v16
  v_fmac_f32 v21, v91, v16
  v_mul_f32 v26, v18, v18
  v_mul_f32 v27, v19, v19
  v_mul_f32 v28, v20, v20
  v_mul_f32 v29, v21, v21
  v_fmaak_f32 v26, v26, v17, 0xc0135761
  buffer_load_dwordx4 v[192:195], v5, s[16:19], s43 offen offset:0 sc1
  v_fmaak_f32 v27, v27, v17, 0xc0135761
  v_fmaak_f32 v28, v28, v17, 0xc0135761
  v_fmaak_f32 v29, v29, v17, 0xc0135761
  v_mul_f32 v26, v18, v26
  v_mul_f32 v27, v19, v27
  v_mul_f32 v28, v20, v28
  v_mul_f32 v29, v21, v29
  v_exp_f32 v26, v26
  v_exp_f32 v27, v27
  v_readlane_b32 s43, v31, 16
  s_nop 0
  s_mul_i32 s43, s43, 5
  s_add_u32 s43, s43, s63
  s_nop 1
  buffer_load_dwordx4 v[196:199], v4, s[16:19], s43 offen offset:0 sc1
  v_exp_f32 v28, v28
  v_exp_f32 v29, v29
  v_add_f32 v26, 1.0, v26
  v_add_f32 v27, 1.0, v27
  v_add_f32 v28, 1.0, v28
  v_add_f32 v29, 1.0, v29
  v_rcp_f32 v26, v26
  v_rcp_f32 v27, v27
  v_rcp_f32 v28, v28
  buffer_load_dwordx4 v[200:203], v4, s[16:19], s43 offen offset:1024 sc1
  v_rcp_f32 v29, v29
  v_mul_f32 v88, v18, v26
  v_mul_f32 v89, v19, v27
  v_mul_f32 v90, v20, v28
  v_mul_f32 v91, v21, v29
  v_cvt_pk_bf16_f32 v88, v88, v89
  v_cvt_pk_bf16_f32 v89, v90, v91
  s_waitcnt lgkmcnt(0)
  v_fmac_f32 v22, v92, v16
  v_fmac_f32 v23, v93, v16
  buffer_load_dwordx4 v[204:207], v4, s[16:19], s43 offen offset:2048 sc1
  v_fmac_f32 v24, v94, v16
  v_fmac_f32 v25, v95, v16
  v_mul_f32 v26, v22, v22
  v_mul_f32 v27, v23, v23
  v_mul_f32 v28, v24, v24
  v_mul_f32 v29, v25, v25
  v_fmaak_f32 v26, v26, v17, 0xc0135761
  v_fmaak_f32 v27, v27, v17, 0xc0135761
  v_fmaak_f32 v28, v28, v17, 0xc0135761
  buffer_load_dwordx4 v[208:211], v4, s[16:19], s43 offen offset:3072 sc1
  v_fmaak_f32 v29, v29, v17, 0xc0135761
  v_mul_f32 v26, v22, v26
  v_mul_f32 v27, v23, v27
  v_mul_f32 v28, v24, v28
  v_mul_f32 v29, v25, v29
  v_exp_f32 v26, v26
  v_exp_f32 v27, v27
  v_exp_f32 v28, v28
  v_exp_f32 v29, v29
  buffer_load_dwordx4 v[212:215], v5, s[16:19], s43 offen offset:0 sc1
  v_add_f32 v26, 1.0, v26
  v_add_f32 v27, 1.0, v27
  v_add_f32 v28, 1.0, v28
  v_add_f32 v29, 1.0, v29
  v_rcp_f32 v26, v26
  v_rcp_f32 v27, v27
  v_rcp_f32 v28, v28
  v_rcp_f32 v29, v29
  v_mul_f32 v92, v22, v26
  v_mul_f32 v93, v23, v27
  v_mul_f32 v94, v24, v28
  v_mul_f32 v95, v25, v29
  v_cvt_pk_bf16_f32 v90, v92, v93
  v_cvt_pk_bf16_f32 v91, v94, v95
  buffer_store_dwordx4 v[88:91], v15, s[12:15], s47 offen offset:1536 sc1
  s_lshl_b32 s41, s21, 3
  s_add_u32 s41, s41, s25
  s_lshl_b32 s41, s41, 10
  s_lshl_b32 s42, s24, 7
  s_add_u32 s41, s41, s42
  s_mov_b32 s42, 3
  s_load_dwordx4 s[64:67], s[0:1], 56
  v_mov_b32 v12, v1
  s_lshr_b32 s72, s100, 2
  s_mul_i32 s72, s72, 1
  v_subrev_u32 v10, 5, v12
  v_cmp_gt_u32 vcc, 10, v12
  s_nop 1
  v_cndmask_b32 v10, v10, v12, vcc
  v_lshlrev_b32 v10, 2, v10
  v_add_u32 v10, s20, v10
  v_mul_u32_u24 v11, 147, v10
  v_lshrrev_b32 v11, 11, v11
  v_mul_u32_u24 v15, 14, v11
  v_sub_u32 v10, v10, v15
  v_add_u32 v11, s72, v11
  v_and_b32 v11, 3, v11
  v_lshrrev_b32 v15, 1, v10
  v_lshl_add_u32 v11, v15, 2, v11
  v_and_b32 v10, 1, v10
  v_cmp_eq_u32 vcc, 27, v11
  v_min_u32 v11, 26, v11
  v_lshl_add_u32 v11, v11, 1, v10
  v_lshlrev_b32 v11, 10, v11
  v_cndmask_b32 v10, 0, 1, vcc
  v_or_b32 v11, v11, v10
  s_mul_i32 s72, s20, 5
  s_add_u32 s72, s72, 44
  v_add_u32 v10, s72, v12
  v_lshlrev_b32 v10, 10, v10
  v_subrev_u32 v15, 10, v12
  v_cmp_gt_u32 vcc, 5, v15
  s_nop 1
  v_cndmask_b32 v15, v11, v10, vcc
  v_accvgpr_read_b32 v7, a35
  v_lshlrev_b32 v248, 4, v1
  v_add_u32 v249, 4096, v248
  v_add_u32 v250, 75776, v248
  v_add_u32 v251, 151552, v248
  v_add_u32 v252, 227328, v248
  s_lshr_b32 s48, s20, 1
  s_lshl_b32 s48, 0x15, s48
  s_lshl_b32 s49, s20, 1
  s_lshl_b32 s49, 0x30300, s49
  s_cmp_lt_u32 s20, 2
  s_mov_b32 s50, 0x55
  s_cselect_b32 s50, 0x6a, s50
  s_waitcnt vmcnt(12)
  s_mov_b32 s74, 0
L_plw1:
  v_sub_u32 v9, v8, v7
  v_cmp_gt_u32 vcc, 1, v9
  s_add_u32 s74, s74, 1
  s_nop 2
  s_and_b32 s72, vcc_lo, 0x7f
  s_cbranch_scc0 L_plw1_ok
  s_cmp_ge_u32 s74, 0x10000
  s_cbranch_scc1 L_plw1_ok
  s_sleep 8
  buffer_load_dword v8, v6, s[56:59], 0 offen sc1
  s_waitcnt vmcnt(0)
  s_branch L_plw1
L_plw1_ok:
  v_readlane_b32 s72, v15, 0
  s_nop 0
  s_add_u32 s72, s72, s62
  s_nop 2
  buffer_load_dwordx4 a[0:3], v248, s[12:15], s72 offen sc1
  buffer_load_dwordx4 a[4:7], v250, s[12:15], s72 offen sc1
  buffer_load_dwordx4 a[8:11], v251, s[12:15], s72 offen sc1
  buffer_load_dwordx4 a[12:15], v252, s[12:15], s72 offen sc1
  v_readlane_b32 s72, v15, 1
  s_nop 0
  s_add_u32 s72, s72, s62
  s_nop 2
  buffer_load_dwordx4 a[16:19], v248, s[12:15], s72 offen sc1
  buffer_load_dwordx4 a[20:23], v250, s[12:15], s72 offen sc1
  buffer_load_dwordx4 a[24:27], v251, s[12:15], s72 offen sc1
  buffer_load_dwordx4 a[28:31], v252, s[12:15], s72 offen sc1
  v_readlane_b32 s72, v15, 2
  s_nop 0
  s_add_u32 s72, s72, s62
  s_nop 2
  buffer_load_dwordx4 v[216:219], v248, s[12:15], s72 offen sc1
  buffer_load_dwordx4 v[220:223], v250, s[12:15], s72 offen sc1
  buffer_load_dwordx4 v[224:227], v251, s[12:15], s72 offen sc1
  buffer_load_dwordx4 v[228:231], v252, s[12:15], s72 offen sc1
  v_readlane_b32 s72, v15, 3
  s_bitcmp1_b32 s72, 0
  s_cselect_b32 s14, 0, 9699328
  s_and_b32 s72, s72, -2
  s_add_u32 s72, s72, s62
  s_nop 0
  buffer_load_dwordx4 v[232:235], v248, s[12:15], s72 offen sc1
  buffer_load_dwordx4 v[236:239], v250, s[12:15], s72 offen sc1
  buffer_load_dwordx4 v[240:243], v251, s[12:15], s72 offen sc1
  buffer_load_dwordx4 v[244:247], v252, s[12:15], s72 offen sc1
  s_waitcnt vmcnt(16)
  s_barrier
  s_mov_b32 exec_lo, s48
  s_mov_b32 exec_hi, 0
  buffer_load_dword v8, v6, s[56:59], 0 offen sc1
  s_mov_b64 exec, -1
  s_waitcnt lgkmcnt(0)
  s_mov_b32 s8, s66
  s_and_b32 s9, s67, 0xffff
  s_mov_b32 s10, 2621440
  s_mov_b32 s11, 0x20000
  s_mov_b32 s76, s64
  s_and_b32 s77, s65, 0xffff
  s_mov_b32 s78, 1280
  s_mov_b32 s79, 0x20000
  s_lshl_b32 s31, s100, 6
  s_lshl_b32 s26, s20, 4
  s_add_u32 s31, s31, s26
  s_lshr_b32 s26, s31, 10
  s_and_b32 s31, s31, 1023
  s_lshl_b32 s31, s31, 1
  s_add_u32 s26, s26, s31
  s_mul_i32 s36, s20, 21504
  s_mul_i32 s31, s101, 160
  s_waitcnt vmcnt(16)
  v_mfma_f32_16x16x32_bf16 v[16:19], a[36:39], a[0:3], 0
  v_readlane_b32 s72, v15, 4
  s_mov_b32 s14, 9699328
  s_add_u32 s72, s72, s62
  v_mfma_f32_16x16x32_bf16 v[20:23], a[40:43], a[0:3], 0
  v_mfma_f32_16x16x32_bf16 v[24:27], a[44:47], a[0:3], 0
  v_mfma_f32_16x16x32_bf16 v[28:31], a[48:51], a[0:3], 0
  v_mfma_f32_16x16x32_bf16 v[32:35], a[52:55], a[0:3], 0
  buffer_load_dwordx4 a[0:3], v248, s[12:15], s72 offen sc1
  s_waitcnt vmcnt(16)
  v_mfma_f32_16x16x32_bf16 v[36:39], a[36:39], a[4:7], 0
  v_mfma_f32_16x16x32_bf16 v[40:43], a[40:43], a[4:7], 0
  v_mfma_f32_16x16x32_bf16 v[44:47], a[44:47], a[4:7], 0
  v_mfma_f32_16x16x32_bf16 v[48:51], a[48:51], a[4:7], 0
  v_mfma_f32_16x16x32_bf16 v[52:55], a[52:55], a[4:7], 0
  buffer_load_dwordx4 a[4:7], v250, s[12:15], s72 offen sc1
  s_waitcnt vmcnt(16)
  v_mfma_f32_16x16x32_bf16 v[56:59], a[36:39], a[8:11], 0
  v_mfma_f32_16x16x32_bf16 v[60:63], a[40:43], a[8:11], 0
  v_mfma_f32_16x16x32_bf16 v[64:67], a[44:47], a[8:11], 0
  v_mfma_f32_16x16x32_bf16 v[68:71], a[48:51], a[8:11], 0
  v_mfma_f32_16x16x32_bf16 v[72:75], a[52:55], a[8:11], 0
  buffer_load_dwordx4 a[8:11], v251, s[12:15], s72 offen sc1
  s_waitcnt vmcnt(16)
  v_mfma_f32_16x16x32_bf16 v[76:79], a[36:39], a[12:15], 0
  v_mfma_f32_16x16x32_bf16 v[80:83], a[40:43], a[12:15], 0
  v_mfma_f32_16x16x32_bf16 v[84:87], a[44:47], a[12:15], 0
  v_mfma_f32_16x16x32_bf16 v[88:91], a[48:51], a[12:15], 0
  v_mfma_f32_16x16x32_bf16 v[92:95], a[52:55], a[12:15], 0
  buffer_load_dwordx4 a[12:15], v252, s[12:15], s72 offen sc1
  s_waitcnt vmcnt(16)
  v_mfma_f32_16x16x32_bf16 v[16:19], a[56:59], a[16:19], v[16:19]
  v_readlane_b32 s72, v15, 5
  s_nop 0
  s_add_u32 s72, s72, s62
  v_mfma_f32_16x16x32_bf16 v[20:23], a[60:63], a[16:19], v[20:23]
  v_mfma_f32_16x16x32_bf16 v[24:27], a[64:67], a[16:19], v[24:27]
  v_mfma_f32_16x16x32_bf16 v[28:31], a[68:71], a[16:19], v[28:31]
  v_mfma_f32_16x16x32_bf16 v[32:35], a[72:75], a[16:19], v[32:35]
  buffer_load_dwordx4 a[16:19], v248, s[12:15], s72 offen sc1
  s_waitcnt vmcnt(16)
  v_mfma_f32_16x16x32_bf16 v[36:39], a[56:59], a[20:23], v[36:39]
  v_mfma_f32_16x16x32_bf16 v[40:43], a[60:63], a[20:23], v[40:43]
  v_mfma_f32_16x16x32_bf16 v[44:47], a[64:67], a[20:23], v[44:47]
  v_mfma_f32_16x16x32_bf16 v[48:51], a[68:71], a[20:23], v[48:51]
  v_mfma_f32_16x16x32_bf16 v[52:55], a[72:75], a[20:23], v[52:55]
  buffer_load_dwordx4 a[20:23], v250, s[12:15], s72 offen sc1
  s_waitcnt vmcnt(16)
  v_mfma_f32_16x16x32_bf16 v[56:59], a[56:59], a[24:27], v[56:59]
  v_mfma_f32_16x16x32_bf16 v[60:63], a[60:63], a[24:27], v[60:63]
  v_mfma_f32_16x16x32_bf16 v[64:67], a[64:67], a[24:27], v[64:67]
  v_mfma_f32_16x16x32_bf16 v[68:71], a[68:71], a[24:27], v[68:71]
  v_mfma_f32_16x16x32_bf16 v[72:75], a[72:75], a[24:27], v[72:75]
  buffer_load_dwordx4 a[24:27], v251, s[12:15], s72 offen sc1
  s_waitcnt vmcnt(16)
  v_mfma_f32_16x16x32_bf16 v[76:79], a[56:59], a[28:31], v[76:79]
  v_mfma_f32_16x16x32_bf16 v[80:83], a[60:63], a[28:31], v[80:83]
  v_mfma_f32_16x16x32_bf16 v[84:87], a[64:67], a[28:31], v[84:87]
  v_mfma_f32_16x16x32_bf16 v[88:91], a[68:71], a[28:31], v[88:91]
  v_mfma_f32_16x16x32_bf16 v[92:95], a[72:75], a[28:31], v[92:95]
  buffer_load_dwordx4 a[28:31], v252, s[12:15], s72 offen sc1
  s_waitcnt vmcnt(16)
  v_mfma_f32_16x16x32_bf16 v[16:19], a[76:79], v[216:219], v[16:19]
  v_readlane_b32 s72, v15, 6
  s_bitcmp1_b32 s72, 0
  s_cselect_b32 s14, 0, 9699328
  s_and_b32 s72, s72, -2
  s_add_u32 s72, s72, s62
  v_mfma_f32_16x16x32_bf16 v[20:23], a[80:83], v[216:219], v[20:23]
  v_mfma_f32_16x16x32_bf16 v[24:27], a[84:87], v[216:219], v[24:27]
  v_mfma_f32_16x16x32_bf16 v[28:31], a[88:91], v[216:219], v[28:31]
  v_mfma_f32_16x16x32_bf16 v[32:35], a[92:95], v[216:219], v[32:35]
  buffer_load_dwordx4 v[216:219], v248, s[12:15], s72 offen sc1
  s_waitcnt vmcnt(16)
  v_mfma_f32_16x16x32_bf16 v[36:39], a[76:79], v[220:223], v[36:39]
  v_mfma_f32_16x16x32_bf16 v[40:43], a[80:83], v[220:223], v[40:43]
  v_mfma_f32_16x16x32_bf16 v[44:47], a[84:87], v[220:223], v[44:47]
  v_mfma_f32_16x16x32_bf16 v[48:51], a[88:91], v[220:223], v[48:51]
  v_mfma_f32_16x16x32_bf16 v[52:55], a[92:95], v[220:223], v[52:55]
  buffer_load_dwordx4 v[220:223], v250, s[12:15], s72 offen sc1
  s_waitcnt vmcnt(16)
  v_mfma_f32_16x16x32_bf16 v[56:59], a[76:79], v[224:227], v[56:59]
  v_mfma_f32_16x16x32_bf16 v[60:63], a[80:83], v[224:227], v[60:63]
  v_mfma_f32_16x16x32_bf16 v[64:67], a[84:87], v[224:227], v[64:67]
  v_mfma_f32_16x16x32_bf16 v[68:71], a[88:91], v[224:227], v[68:71]
  v_mfma_f32_16x16x32_bf16 v[72:75], a[92:95], v[224:227], v[72:75]
  buffer_load_dwordx4 v[224:227], v251, s[12:15], s72 offen sc1
  s_waitcnt vmcnt(16)
  v_mfma_f32_16x16x32_bf16 v[76:79], a[76:79], v[228:231], v[76:79]
  v_mfma_f32_16x16x32_bf16 v[80:83], a[80:83], v[228:231], v[80:83]
  v_mfma_f32_16x16x32_bf16 v[84:87], a[84:87], v[228:231], v[84:87]
  v_mfma_f32_16x16x32_bf16 v[88:91], a[88:91], v[228:231], v[88:91]
  v_mfma_f32_16x16x32_bf16 v[92:95], a[92:95], v[228:231], v[92:95]
  buffer_load_dwordx4 v[228:231], v252, s[12:15], s72 offen sc1
  v_accvgpr_read_b32 v11, a35
  v_mov_b32 v10, 0x40000000
  v_cmp_eq_u32 vcc, 0, v1
  v_readlane_b32 s72, v11, 24
  s_cmp_eq_u32 s20, 0
  s_cselect_b32 s41, s41, 0x40000000
  v_mov_b32 v11, s41
  v_cndmask_b32 v10, v10, v11, vcc
  s_add_u32 s72, s72, s42
  v_mov_b32 v11, s72
  buffer_store_dword v11, v10, s[56:59], 0 offen sc1
  s_waitcnt vmcnt(13)
  s_mov_b32 s74, 0
L_plw2:
  v_sub_u32 v9, v8, v7
  v_cmp_gt_u32 vcc, 2, v9
  s_add_u32 s74, s74, 1
  s_nop 2
  s_and_b32 s72, vcc_lo, s48
  s_cbranch_scc0 L_plw2_ok
  s_cmp_ge_u32 s74, 0x10000
  s_cbranch_scc1 L_plw2_ok
  s_sleep 8
  buffer_load_dword v8, v6, s[56:59], 0 offen sc1
  s_waitcnt vmcnt(0)
  s_branch L_plw2
L_plw2_ok:
  v_mfma_f32_16x16x32_bf16 v[16:19], a[96:99], v[232:235], v[16:19]
  v_readlane_b32 s72, v15, 7
  s_mov_b32 s14, 9699328
  s_add_u32 s72, s72, s62
  v_mfma_f32_16x16x32_bf16 v[20:23], a[100:103], v[232:235], v[20:23]
  v_mfma_f32_16x16x32_bf16 v[24:27], a[104:107], v[232:235], v[24:27]
  v_mfma_f32_16x16x32_bf16 v[28:31], a[108:111], v[232:235], v[28:31]
  v_mfma_f32_16x16x32_bf16 v[32:35], a[112:115], v[232:235], v[32:35]
  buffer_load_dwordx4 v[232:235], v248, s[12:15], s72 offen sc1
  v_mfma_f32_16x16x32_bf16 v[36:39], a[96:99], v[236:239], v[36:39]
  v_mfma_f32_16x16x32_bf16 v[40:43], a[100:103], v[236:239], v[40:43]
  v_mfma_f32_16x16x32_bf16 v[44:47], a[104:107], v[236:239], v[44:47]
  v_mfma_f32_16x16x32_bf16 v[48:51], a[108:111], v[236:239], v[48:51]
  v_mfma_f32_16x16x32_bf16 v[52:55], a[112:115], v[236:239], v[52:55]
  buffer_load_dwordx4 v[236:239], v250, s[12:15], s72 offen sc1
  v_mfma_f32_16x16x32_bf16 v[56:59], a[96:99], v[240:243], v[56:59]
  v_mfma_f32_16x16x32_bf16 v[60:63], a[100:103], v[240:243], v[60:63]
  v_mfma_f32_16x16x32_bf16 v[64:67], a[104:107], v[240:243], v[64:67]
  v_mfma_f32_16x16x32_bf16 v[68:71], a[108:111], v[240:243], v[68:71]
  v_mfma_f32_16x16x32_bf16 v[72:75], a[112:115], v[240:243], v[72:75]
  buffer_load_dwordx4 v[240:243], v251, s[12:15], s72 offen sc1
  v_mfma_f32_16x16x32_bf16 v[76:79], a[96:99], v[244:247], v[76:79]
  v_mfma_f32_16x16x32_bf16 v[80:83], a[100:103], v[244:247], v[80:83]
  v_mfma_f32_16x16x32_bf16 v[84:87], a[104:107], v[244:247], v[84:87]
  v_mfma_f32_16x16x32_bf16 v[88:91], a[108:111], v[244:247], v[88:91]
  v_mfma_f32_16x16x32_bf16 v[92:95], a[112:115], v[244:247], v[92:95]
  buffer_load_dwordx4 v[244:247], v252, s[12:15], s72 offen sc1
  s_mov_b32 exec_lo, s49
  s_mov_b32 exec_hi, 0
  buffer_load_dword v8, v6, s[56:59], 0 offen sc1
  s_mov_b64 exec, -1
  s_waitcnt vmcnt(17)
  v_mfma_f32_16x16x32_bf16 v[16:19], a[116:119], a[0:3], v[16:19]
  v_readlane_b32 s72, v15, 8
  s_nop 0
  s_add_u32 s72, s72, s62
  v_mfma_f32_16x16x32_bf16 v[20:23], a[120:123], a[0:3], v[20:23]
  v_mfma_f32_16x16x32_bf16 v[24:27], a[124:127], a[0:3], v[24:27]
  v_mfma_f32_16x16x32_bf16 v[28:31], a[128:131], a[0:3], v[28:31]
  v_mfma_f32_16x16x32_bf16 v[32:35], a[132:135], a[0:3], v[32:35]
  buffer_load_dwordx4 a[0:3], v248, s[12:15], s72 offen sc1
  s_waitcnt vmcnt(17)
  v_mfma_f32_16x16x32_bf16 v[36:39], a[116:119], a[4:7], v[36:39]
  v_mfma_f32_16x16x32_bf16 v[40:43], a[120:123], a[4:7], v[40:43]
  v_mfma_f32_16x16x32_bf16 v[44:47], a[124:127], a[4:7], v[44:47]
  v_mfma_f32_16x16x32_bf16 v[48:51], a[128:131], a[4:7], v[48:51]
  v_mfma_f32_16x16x32_bf16 v[52:55], a[132:135], a[4:7], v[52:55]
  buffer_load_dwordx4 a[4:7], v250, s[12:15], s72 offen sc1
  s_waitcnt vmcnt(17)
  v_mfma_f32_16x16x32_bf16 v[56:59], a[116:119], a[8:11], v[56:59]
  v_mfma_f32_16x16x32_bf16 v[60:63], a[120:123], a[8:11], v[60:63]
  v_mfma_f32_16x16x32_bf16 v[64:67], a[124:127], a[8:11], v[64:67]
  v_mfma_f32_16x16x32_bf16 v[68:71], a[128:131], a[8:11], v[68:71]
  v_mfma_f32_16x16x32_bf16 v[72:75], a[132:135], a[8:11], v[72:75]
  buffer_load_dwordx4 a[8:11], v251, s[12:15], s72 offen sc1
  s_waitcnt vmcnt(17)
  v_mfma_f32_16x16x32_bf16 v[76:79], a[116:119], a[12:15], v[76:79]
  v_mfma_f32_16x16x32_bf16 v[80:83], a[120:123], a[12:15], v[80:83]
  v_mfma_f32_16x16x32_bf16 v[84:87], a[124:127], a[12:15], v[84:87]
  v_mfma_f32_16x16x32_bf16 v[88:91], a[128:131], a[12:15], v[88:91]
  v_mfma_f32_16x16x32_bf16 v[92:95], a[132:135], a[12:15], v[92:95]
  buffer_load_dwordx4 a[12:15], v252, s[12:15], s72 offen sc1
  s_waitcnt vmcnt(17)
  v_mfma_f32_16x16x32_bf16 v[16:19], a[136:139], a[16:19], v[16:19]
  v_readlane_b32 s72, v15, 9
  s_nop 0
  s_add_u32 s72, s72, s62
  v_mfma_f32_16x16x32_bf16 v[20:23], a[140:143], a[16:19], v[20:23]
  v_mfma_f32_16x16x32_bf16 v[24:27], a[144:147], a[16:19], v[24:27]
  v_mfma_f32_16x16x32_bf16 v[28:31], a[148:151], a[16:19], v[28:31]
  v_mfma_f32_16x16x32_bf16 v[32:35], a[152:155], a[16:19], v[32:35]
  buffer_load_dwordx4 a[16:19], v248, s[12:15], s72 offen sc1
  s_waitcnt vmcnt(17)
  v_mfma_f32_16x16x32_bf16 v[36:39], a[136:139], a[20:23], v[36:39]
  v_mfma_f32_16x16x32_bf16 v[40:43], a[140:143], a[20:23], v[40:43]
  v_mfma_f32_16x16x32_bf16 v[44:47], a[144:147], a[20:23], v[44:47]
  v_mfma_f32_16x16x32_bf16 v[48:51], a[148:151], a[20:23], v[48:51]
  v_mfma_f32_16x16x32_bf16 v[52:55], a[152:155], a[20:23], v[52:55]
  buffer_load_dwordx4 a[20:23], v250, s[12:15], s72 offen sc1
  s_waitcnt vmcnt(17)
  v_mfma_f32_16x16x32_bf16 v[56:59], a[136:139], a[24:27], v[56:59]
  v_mfma_f32_16x16x32_bf16 v[60:63], a[140:143], a[24:27], v[60:63]
  v_mfma_f32_16x16x32_bf16 v[64:67], a[144:147], a[24:27], v[64:67]
  v_mfma_f32_16x16x32_bf16 v[68:71], a[148:151], a[24:27], v[68:71]
  v_mfma_f32_16x16x32_bf16 v[72:75], a[152:155], a[24:27], v[72:75]
  buffer_load_dwordx4 a[24:27], v251, s[12:15], s72 offen sc1
  s_waitcnt vmcnt(17)
  v_mfma_f32_16x16x32_bf16 v[76:79], a[136:139], a[28:31], v[76:79]
  v_mfma_f32_16x16x32_bf16 v[80:83], a[140:143], a[28:31], v[80:83]
  v_mfma_f32_16x16x32_bf16 v[84:87], a[144:147], a[28:31], v[84:87]
  v_mfma_f32_16x16x32_bf16 v[88:91], a[148:151], a[28:31], v[88:91]
  v_mfma_f32_16x16x32_bf16 v[92:95], a[152:155], a[28:31], v[92:95]
  buffer_load_dwordx4 a[28:31], v252, s[12:15], s72 offen sc1
  s_waitcnt vmcnt(8)
  s_mov_b32 s74, 0
L_plw3:
  v_sub_u32 v9, v8, v7
  v_cmp_gt_u32 vcc, 1, v9
  s_add_u32 s74, s74, 1
  s_nop 2
  s_and_b32 s72, vcc_lo, s49
  s_cbranch_scc0 L_plw3_ok
  s_cmp_ge_u32 s74, 0x80000
  s_cbranch_scc1 L_plw3_ok
  s_sleep 8
  buffer_load_dword v8, v6, s[56:59], 0 offen sc1
  s_waitcnt vmcnt(0)
  s_branch L_plw3
L_plw3_ok:
  v_mfma_f32_16x16x32_bf16 v[16:19], a[156:159], v[216:219], v[16:19]
  v_readlane_b32 s72, v15, 10
  s_nop 0
  s_add_u32 s72, s72, s62
  v_mfma_f32_16x16x32_bf16 v[20:23], a[160:163], v[216:219], v[20:23]
  v_mfma_f32_16x16x32_bf16 v[24:27], a[164:167], v[216:219], v[24:27]
  v_mfma_f32_16x16x32_bf16 v[28:31], a[168:171], v[216:219], v[28:31]
  v_mfma_f32_16x16x32_bf16 v[32:35], a[172:175], v[216:219], v[32:35]
  buffer_load_dwordx4 v[216:219], v248, s[12:15], s72 offen sc1
  v_mfma_f32_16x16x32_bf16 v[36:39], a[156:159], v[220:223], v[36:39]
  v_mfma_f32_16x16x32_bf16 v[40:43], a[160:163], v[220:223], v[40:43]
  v_mfma_f32_16x16x32_bf16 v[44:47], a[164:167], v[220:223], v[44:47]
  v_mfma_f32_16x16x32_bf16 v[48:51], a[168:171], v[220:223], v[48:51]
  v_mfma_f32_16x16x32_bf16 v[52:55], a[172:175], v[220:223], v[52:55]
  buffer_load_dwordx4 v[220:223], v250, s[12:15], s72 offen sc1
  v_mfma_f32_16x16x32_bf16 v[56:59], a[156:159], v[224:227], v[56:59]
  v_mfma_f32_16x16x32_bf16 v[60:63], a[160:163], v[224:227], v[60:63]
  v_mfma_f32_16x16x32_bf16 v[64:67], a[164:167], v[224:227], v[64:67]
  v_mfma_f32_16x16x32_bf16 v[68:71], a[168:171], v[224:227], v[68:71]
  v_mfma_f32_16x16x32_bf16 v[72:75], a[172:175], v[224:227], v[72:75]
  buffer_load_dwordx4 v[224:227], v251, s[12:15], s72 offen sc1
  v_mfma_f32_16x16x32_bf16 v[76:79], a[156:159], v[228:231], v[76:79]
  v_mfma_f32_16x16x32_bf16 v[80:83], a[160:163], v[228:231], v[80:83]
  v_mfma_f32_16x16x32_bf16 v[84:87], a[164:167], v[228:231], v[84:87]
  v_mfma_f32_16x16x32_bf16 v[88:91], a[168:171], v[228:231], v[88:91]
  v_mfma_f32_16x16x32_bf16 v[92:95], a[172:175], v[228:231], v[92:95]
  buffer_load_dwordx4 v[228:231], v252, s[12:15], s72 offen sc1
  v_mfma_f32_16x16x32_bf16 v[16:19], a[176:179], v[232:235], v[16:19]
  v_readlane_b32 s72, v15, 11
  s_nop 0
  s_add_u32 s72, s72, s62
  v_mfma_f32_16x16x32_bf16 v[20:23], a[180:183], v[232:235], v[20:23]
  v_mfma_f32_16x16x32_bf16 v[24:27], a[184:187], v[232:235], v[24:27]
  v_mfma_f32_16x16x32_bf16 v[28:31], a[188:191], v[232:235], v[28:31]
  v_mfma_f32_16x16x32_bf16 v[32:35], a[192:195], v[232:235], v[32:35]
  buffer_load_dwordx4 v[232:235], v248, s[12:15], s72 offen sc1
  v_mfma_f32_16x16x32_bf16 v[36:39], a[176:179], v[236:239], v[36:39]
  v_mfma_f32_16x16x32_bf16 v[40:43], a[180:183], v[236:239], v[40:43]
  v_mfma_f32_16x16x32_bf16 v[44:47], a[184:187], v[236:239], v[44:47]
  v_mfma_f32_16x16x32_bf16 v[48:51], a[188:191], v[236:239], v[48:51]
  v_mfma_f32_16x16x32_bf16 v[52:55], a[192:195], v[236:239], v[52:55]
  buffer_load_dwordx4 v[236:239], v250, s[12:15], s72 offen sc1
  v_mfma_f32_16x16x32_bf16 v[56:59], a[176:179], v[240:243], v[56:59]
  v_mfma_f32_16x16x32_bf16 v[60:63], a[180:183], v[240:243], v[60:63]
  v_mfma_f32_16x16x32_bf16 v[64:67], a[184:187], v[240:243], v[64:67]
  v_mfma_f32_16x16x32_bf16 v[68:71], a[188:191], v[240:243], v[68:71]
  v_mfma_f32_16x16x32_bf16 v[72:75], a[192:195], v[240:243], v[72:75]
  buffer_load_dwordx4 v[240:243], v251, s[12:15], s72 offen sc1
  v_mfma_f32_16x16x32_bf16 v[76:79], a[176:179], v[244:247], v[76:79]
  v_mfma_f32_16x16x32_bf16 v[80:83], a[180:183], v[244:247], v[80:83]
  v_mfma_f32_16x16x32_bf16 v[84:87], a[184:187], v[244:247], v[84:87]
  v_mfma_f32_16x16x32_bf16 v[88:91], a[188:191], v[244:247], v[88:91]
  v_mfma_f32_16x16x32_bf16 v[92:95], a[192:195], v[244:247], v[92:95]
  buffer_load_dwordx4 v[244:247], v252, s[12:15], s72 offen sc1
  s_waitcnt vmcnt(15)
  v_mfma_f32_16x16x32_bf16 v[16:19], a[196:199], a[0:3], v[16:19]
  v_readlane_b32 s72, v15, 12
  s_nop 0
  s_add_u32 s72, s72, s62
  v_mfma_f32_16x16x32_bf16 v[20:23], a[200:203], a[0:3], v[20:23]
  v_mfma_f32_16x16x32_bf16 v[24:27], a[204:207], a[0:3], v[24:27]
  v_readlane_b32 s43, v15, 17
  s_nop 0
  s_mul_i32 s43, s43, 5
  s_add_u32 s43, s43, s63
  s_nop 1
  buffer_load_dwordx4 a[36:39], v248, s[16:19], s43 offen offset:0 sc1
  v_mfma_f32_16x16x32_bf16 v[28:31], a[208:211], a[0:3], v[28:31]
  v_mfma_f32_16x16x32_bf16 v[32:35], a[212:215], a[0:3], v[32:35]
  buffer_load_dwordx4 a[0:3], v248, s[12:15], s72 offen sc1
  s_waitcnt vmcnt(16)
  v_mfma_f32_16x16x32_bf16 v[36:39], a[196:199], a[4:7], v[36:39]
  v_mfma_f32_16x16x32_bf16 v[40:43], a[200:203], a[4:7], v[40:43]
  v_mfma_f32_16x16x32_bf16 v[44:47], a[204:207], a[4:7], v[44:47]
  buffer_load_dwordx4 a[40:43], v248, s[16:19], s43 offen offset:1024 sc1
  v_mfma_f32_16x16x32_bf16 v[48:51], a[208:211], a[4:7], v[48:51]
  v_mfma_f32_16x16x32_bf16 v[52:55], a[212:215], a[4:7], v[52:55]
  buffer_load_dwordx4 a[4:7], v250, s[12:15], s72 offen sc1
  s_waitcnt vmcnt(17)
  v_mfma_f32_16x16x32_bf16 v[56:59], a[196:199], a[8:11], v[56:59]
  v_mfma_f32_16x16x32_bf16 v[60:63], a[200:203], a[8:11], v[60:63]
  v_mfma_f32_16x16x32_bf16 v[64:67], a[204:207], a[8:11], v[64:67]
  buffer_load_dwordx4 a[44:47], v248, s[16:19], s43 offen offset:2048 sc1
  v_mfma_f32_16x16x32_bf16 v[68:71], a[208:211], a[8:11], v[68:71]
  v_mfma_f32_16x16x32_bf16 v[72:75], a[212:215], a[8:11], v[72:75]
  buffer_load_dwordx4 a[8:11], v251, s[12:15], s72 offen sc1
  s_waitcnt vmcnt(18)
  v_mfma_f32_16x16x32_bf16 v[76:79], a[196:199], a[12:15], v[76:79]
  v_mfma_f32_16x16x32_bf16 v[80:83], a[200:203], a[12:15], v[80:83]
  v_mfma_f32_16x16x32_bf16 v[84:87], a[204:207], a[12:15], v[84:87]
  buffer_load_dwordx4 a[48:51], v248, s[16:19], s43 offen offset:3072 sc1
  v_mfma_f32_16x16x32_bf16 v[88:91], a[208:211], a[12:15], v[88:91]
  v_mfma_f32_16x16x32_bf16 v[92:95], a[212:215], a[12:15], v[92:95]
  buffer_load_dwordx4 a[12:15], v252, s[12:15], s72 offen sc1
  s_mov_b32 exec_lo, s50
  s_mov_b32 exec_hi, 0
  buffer_load_dword v8, v6, s[56:59], 0 offen sc1
  s_mov_b64 exec, -1
  s_waitcnt vmcnt(20)
  v_mfma_f32_16x16x32_bf16 v[16:19], a[216:219], a[16:19], v[16:19]
  v_readlane_b32 s72, v15, 13
  s_nop 0
  s_add_u32 s72, s72, s62
  v_mfma_f32_16x16x32_bf16 v[20:23], a[220:223], a[16:19], v[20:23]
  v_mfma_f32_16x16x32_bf16 v[24:27], a[224:227], a[16:19], v[24:27]
  buffer_load_dwordx4 a[52:55], v249, s[16:19], s43 offen offset:0 sc1
  v_mfma_f32_16x16x32_bf16 v[28:31], a[228:231], a[16:19], v[28:31]
  v_mfma_f32_16x16x32_bf16 v[32:35], a[232:235], a[16:19], v[32:35]
  buffer_load_dwordx4 a[16:19], v248, s[12:15], s72 offen sc1
  s_waitcnt vmcnt(21)
  v_mfma_f32_16x16x32_bf16 v[36:39], a[216:219], a[20:23], v[36:39]
  v_mfma_f32_16x16x32_bf16 v[40:43], a[220:223], a[20:23], v[40:43]
  v_mfma_f32_16x16x32_bf16 v[44:47], a[224:227], a[20:23], v[44:47]
  v_readlane_b32 s43, v15, 18
  s_nop 0
  s_and_b32 s43, s43, -2
  s_mul_i32 s43, s43, 5
  s_add_u32 s43, s43, s63
  s_nop 0
  buffer_load_dwordx4 a[56:59], v248, s[16:19], s43 offen offset:0 sc1
  v_mfma_f32_16x16x32_bf16 v[48:51], a[228:231], a[20:23], v[48:51]
  v_mfma_f32_16x16x32_bf16 v[52:55], a[232:235], a[20:23], v[52:55]
  buffer_load_dwordx4 a[20:23], v250, s[12:15], s72 offen sc1
  s_waitcnt vmcnt(22)
  v_mfma_f32_16x16x32_bf16 v[56:59], a[216:219], a[24:27], v[56:59]
  v_mfma_f32_16x16x32_bf16 v[60:63], a[220:223], a[24:27], v[60:63]
  v_mfma_f32_16x16x32_bf16 v[64:67], a[224:227], a[24:27], v[64:67]
  buffer_load_dwordx4 a[60:63], v248, s[16:19], s43 offen offset:1024 sc1
  v_mfma_f32_16x16x32_bf16 v[68:71], a[228:231], a[24:27], v[68:71]
  v_mfma_f32_16x16x32_bf16 v[72:75], a[232:235], a[24:27], v[72:75]
  buffer_load_dwordx4 a[24:27], v251, s[12:15], s72 offen sc1
  s_waitcnt vmcnt(23)
  v_mfma_f32_16x16x32_bf16 v[76:79], a[216:219], a[28:31], v[76:79]
  v_mfma_f32_16x16x32_bf16 v[80:83], a[220:223], a[28:31], v[80:83]
  v_mfma_f32_16x16x32_bf16 v[84:87], a[224:227], a[28:31], v[84:87]
  buffer_load_dwordx4 a[64:67], v248, s[16:19], s43 offen offset:2048 sc1
  v_mfma_f32_16x16x32_bf16 v[88:91], a[228:231], a[28:31], v[88:91]
  v_mfma_f32_16x16x32_bf16 v[92:95], a[232:235], a[28:31], v[92:95]
  buffer_load_dwordx4 a[28:31], v252, s[12:15], s72 offen sc1
  s_waitcnt vmcnt(24)
  v_mfma_f32_16x16x32_bf16 v[16:19], a[236:239], v[216:219], v[16:19]
  v_readlane_b32 s72, v15, 14
  s_nop 0
  s_add_u32 s72, s72, s62
  v_mfma_f32_16x16x32_bf16 v[20:23], a[240:243], v[216:219], v[20:23]
  v_mfma_f32_16x16x32_bf16 v[24:27], a[244:247], v[216:219], v[24:27]
  buffer_load_dwordx4 a[68:71], v248, s[16:19], s43 offen offset:3072 sc1
  v_mfma_f32_16x16x32_bf16 v[28:31], a[248:251], v[216:219], v[28:31]
  v_mfma_f32_16x16x32_bf16 v[32:35], a[252:255], v[216:219], v[32:35]
  buffer_load_dwordx4 v[216:219], v248, s[12:15], s72 offen sc1
  s_waitcnt vmcnt(25)
  v_mfma_f32_16x16x32_bf16 v[36:39], a[236:239], v[220:223], v[36:39]
  v_mfma_f32_16x16x32_bf16 v[40:43], a[240:243], v[220:223], v[40:43]
  v_mfma_f32_16x16x32_bf16 v[44:47], a[244:247], v[220:223], v[44:47]
  buffer_load_dwordx4 a[72:75], v249, s[16:19], s43 offen offset:0 sc1
  v_mfma_f32_16x16x32_bf16 v[48:51], a[248:251], v[220:223], v[48:51]
  v_mfma_f32_16x16x32_bf16 v[52:55], a[252:255], v[220:223], v[52:55]
  buffer_load_dwordx4 v[220:223], v250, s[12:15], s72 offen sc1
  s_waitcnt vmcnt(26)
  v_mfma_f32_16x16x32_bf16 v[56:59], a[236:239], v[224:227], v[56:59]
  v_mfma_f32_16x16x32_bf16 v[60:63], a[240:243], v[224:227], v[60:63]
  v_mfma_f32_16x16x32_bf16 v[64:67], a[244:247], v[224:227], v[64:67]
  v_mfma_f32_16x16x32_bf16 v[68:71], a[248:251], v[224:227], v[68:71]
  v_mfma_f32_16x16x32_bf16 v[72:75], a[252:255], v[224:227], v[72:75]
  buffer_load_dwordx4 v[224:227], v251, s[12:15], s72 offen sc1
  s_waitcnt vmcnt(26)
  v_mfma_f32_16x16x32_bf16 v[76:79], a[236:239], v[228:231], v[76:79]
  v_mfma_f32_16x16x32_bf16 v[80:83], a[240:243], v[228:231], v[80:83]
  v_mfma_f32_16x16x32_bf16 v[84:87], a[244:247], v[228:231], v[84:87]
  v_mfma_f32_16x16x32_bf16 v[88:91], a[248:251], v[228:231], v[88:91]
  v_mfma_f32_16x16x32_bf16 v[92:95], a[252:255], v[228:231], v[92:95]
  buffer_load_dwordx4 v[228:231], v252, s[12:15], s72 offen sc1
  s_waitcnt vmcnt(14)
  s_mov_b32 s74, 0
L_plw4:
  v_sub_u32 v9, v8, v7
  v_cmp_gt_u32 vcc, 3, v9
  s_add_u32 s74, s74, 1
  s_nop 2
  s_and_b32 s72, vcc_lo, s50
  s_cbranch_scc0 L_plw4_ok
  s_cmp_ge_u32 s74, 0x80000
  s_cbranch_scc1 L_plw4_ok
  s_sleep 8
  buffer_load_dword v8, v6, s[56:59], 0 offen sc1
  s_waitcnt vmcnt(0)
  s_branch L_plw4
L_plw4_ok:
  v_mfma_f32_16x16x32_bf16 v[16:19], v[96:99], v[232:235], v[16:19]
  v_readlane_b32 s72, v15, 15
  s_bitcmp1_b32 s72, 0
  s_cselect_b32 s14, 0, 9699328
  s_and_b32 s72, s72, -2
  s_add_u32 s72, s72, s62
  v_mfma_f32_16x16x32_bf16 v[20:23], v[100:103], v[232:235], v[20:23]
  v_mfma_f32_16x16x32_bf16 v[24:27], v[104:107], v[232:235], v[24:27]
  v_mfma_f32_16x16x32_bf16 v[28:31], v[108:111], v[232:235], v[28:31]
  v_mfma_f32_16x16x32_bf16 v[32:35], v[112:115], v[232:235], v[32:35]
  buffer_load_dwordx4 v[232:235], v248, s[12:15], s72 offen sc1
  v_mfma_f32_16x16x32_bf16 v[36:39], v[96:99], v[236:239], v[36:39]
  v_mfma_f32_16x16x32_bf16 v[40:43], v[100:103], v[236:239], v[40:43]
  v_mfma_f32_16x16x32_bf16 v[44:47], v[104:107], v[236:239], v[44:47]
  v_mfma_f32_16x16x32_bf16 v[48:51], v[108:111], v[236:239], v[48:51]
  v_mfma_f32_16x16x32_bf16 v[52:55], v[112:115], v[236:239], v[52:55]
  buffer_load_dwordx4 v[236:239], v250, s[12:15], s72 offen sc1
  v_mfma_f32_16x16x32_bf16 v[56:59], v[96:99], v[240:243], v[56:59]
  v_mfma_f32_16x16x32_bf16 v[60:63], v[100:103], v[240:243], v[60:63]
  v_mfma_f32_16x16x32_bf16 v[64:67], v[104:107], v[240:243], v[64:67]
  v_mfma_f32_16x16x32_bf16 v[68:71], v[108:111], v[240:243], v[68:71]
  v_mfma_f32_16x16x32_bf16 v[72:75], v[112:115], v[240:243], v[72:75]
  buffer_load_dwordx4 v[240:243], v251, s[12:15], s72 offen sc1
  v_mfma_f32_16x16x32_bf16 v[76:79], v[96:99], v[244:247], v[76:79]
  v_mfma_f32_16x16x32_bf16 v[80:83], v[100:103], v[244:247], v[80:83]
  v_mfma_f32_16x16x32_bf16 v[84:87], v[104:107], v[244:247], v[84:87]
  v_mfma_f32_16x16x32_bf16 v[88:91], v[108:111], v[244:247], v[88:91]
  v_mfma_f32_16x16x32_bf16 v[92:95], v[112:115], v[244:247], v[92:95]
  buffer_load_dwordx4 v[244:247], v252, s[12:15], s72 offen sc1
  v_mfma_f32_16x16x32_bf16 v[16:19], v[116:119], a[0:3], v[16:19]
  v_readlane_b32 s72, v15, 16
  s_mov_b32 s14, 9699328
  s_add_u32 s72, s72, s62
  v_mfma_f32_16x16x32_bf16 v[20:23], v[120:123], a[0:3], v[20:23]
  v_mfma_f32_16x16x32_bf16 v[24:27], v[124:127], a[0:3], v[24:27]
  v_mfma_f32_16x16x32_bf16 v[28:31], v[128:131], a[0:3], v[28:31]
  v_mfma_f32_16x16x32_bf16 v[32:35], v[132:135], a[0:3], v[32:35]
  buffer_load_dwordx4 a[0:3], v248, s[12:15], s72 offen sc1
  v_add_u32 v14, 0, v1
  v_mul_u32_u24 v0, 3277, v14
  v_lshrrev_b32 v0, 16, v0
  v_mul_u32_u24 v96, 20, v0
  v_sub_u32 v14, v14, v96
  v_mul_u32_u24 v96, 336, v0
  v_lshl_add_u32 v96, v14, 4, v96
  v_add_u32 v2, s36, v96
  v_lshlrev_b32 v7, 3, v14
  v_and_b32 v96, 8, v0
  v_and_b32 v97, 3, v0
  v_lshl_add_u32 v96, v97, 1, v96
  v_bfe_u32 v97, v0, 2, 1
  v_add_u32 v96, v96, v97
  v_lshlrev_b32 v96, 1, v96
  v_add_u32 v96, s26, v96
  v_mul_u32_u24 v96, 1280, v96
  v_add_u32 v253, v96, v7
  v_mfma_f32_16x16x32_bf16 v[36:39], v[116:119], a[4:7], v[36:39]
  v_mfma_f32_16x16x32_bf16 v[40:43], v[120:123], a[4:7], v[40:43]
  v_mfma_f32_16x16x32_bf16 v[44:47], v[124:127], a[4:7], v[44:47]
  v_mfma_f32_16x16x32_bf16 v[48:51], v[128:131], a[4:7], v[48:51]
  v_mfma_f32_16x16x32_bf16 v[52:55], v[132:135], a[4:7], v[52:55]
  buffer_load_dwordx4 a[4:7], v250, s[12:15], s72 offen sc1
  v_add_u32 v14, 64, v1
  v_mul_u32_u24 v0, 3277, v14
  v_lshrrev_b32 v0, 16, v0
  v_mul_u32_u24 v96, 20, v0
  v_sub_u32 v14, v14, v96
  v_mul_u32_u24 v96, 336, v0
  v_lshl_add_u32 v96, v14, 4, v96
  v_add_u32 v3, s36, v96
  v_lshlrev_b32 v8, 3, v14
  v_and_b32 v96, 8, v0
  v_and_b32 v97, 3, v0
  v_lshl_add_u32 v96, v97, 1, v96
  v_bfe_u32 v97, v0, 2, 1
  v_add_u32 v96, v96, v97
  v_lshlrev_b32 v96, 1, v96
  v_add_u32 v96, s26, v96
  v_mul_u32_u24 v96, 1280, v96
  v_add_u32 v254, v96, v8
  v_mfma_f32_16x16x32_bf16 v[56:59], v[116:119], a[8:11], v[56:59]
  v_mfma_f32_16x16x32_bf16 v[60:63], v[120:123], a[8:11], v[60:63]
  v_mfma_f32_16x16x32_bf16 v[64:67], v[124:127], a[8:11], v[64:67]
  v_mfma_f32_16x16x32_bf16 v[68:71], v[128:131], a[8:11], v[68:71]
  v_mfma_f32_16x16x32_bf16 v[72:75], v[132:135], a[8:11], v[72:75]
  buffer_load_dwordx4 a[8:11], v251, s[12:15], s72 offen sc1
  v_add_u32 v14, 128, v1
  v_mul_u32_u24 v0, 3277, v14
  v_lshrrev_b32 v0, 16, v0
  v_mul_u32_u24 v96, 20, v0
  v_sub_u32 v14, v14, v96
  v_mul_u32_u24 v96, 336, v0
  v_lshl_add_u32 v96, v14, 4, v96
  v_add_u32 v4, s36, v96
  v_lshlrev_b32 v9, 3, v14
  v_and_b32 v96, 8, v0
  v_and_b32 v97, 3, v0
  v_lshl_add_u32 v96, v97, 1, v96
  v_bfe_u32 v97, v0, 2, 1
  v_add_u32 v96, v96, v97
  v_lshlrev_b32 v96, 1, v96
  v_add_u32 v96, s26, v96
  v_mul_u32_u24 v96, 1280, v96
  v_add_u32 v255, v96, v9
  v_mfma_f32_16x16x32_bf16 v[76:79], v[116:119], a[12:15], v[76:79]
  v_mfma_f32_16x16x32_bf16 v[80:83], v[120:123], a[12:15], v[80:83]
  v_mfma_f32_16x16x32_bf16 v[84:87], v[124:127], a[12:15], v[84:87]
  v_mfma_f32_16x16x32_bf16 v[88:91], v[128:131], a[12:15], v[88:91]
  v_mfma_f32_16x16x32_bf16 v[92:95], v[132:135], a[12:15], v[92:95]
  buffer_load_dwordx4 a[12:15], v252, s[12:15], s72 offen sc1
  v_add_u32 v14, 192, v1
  v_mul_u32_u24 v0, 3277, v14
  v_lshrrev_b32 v0, 16, v0
  v_mul_u32_u24 v96, 20, v0
  v_sub_u32 v14, v14, v96
  v_mul_u32_u24 v96, 336, v0
  v_lshl_add_u32 v96, v14, 4, v96
  v_add_u32 v5, s36, v96
  v_lshlrev_b32 v10, 3, v14
  v_and_b32 v96, 8, v0
  v_and_b32 v97, 3, v0
  v_lshl_add_u32 v96, v97, 1, v96
  v_bfe_u32 v97, v0, 2, 1
  v_add_u32 v96, v96, v97
  v_lshlrev_b32 v96, 1, v96
  v_add_u32 v96, s26, v96
  v_mul_u32_u24 v96, 1280, v96
  v_add_u32 v12, v96, v10
  s_waitcnt vmcnt(20)
  v_mfma_f32_16x16x32_bf16 v[16:19], v[136:139], a[16:19], v[16:19]
  v_readlane_b32 s72, v15, 17
  s_nop 0
  s_add_u32 s72, s72, s62
  v_mfma_f32_16x16x32_bf16 v[20:23], v[140:143], a[16:19], v[20:23]
  v_mfma_f32_16x16x32_bf16 v[24:27], v[144:147], a[16:19], v[24:27]
  v_mfma_f32_16x16x32_bf16 v[28:31], v[148:151], a[16:19], v[28:31]
  v_mfma_f32_16x16x32_bf16 v[32:35], v[152:155], a[16:19], v[32:35]
  buffer_load_dwordx4 a[16:19], v248, s[12:15], s72 offen sc1
  v_add_u32 v14, 256, v1
  v_mul_u32_u24 v0, 3277, v14
  v_lshrrev_b32 v0, 16, v0
  v_mul_u32_u24 v96, 20, v0
  v_sub_u32 v14, v14, v96
  v_mul_u32_u24 v96, 336, v0
  v_lshl_add_u32 v96, v14, 4, v96
  v_add_u32 v6, s36, v96
  v_lshlrev_b32 v11, 3, v14
  v_and_b32 v96, 8, v0
  v_and_b32 v97, 3, v0
  v_lshl_add_u32 v96, v97, 1, v96
  v_bfe_u32 v97, v0, 2, 1
  v_add_u32 v96, v96, v97
  v_lshlrev_b32 v96, 1, v96
  v_add_u32 v96, s26, v96
  v_mul_u32_u24 v96, 1280, v96
  v_add_u32 v13, v96, v11
  s_mul_i32 s26, s20, 5376
  v_and_b32 v14, 15, v1
  v_mul_u32_u24 v14, 336, v14
  v_lshrrev_b32 v0, 4, v1
  v_lshl_add_u32 v14, v0, 4, v14
  v_add_u32 v14, s26, v14
  s_waitcnt vmcnt(19)
  v_mfma_f32_16x16x32_bf16 v[36:39], v[136:139], a[20:23], v[36:39]
  v_mfma_f32_16x16x32_bf16 v[40:43], v[140:143], a[20:23], v[40:43]
  v_mfma_f32_16x16x32_bf16 v[44:47], v[144:147], a[20:23], v[44:47]
  v_mfma_f32_16x16x32_bf16 v[48:51], v[148:151], a[20:23], v[48:51]
  v_mfma_f32_16x16x32_bf16 v[52:55], v[152:155], a[20:23], v[52:55]
  buffer_load_dwordx4 a[20:23], v250, s[12:15], s72 offen sc1
  s_waitcnt vmcnt(18)
  v_mfma_f32_16x16x32_bf16 v[56:59], v[136:139], a[24:27], v[56:59]
  v_mfma_f32_16x16x32_bf16 v[60:63], v[140:143], a[24:27], v[60:63]
  v_mfma_f32_16x16x32_bf16 v[64:67], v[144:147], a[24:27], v[64:67]
  v_mfma_f32_16x16x32_bf16 v[68:71], v[148:151], a[24:27], v[68:71]
  v_mfma_f32_16x16x32_bf16 v[72:75], v[152:155], a[24:27], v[72:75]
  buffer_load_dwordx4 a[24:27], v251, s[12:15], s72 offen sc1
  s_waitcnt vmcnt(17)
  v_mfma_f32_16x16x32_bf16 v[76:79], v[136:139], a[28:31], v[76:79]
  v_mfma_f32_16x16x32_bf16 v[80:83], v[140:143], a[28:31], v[80:83]
  v_mfma_f32_16x16x32_bf16 v[84:87], v[144:147], a[28:31], v[84:87]
  v_mfma_f32_16x16x32_bf16 v[88:91], v[148:151], a[28:31], v[88:91]
  v_mfma_f32_16x16x32_bf16 v[92:95], v[152:155], a[28:31], v[92:95]
  buffer_load_dwordx4 a[28:31], v252, s[12:15], s72 offen sc1
  buffer_load_dwordx2 v[96:97], v253, s[4:7], s31 offen
  buffer_load_dwordx2 v[98:99], v254, s[4:7], s31 offen
  buffer_load_dwordx2 v[100:101], v255, s[4:7], s31 offen
  buffer_load_dwordx2 v[102:103], v12, s[4:7], s31 offen
  buffer_load_dwordx2 v[104:105], v13, s[4:7], s31 offen
  buffer_load_dwordx2 v[106:107], v7, s[76:79], s31 offen
  buffer_load_dwordx2 v[108:109], v8, s[76:79], s31 offen
  buffer_load_dwordx2 v[110:111], v9, s[76:79], s31 offen
  buffer_load_dwordx2 v[112:113], v10, s[76:79], s31 offen
  buffer_load_dwordx2 v[114:115], v11, s[76:79], s31 offen
  s_waitcnt vmcnt(26)
  v_mfma_f32_16x16x32_bf16 v[16:19], v[156:159], v[216:219], v[16:19]
  v_readlane_b32 s72, v15, 18
  s_bitcmp1_b32 s72, 0
  s_cselect_b32 s14, 0, 9699328
  s_and_b32 s72, s72, -2
  s_add_u32 s72, s72, s62
  v_mfma_f32_16x16x32_bf16 v[20:23], v[160:163], v[216:219], v[20:23]
  v_mfma_f32_16x16x32_bf16 v[24:27], v[164:167], v[216:219], v[24:27]
  v_mfma_f32_16x16x32_bf16 v[28:31], v[168:171], v[216:219], v[28:31]
  v_mfma_f32_16x16x32_bf16 v[32:35], v[172:175], v[216:219], v[32:35]
  buffer_load_dwordx4 v[216:219], v248, s[12:15], s72 offen sc1
  s_waitcnt vmcnt(25)
  v_mfma_f32_16x16x32_bf16 v[36:39], v[156:159], v[220:223], v[36:39]
  v_mfma_f32_16x16x32_bf16 v[40:43], v[160:163], v[220:223], v[40:43]
  v_mfma_f32_16x16x32_bf16 v[44:47], v[164:167], v[220:223], v[44:47]
  v_mfma_f32_16x16x32_bf16 v[48:51], v[168:171], v[220:223], v[48:51]
  v_mfma_f32_16x16x32_bf16 v[52:55], v[172:175], v[220:223], v[52:55]
  buffer_load_dwordx4 v[220:223], v250, s[12:15], s72 offen sc1
  s_waitcnt vmcnt(25)
  v_mfma_f32_16x16x32_bf16 v[56:59], v[156:159], v[224:227], v[56:59]
  v_mfma_f32_16x16x32_bf16 v[60:63], v[160:163], v[224:227], v[60:63]
  v_mfma_f32_16x16x32_bf16 v[64:67], v[164:167], v[224:227], v[64:67]
  v_mfma_f32_16x16x32_bf16 v[68:71], v[168:171], v[224:227], v[68:71]
  v_mfma_f32_16x16x32_bf16 v[72:75], v[172:175], v[224:227], v[72:75]
  buffer_load_dwordx4 v[224:227], v251, s[12:15], s72 offen sc1
  s_waitcnt vmcnt(25)
  v_mfma_f32_16x16x32_bf16 v[76:79], v[156:159], v[228:231], v[76:79]
  v_mfma_f32_16x16x32_bf16 v[80:83], v[160:163], v[228:231], v[80:83]
  v_mfma_f32_16x16x32_bf16 v[84:87], v[164:167], v[228:231], v[84:87]
  v_mfma_f32_16x16x32_bf16 v[88:91], v[168:171], v[228:231], v[88:91]
  v_mfma_f32_16x16x32_bf16 v[92:95], v[172:175], v[228:231], v[92:95]
  buffer_load_dwordx4 v[228:231], v252, s[12:15], s72 offen sc1
  s_waitcnt vmcnt(25)
  v_mfma_f32_16x16x32_bf16 v[16:19], v[176:179], v[232:235], v[16:19]
  v_mfma_f32_16x16x32_bf16 v[20:23], v[180:183], v[232:235], v[20:23]
  v_mfma_f32_16x16x32_bf16 v[24:27], v[184:187], v[232:235], v[24:27]
  v_mfma_f32_16x16x32_bf16 v[28:31], v[188:191], v[232:235], v[28:31]
  v_mfma_f32_16x16x32_bf16 v[32:35], v[192:195], v[232:235], v[32:35]
  s_waitcnt vmcnt(24)
  v_mfma_f32_16x16x32_bf16 v[36:39], v[176:179], v[236:239], v[36:39]
  v_mfma_f32_16x16x32_bf16 v[40:43], v[180:183], v[236:239], v[40:43]
  v_mfma_f32_16x16x32_bf16 v[44:47], v[184:187], v[236:239], v[44:47]
  v_mfma_f32_16x16x32_bf16 v[48:51], v[188:191], v[236:239], v[48:51]
  v_mfma_f32_16x16x32_bf16 v[52:55], v[192:195], v[236:239], v[52:55]
  s_waitcnt vmcnt(23)
  v_mfma_f32_16x16x32_bf16 v[56:59], v[176:179], v[240:243], v[56:59]
  v_mfma_f32_16x16x32_bf16 v[60:63], v[180:183], v[240:243], v[60:63]
  v_mfma_f32_16x16x32_bf16 v[64:67], v[184:187], v[240:243], v[64:67]
  v_mfma_f32_16x16x32_bf16 v[68:71], v[188:191], v[240:243], v[68:71]
  v_mfma_f32_16x16x32_bf16 v[72:75], v[192:195], v[240:243], v[72:75]
  s_waitcnt vmcnt(22)
  v_mfma_f32_16x16x32_bf16 v[76:79], v[176:179], v[244:247], v[76:79]
  v_mfma_f32_16x16x32_bf16 v[80:83], v[180:183], v[244:247], v[80:83]
  v_mfma_f32_16x16x32_bf16 v[84:87], v[184:187], v[244:247], v[84:87]
  v_mfma_f32_16x16x32_bf16 v[88:91], v[188:191], v[244:247], v[88:91]
  v_mfma_f32_16x16x32_bf16 v[92:95], v[192:195], v[244:247], v[92:95]
  s_waitcnt vmcnt(21)
  v_mfma_f32_16x16x32_bf16 v[16:19], v[196:199], a[0:3], v[16:19]
  v_mfma_f32_16x16x32_bf16 v[20:23], v[200:203], a[0:3], v[20:23]
  v_mfma_f32_16x16x32_bf16 v[24:27], v[204:207], a[0:3], v[24:27]
  v_mfma_f32_16x16x32_bf16 v[28:31], v[208:211], a[0:3], v[28:31]
  v_mfma_f32_16x16x32_bf16 v[32:35], v[212:215], a[0:3], v[32:35]
  s_waitcnt vmcnt(20)
  v_mfma_f32_16x16x32_bf16 v[36:39], v[196:199], a[4:7], v[36:39]
  v_mfma_f32_16x16x32_bf16 v[40:43], v[200:203], a[4:7], v[40:43]
  v_mfma_f32_16x16x32_bf16 v[44:47], v[204:207], a[4:7], v[44:47]
  v_mfma_f32_16x16x32_bf16 v[48:51], v[208:211], a[4:7], v[48:51]
  v_mfma_f32_16x16x32_bf16 v[52:55], v[212:215], a[4:7], v[52:55]
  s_waitcnt vmcnt(19)
  v_mfma_f32_16x16x32_bf16 v[56:59], v[196:199], a[8:11], v[56:59]
  v_mfma_f32_16x16x32_bf16 v[60:63], v[200:203], a[8:11], v[60:63]
  v_mfma_f32_16x16x32_bf16 v[64:67], v[204:207], a[8:11], v[64:67]
  v_mfma_f32_16x16x32_bf16 v[68:71], v[208:211], a[8:11], v[68:71]
  v_mfma_f32_16x16x32_bf16 v[72:75], v[212:215], a[8:11], v[72:75]
  s_waitcnt vmcnt(18)
  v_mfma_f32_16x16x32_bf16 v[76:79], v[196:199], a[12:15], v[76:79]
  v_mfma_f32_16x16x32_bf16 v[80:83], v[200:203], a[12:15], v[80:83]
  v_mfma_f32_16x16x32_bf16 v[84:87], v[204:207], a[12:15], v[84:87]
  v_mfma_f32_16x16x32_bf16 v[88:91], v[208:211], a[12:15], v[88:91]
  v_mfma_f32_16x16x32_bf16 v[92:95], v[212:215], a[12:15], v[92:95]
  s_waitcnt vmcnt(17)
  v_mfma_f32_16x16x32_bf16 v[16:19], a[36:39], a[16:19], v[16:19]
  v_mfma_f32_16x16x32_bf16 v[20:23], a[40:43], a[16:19], v[20:23]
  v_mfma_f32_16x16x32_bf16 v[24:27], a[44:47], a[16:19], v[24:27]
  v_mfma_f32_16x16x32_bf16 v[28:31], a[48:51], a[16:19], v[28:31]
  v_mfma_f32_16x16x32_bf16 v[32:35], a[52:55], a[16:19], v[32:35]
  s_waitcnt vmcnt(16)
  v_mfma_f32_16x16x32_bf16 v[36:39], a[36:39], a[20:23], v[36:39]
  v_mfma_f32_16x16x32_bf16 v[40:43], a[40:43], a[20:23], v[40:43]
  v_mfma_f32_16x16x32_bf16 v[44:47], a[44:47], a[20:23], v[44:47]
  v_mfma_f32_16x16x32_bf16 v[48:51], a[48:51], a[20:23], v[48:51]
  v_mfma_f32_16x16x32_bf16 v[52:55], a[52:55], a[20:23], v[52:55]
  s_waitcnt vmcnt(15)
  v_mfma_f32_16x16x32_bf16 v[56:59], a[36:39], a[24:27], v[56:59]
  v_mfma_f32_16x16x32_bf16 v[60:63], a[40:43], a[24:27], v[60:63]
  v_mfma_f32_16x16x32_bf16 v[64:67], a[44:47], a[24:27], v[64:67]
  v_mfma_f32_16x16x32_bf16 v[68:71], a[48:51], a[24:27], v[68:71]
  v_mfma_f32_16x16x32_bf16 v[72:75], a[52:55], a[24:27], v[72:75]
  s_waitcnt vmcnt(14)
  v_mfma_f32_16x16x32_bf16 v[76:79], a[36:39], a[28:31], v[76:79]
  v_mfma_f32_16x16x32_bf16 v[80:83], a[40:43], a[28:31], v[80:83]
  v_mfma_f32_16x16x32_bf16 v[84:87], a[44:47], a[28:31], v[84:87]
  v_mfma_f32_16x16x32_bf16 v[88:91], a[48:51], a[28:31], v[88:91]
  v_mfma_f32_16x16x32_bf16 v[92:95], a[52:55], a[28:31], v[92:95]
  s_waitcnt vmcnt(13)
  v_lshlrev_b32 v120, 16, v96
  v_and_b32 v121, 0xffff0000, v96
  s_waitcnt vmcnt(8)
  v_lshlrev_b32 v140, 16, v106
  v_and_b32 v141, 0xffff0000, v106
  v_lshlrev_b32 v122, 16, v97
  v_and_b32 v123, 0xffff0000, v97
  v_lshlrev_b32 v142, 16, v107
  v_and_b32 v143, 0xffff0000, v107
  v_lshlrev_b32 v124, 16, v98
  v_and_b32 v125, 0xffff0000, v98
  s_waitcnt vmcnt(7)
  v_lshlrev_b32 v144, 16, v108
  v_and_b32 v145, 0xffff0000, v108
  v_lshlrev_b32 v126, 16, v99
  v_and_b32 v127, 0xffff0000, v99
  v_lshlrev_b32 v146, 16, v109
  v_and_b32 v147, 0xffff0000, v109
  v_lshlrev_b32 v128, 16, v100
  v_and_b32 v129, 0xffff0000, v100
  s_waitcnt vmcnt(6)
  v_lshlrev_b32 v148, 16, v110
  v_and_b32 v149, 0xffff0000, v110
  v_lshlrev_b32 v130, 16, v101
  v_and_b32 v131, 0xffff0000, v101
  v_lshlrev_b32 v150, 16, v111
  v_and_b32 v151, 0xffff0000, v111
  v_lshlrev_b32 v132, 16, v102
  v_and_b32 v133, 0xffff0000, v102
  s_waitcnt vmcnt(5)
  v_lshlrev_b32 v152, 16, v112
  v_and_b32 v153, 0xffff0000, v112
  v_lshlrev_b32 v134, 16, v103
  v_and_b32 v135, 0xffff0000, v103
  v_lshlrev_b32 v154, 16, v113
  v_and_b32 v155, 0xffff0000, v113
  v_lshlrev_b32 v136, 16, v104
  v_and_b32 v137, 0xffff0000, v104
  s_waitcnt vmcnt(4)
  v_lshlrev_b32 v156, 16, v114
  v_and_b32 v157, 0xffff0000, v114
  v_lshlrev_b32 v138, 16, v105
  v_and_b32 v139, 0xffff0000, v105
  v_lshlrev_b32 v158, 16, v115
  v_and_b32 v159, 0xffff0000, v115
  v_add_f32 v120, v120, v140
  v_add_f32 v121, v121, v141
  v_add_f32 v122, v122, v142
  v_add_f32 v123, v123, v143
  v_add_f32 v124, v124, v144
  v_add_f32 v125, v125, v145
  v_add_f32 v126, v126, v146
  v_add_f32 v127, v127, v147
  v_add_f32 v128, v128, v148
  v_add_f32 v129, v129, v149
  v_add_f32 v130, v130, v150
  v_add_f32 v131, v131, v151
  v_add_f32 v132, v132, v152
  v_add_f32 v133, v133, v153
  v_add_f32 v134, v134, v154
  v_add_f32 v135, v135, v155
  v_add_f32 v136, v136, v156
  v_add_f32 v137, v137, v157
  v_add_f32 v138, v138, v158
  v_add_f32 v139, v139, v159
  s_waitcnt vmcnt(3)
  v_mfma_f32_16x16x32_bf16 v[16:19], a[56:59], v[216:219], v[16:19]
  v_mfma_f32_16x16x32_bf16 v[20:23], a[60:63], v[216:219], v[20:23]
  v_mfma_f32_16x16x32_bf16 v[24:27], a[64:67], v[216:219], v[24:27]
  v_mfma_f32_16x16x32_bf16 v[28:31], a[68:71], v[216:219], v[28:31]
  v_mfma_f32_16x16x32_bf16 v[32:35], a[72:75], v[216:219], v[32:35]
  s_waitcnt vmcnt(2)
  v_mfma_f32_16x16x32_bf16 v[36:39], a[56:59], v[220:223], v[36:39]
  s_nop 1
  ds_write_b128 v14, v[16:19] offset:0
  v_mfma_f32_16x16x32_bf16 v[40:43], a[60:63], v[220:223], v[40:43]
  ds_write_b128 v14, v[20:23] offset:64
  v_mfma_f32_16x16x32_bf16 v[44:47], a[64:67], v[220:223], v[44:47]
  ds_write_b128 v14, v[24:27] offset:128
  v_mfma_f32_16x16x32_bf16 v[48:51], a[68:71], v[220:223], v[48:51]
  ds_write_b128 v14, v[28:31] offset:192
  v_mfma_f32_16x16x32_bf16 v[52:55], a[72:75], v[220:223], v[52:55]
  ds_write_b128 v14, v[32:35] offset:256
  s_waitcnt vmcnt(1)
  v_mfma_f32_16x16x32_bf16 v[56:59], a[56:59], v[224:227], v[56:59]
  ds_write_b128 v14, v[36:39] offset:21504
  v_mfma_f32_16x16x32_bf16 v[60:63], a[60:63], v[224:227], v[60:63]
  ds_write_b128 v14, v[40:43] offset:21568
  v_mfma_f32_16x16x32_bf16 v[64:67], a[64:67], v[224:227], v[64:67]
  ds_write_b128 v14, v[44:47] offset:21632
  v_mfma_f32_16x16x32_bf16 v[68:71], a[68:71], v[224:227], v[68:71]
  ds_write_b128 v14, v[48:51] offset:21696
  v_mfma_f32_16x16x32_bf16 v[72:75], a[72:75], v[224:227], v[72:75]
  ds_write_b128 v14, v[52:55] offset:21760
  s_waitcnt vmcnt(0)
  v_mfma_f32_16x16x32_bf16 v[76:79], a[56:59], v[228:231], v[76:79]
  ds_write_b128 v14, v[56:59] offset:43008
  v_mfma_f32_16x16x32_bf16 v[80:83], a[60:63], v[228:231], v[80:83]
  ds_write_b128 v14, v[60:63] offset:43072
  v_mfma_f32_16x16x32_bf16 v[84:87], a[64:67], v[228:231], v[84:87]
  ds_write_b128 v14, v[64:67] offset:43136
  v_mfma_f32_16x16x32_bf16 v[88:91], a[68:71], v[228:231], v[88:91]
  ds_write_b128 v14, v[68:71] offset:43200
  v_mfma_f32_16x16x32_bf16 v[92:95], a[72:75], v[228:231], v[92:95]
  ds_write_b128 v14, v[72:75] offset:43264
  ds_write_b128 v14, v[76:79] offset:64512
  ds_write_b128 v14, v[80:83] offset:64576
  s_nop 0
  ds_write_b128 v14, v[84:87] offset:64640
  s_nop 0
  ds_write_b128 v14, v[88:91] offset:64704
  s_nop 0
  ds_write_b128 v14, v[92:95] offset:64768
  s_waitcnt lgkmcnt(0)
  s_barrier
  ds_read_b128 v[16:19], v2 offset:0
  ds_read_b128 v[36:39], v2 offset:5376
  ds_read_b128 v[56:59], v2 offset:10752
  ds_read_b128 v[76:79], v2 offset:16128
  ds_read_b128 v[20:23], v3 offset:0
  ds_read_b128 v[40:43], v3 offset:5376
  ds_read_b128 v[60:63], v3 offset:10752
  ds_read_b128 v[80:83], v3 offset:16128
  ds_read_b128 v[24:27], v4 offset:0
  ds_read_b128 v[44:47], v4 offset:5376
  ds_read_b128 v[64:67], v4 offset:10752
  ds_read_b128 v[84:87], v4 offset:16128
  ds_read_b128 v[28:31], v5 offset:0
  ds_read_b128 v[48:51], v5 offset:5376
  ds_read_b128 v[68:71], v5 offset:10752
  ds_read_b128 v[88:91], v5 offset:16128
  ds_read_b128 v[32:35], v6 offset:0
  ds_read_b128 v[52:55], v6 offset:5376
  ds_read_b128 v[72:75], v6 offset:10752
  ds_read_b128 v[92:95], v6 offset:16128
  s_waitcnt lgkmcnt(15)
  v_add_f32 v16, v16, v36
  v_add_f32 v56, v56, v76
  v_add_f32 v120, v120, v16
  v_add_f32 v120, v120, v56
  v_add_f32 v17, v17, v37
  v_add_f32 v57, v57, v77
  v_add_f32 v121, v121, v17
  v_add_f32 v121, v121, v57
  v_add_f32 v18, v18, v38
  v_add_f32 v58, v58, v78
  v_add_f32 v122, v122, v18
  v_add_f32 v122, v122, v58
  v_add_f32 v19, v19, v39
  v_add_f32 v59, v59, v79
  v_add_f32 v123, v123, v19
  v_add_f32 v123, v123, v59
  v_cvt_pk_bf16_f32 v100, v120, v121
  v_cvt_pk_bf16_f32 v101, v122, v123
  buffer_store_dwordx2 v[100:101], v253, s[8:11], s31 offen nt
  s_waitcnt lgkmcnt(14)
  v_add_f32 v20, v20, v40
  s_waitcnt lgkmcnt(12)
  v_add_f32 v60, v60, v80
  v_add_f32 v124, v124, v20
  v_add_f32 v124, v124, v60
  v_add_f32 v21, v21, v41
  v_add_f32 v61, v61, v81
  v_add_f32 v125, v125, v21
  v_add_f32 v125, v125, v61
  v_add_f32 v22, v22, v42
  v_add_f32 v62, v62, v82
  v_add_f32 v126, v126, v22
  v_add_f32 v126, v126, v62
  v_add_f32 v23, v23, v43
  v_add_f32 v63, v63, v83
  v_add_f32 v127, v127, v23
  v_add_f32 v127, v127, v63
  v_cvt_pk_bf16_f32 v102, v124, v125
  v_cvt_pk_bf16_f32 v103, v126, v127
  buffer_store_dwordx2 v[102:103], v254, s[8:11], s31 offen nt
  s_waitcnt lgkmcnt(10)
  v_add_f32 v24, v24, v44
  s_waitcnt lgkmcnt(8)
  v_add_f32 v64, v64, v84
  v_add_f32 v128, v128, v24
  v_add_f32 v128, v128, v64
  v_add_f32 v25, v25, v45
  v_add_f32 v65, v65, v85
  v_add_f32 v129, v129, v25
  v_add_f32 v129, v129, v65
  v_add_f32 v26, v26, v46
  v_add_f32 v66, v66, v86
  v_add_f32 v130, v130, v26
  v_add_f32 v130, v130, v66
  v_add_f32 v27, v27, v47
  v_add_f32 v67, v67, v87
  v_add_f32 v131, v131, v27
  v_add_f32 v131, v131, v67
  v_cvt_pk_bf16_f32 v104, v128, v129
  v_cvt_pk_bf16_f32 v105, v130, v131
  buffer_store_dwordx2 v[104:105], v255, s[8:11], s31 offen nt
  s_waitcnt lgkmcnt(6)
  v_add_f32 v28, v28, v48
  s_waitcnt lgkmcnt(4)
  v_add_f32 v68, v68, v88
  v_add_f32 v132, v132, v28
  v_add_f32 v132, v132, v68
  v_add_f32 v29, v29, v49
  v_add_f32 v69, v69, v89
  v_add_f32 v133, v133, v29
  v_add_f32 v133, v133, v69
  v_add_f32 v30, v30, v50
  v_add_f32 v70, v70, v90
  v_add_f32 v134, v134, v30
  v_add_f32 v134, v134, v70
  v_add_f32 v31, v31, v51
  v_add_f32 v71, v71, v91
  v_add_f32 v135, v135, v31
  v_add_f32 v135, v135, v71
  v_cvt_pk_bf16_f32 v106, v132, v133
  v_cvt_pk_bf16_f32 v107, v134, v135
  buffer_store_dwordx2 v[106:107], v12, s[8:11], s31 offen nt
  s_waitcnt lgkmcnt(2)
  v_add_f32 v32, v32, v52
  s_waitcnt lgkmcnt(0)
  v_add_f32 v72, v72, v92
  v_add_f32 v136, v136, v32
  v_add_f32 v136, v136, v72
  v_add_f32 v33, v33, v53
  v_add_f32 v73, v73, v93
  v_add_f32 v137, v137, v33
  v_add_f32 v137, v137, v73
  v_add_f32 v34, v34, v54
  v_add_f32 v74, v74, v94
  v_add_f32 v138, v138, v34
  v_add_f32 v138, v138, v74
  v_add_f32 v35, v35, v55
  v_add_f32 v75, v75, v95
  v_add_f32 v139, v139, v35
  v_add_f32 v139, v139, v75
  v_cvt_pk_bf16_f32 v108, v136, v137
  v_cvt_pk_bf16_f32 v109, v138, v139
  buffer_store_dwordx2 v[108:109], v13, s[8:11], s31 offen nt
L_end1:
  s_endpgm
.section .rodata,"a"
.p2align 6
.amdhsa_kernel parallel_sum__sliding_local_dilated__mixer_channel_mlp__prompt_kernel
  .amdhsa_next_free_vgpr 512
  .amdhsa_next_free_sgpr 102
  .amdhsa_accum_offset 256
  .amdhsa_group_segment_fixed_size 0
  .amdhsa_kernarg_size 88
  .amdhsa_user_sgpr_count 2
  .amdhsa_user_sgpr_kernarg_segment_ptr 1
  .amdhsa_system_sgpr_workgroup_id_x 1
.end_amdhsa_kernel
```
